```python
import torch

def _softmax(x, axis=-1):
    return torch.softmax(x, dim=axis)
def _gelu(x):
    return torch.nn.functional.gelu(x, approximate="tanh")
def _silu(x):
    return torch.nn.functional.silu(x)
def _sigmoid(x):
    return torch.sigmoid(x)
def _layernorm(x, axis=-1, eps=1e-5):
    m = x.mean(dim=axis, keepdim=True)
    v = x.var(dim=axis, keepdim=True, unbiased=False)
    return (x - m) / torch.sqrt(v + eps)
def _scatter_add(tgt, idx, src, axis=0):
    return tgt.clone().index_add_(axis, idx, src)
def _segment_sum(src, seg, n):
    out = torch.zeros((n,) + src.shape[1:], dtype=src.dtype)
    return out.index_add_(0, seg, src)
def _pad(x, pw):
    flat = tuple(v for pair in reversed(pw) for v in pair)
    return torch.nn.functional.pad(x, flat)

kernel_name = 'concat_heads__mha_block_cached__mha_block_cached__near_ridge'

def setup_inputs():

    _w = (lambda a: (lambda t: t.to(torch.bfloat16) if t.is_floating_point() else t)(torch.as_tensor(a)))
    def _A_setup():
        B, Sq, D = 16, 96, 576
        H, Sk, Dh = 32, 512, 128
        return {
            "x": _w((lambda *s: torch.randn(*s, dtype=torch.bfloat16) * 0.8)(B, Sq, D)),
            "k_cache": _w((lambda *s: torch.randn(*s, dtype=torch.bfloat16) * 0.8)(B, H, Sk, Dh)),
            "v_cache": _w((lambda *s: torch.randn(*s, dtype=torch.bfloat16) * 0.05)(B, H, Sk, Dh)),
            "wq": _w((lambda *s: torch.randn(*s, dtype=torch.bfloat16) * 0.8)(D, H * Dh) * (D ** -0.5)),
            "wo": _w((lambda *s: torch.randn(*s, dtype=torch.bfloat16) * 0.05)(H * Dh, D) * ((H * Dh) ** -0.5)),
        }
    _A_in = _A_setup()

    def _B_setup():
        B, Sq, D = 16, 96, 576
        H, Sk, Dh = 32, 512, 128
        return {
            "x": _w((lambda *s: torch.randn(*s, dtype=torch.bfloat16) * 0.8)(B, Sq, D)),
            "k_cache": _w((lambda *s: torch.randn(*s, dtype=torch.bfloat16) * 0.8)(B, H, Sk, Dh)),
            "v_cache": _w((lambda *s: torch.randn(*s, dtype=torch.bfloat16) * 0.05)(B, H, Sk, Dh)),
            "wq": _w((lambda *s: torch.randn(*s, dtype=torch.bfloat16) * 0.8)(D, H * Dh) * (D ** -0.5)),
            "wo": _w((lambda *s: torch.randn(*s, dtype=torch.bfloat16) * 0.05)(H * Dh, D) * ((H * Dh) ** -0.5)),
        }
    _B_in = _B_setup()

    return {
        "A_x": _A_in["x"],
        "A_k_cache": _A_in["k_cache"],
        "A_v_cache": _A_in["v_cache"],
        "A_wq": _A_in["wq"],
        "A_wo": _A_in["wo"],
        "B_x": _B_in["x"],
        "B_k_cache": _B_in["k_cache"],
        "B_v_cache": _B_in["v_cache"],
        "B_wq": _B_in["wq"],
        "B_wo": _B_in["wo"],
    }

def reference(A_x, A_k_cache, A_v_cache, A_wq, A_wo, B_x, B_k_cache, B_v_cache, B_wq, B_wo):
    def _A_ref(x, k_cache, v_cache, wq, wo):
        B, Sq, D = x.shape
        H, Dh = 32, 128
        q = (lambda x, *d: x.permute(*d))((x @ wq).reshape(B, Sq, H, Dh), 0, 2, 1, 3)
        scores = torch.einsum("bhqd,bhkd->bhqk", q, k_cache) * (Dh ** -0.5)
        p = _softmax(scores, axis=-1)
        o = torch.einsum("bhqk,bhkd->bhqd", p, v_cache)
        return (lambda x, *d: x.permute(*d))(o, 0, 2, 1, 3).reshape(B, Sq, H * Dh) @ wo

    def _B_ref(x, k_cache, v_cache, wq, wo):
        B, Sq, D = x.shape
        H, Dh = 32, 128
        q = (lambda x, *d: x.permute(*d))((x @ wq).reshape(B, Sq, H, Dh), 0, 2, 1, 3)
        scores = torch.einsum("bhqd,bhkd->bhqk", q, k_cache) * (Dh ** -0.5)
        p = _softmax(scores, axis=-1)
        o = torch.einsum("bhqk,bhkd->bhqd", p, v_cache)
        return (lambda x, *d: x.permute(*d))(o, 0, 2, 1, 3).reshape(B, Sq, H * Dh) @ wo

    a = _A_ref(A_x, A_k_cache, A_v_cache, A_wq, A_wo)
    b = _B_ref(B_x, B_k_cache, B_v_cache, B_wq, B_wo)
    return torch.concatenate([a, b], axis=-1)
```

```asm
; @launch grid=(256,1,1) block=(256,1,1) lds=163840
.amdgcn_target "amdgcn-amd-amdhsa--gfx950"
.macro mf d,a,b,c
v_mfma_f32_16x16x32_bf16 \d,\a,\b,\c
.endm
.macro tr d,a,o
ds_read_b64_tr_b16 \d,\a offset:\o
.endm
.macro rq d,a,o
ds_read_b128 \d,\a offset:\o
.endm
.macro dn v,r,s,o
buffer_load_dwordx4 \v,\r,\s offen offset:\o nt lds
.endm
.macro dl v,r,s,o
buffer_load_dwordx4 \v,\r,\s offen offset:\o lds
.endm
.macro wl n
s_waitcnt lgkmcnt(\n)
.endm
.macro cv d,a,b
v_cvt_pk_bf16_f32 \d,\a,\b
.endm
.macro ex d
v_exp_f32 \d,\d
.endm
.text
.globl concat_heads__mha_block_cached__mha_block_cached__near_ridge_kernel
.p2align 8
.type concat_heads__mha_block_cached__mha_block_cached__near_ridge_kernel,@function
concat_heads__mha_block_cached__mha_block_cached__near_ridge_kernel:
s_cmp_ge_u32 s2, 256
s_cbranch_scc1 L_end0
s_load_dwordx16 s[80:95], s[0:1], 0
s_load_dwordx4 s[96:99], s[0:1], 64
s_load_dwordx4 s[68:71], s[0:1], 80
s_load_dwordx2 s[72:73], s[0:1], 96
v_lshrrev_b32 v1, 6, v0
v_and_b32 v0, 63, v0
v_readfirstlane_b32 s3, v1
s_and_b32 s40, s2, 7
s_lshr_b32 s41, s2, 3
s_lshr_b32 s42, s40, 2
s_and_b32 s43, s40, 3
s_lshr_b32 s44, s41, 1
s_and_b32 s45, s41, 1
s_lshl_b32 s46, s43, 1
s_add_u32 s46, s46, s45
s_mul_i32 s48, s45, 5
s_add_u32 s48, s48, s44
s_sub_u32 s49, s48, 9
s_cmp_ge_u32 s48, 9
s_cselect_b32 s48, s49, s48
s_sub_u32 s49, s48, 9
s_cmp_ge_u32 s48, 9
s_cselect_b32 s48, s49, s48
s_lshl_b32 s52, s48, 19
s_lshl_b32 s61, s48, 7
s_lshl_b32 s4, s3, 12
s_mul_i32 s5, s3, 3072
v_lshrrev_b32 v176, 5, v0
v_and_b32 v179, 7, v0
s_mul_i32 s36, s3, 24
v_lshrrev_b32 v177, 3, v0
v_add3_u32 v177, v177, s36, 0
v_bfe_u32 v178, v177, 1, 3
v_xor_b32 v178, v178, v179
v_mul_u32_u24 v177, 1152, v177
v_lshl_add_u32 v25, v178, 4, v177
v_lshrrev_b32 v177, 3, v0
v_add3_u32 v177, v177, s36, 8
v_bfe_u32 v178, v177, 1, 3
v_xor_b32 v178, v178, v179
v_mul_u32_u24 v177, 1152, v177
v_lshl_add_u32 v26, v178, 4, v177
v_subrev_u32 v26, 1024, v26
v_lshrrev_b32 v177, 3, v0
v_add3_u32 v177, v177, s36, 16
v_bfe_u32 v178, v177, 1, 3
v_xor_b32 v178, v178, v179
v_mul_u32_u24 v177, 1152, v177
v_lshl_add_u32 v27, v178, 4, v177
v_subrev_u32 v27, 2048, v27
s_lshl_b32 s36, s3, 3
v_add_u32 v177, s36, v176
v_lshlrev_b32 v177, 13, v177
v_and_b32 v178, 31, v0
v_lshlrev_b32 v179, 2, v176
v_xor_b32 v178, v178, v179
v_lshl_add_u32 v20, v178, 4, v177
v_xor_b32 v21, 0x80, v20
v_add_u32 v22, 30720, v20
v_add_u32 v23, 46080, v21
v_add_u32 v21, 15360, v21
s_mul_i32 s36, s44, 110592
s_lshl_b32 s37, s46, 10
s_mov_b32 s26, 0x1b000
s_mov_b32 s27, 0x20000
s_sub_u32 s18, 0x480000, s37
s_mov_b32 s19, 0x20000
wl 0
s_cmp_eq_u32 s42, 0
s_cselect_b64 s[24:25], s[80:81], s[90:91]
s_cselect_b64 s[16:17], s[86:87], s[96:97]
s_cselect_b64 s[8:9], s[82:83], s[92:93]
s_cselect_b64 s[12:13], s[84:85], s[94:95]
s_cselect_b64 s[20:21], s[88:89], s[98:99]
s_add_u32 s24, s24, s36
s_addc_u32 s25, s25, 0
s_and_b32 s25, s25, 0xffff
s_add_u32 m0, s5, 0x0
s_nop 0
dl v25,s[24:27],s61,0
dl v26,s[24:27],s61,1024
dl v27,s[24:27],s61,2048
s_add_u32 s16, s16, s37
s_addc_u32 s17, s17, 0
s_and_b32 s17, s17, 0xffff
s_add_u32 m0, s4, 0x18000
s_nop 0
dl v20,s[16:19],s52,0
dl v21,s[16:19],s52,1024
dl v22,s[16:19],s52,2048
dl v23,s[16:19],s52,3072
s_getpc_b64 s[28:29]
L_pc0:
s_and_b32 s29, s29, 0xffff
s_mov_b32 s30, L_codeend-L_pc0
s_mov_b32 s31, 0x20000
s_lshl_b32 s47, s41, 2
s_add_u32 s47, s47, s3
s_mul_i32 s47, s47, 640
v_min_u32 v2, 4, v0
v_lshlrev_b32 v2, 7, v2
buffer_load_dword v246, v2, s[28:31], s47 offen
s_lshr_b32 s38, s3, 1
s_and_b32 s39, s3, 1
s_sub_u32 s49, s44, 9
s_min_u32 s41, s44, s49
s_lshl_b32 s41, s41, 7
s_add_u32 s48, s48, 1
s_cmp_eq_u32 s48, 9
s_cselect_b32 s48, 0, s48
s_lshl_b32 s53, s48, 19
s_lshl_b32 s62, s48, 7
s_add_u32 s48, s48, 1
s_cmp_eq_u32 s48, 9
s_cselect_b32 s48, 0, s48
s_lshl_b32 s54, s48, 19
s_lshl_b32 s63, s48, 7
s_add_u32 s48, s48, 1
s_cmp_eq_u32 s48, 9
s_cselect_b32 s48, 0, s48
s_lshl_b32 s55, s48, 19
s_lshl_b32 s64, s48, 7
s_add_u32 s48, s48, 1
s_cmp_eq_u32 s48, 9
s_cselect_b32 s48, 0, s48
s_lshl_b32 s56, s48, 19
s_lshl_b32 s65, s48, 7
s_add_u32 s48, s48, 1
s_cmp_eq_u32 s48, 9
s_cselect_b32 s48, 0, s48
s_lshl_b32 s57, s48, 19
s_lshl_b32 s66, s48, 7
s_add_u32 s48, s48, 1
s_cmp_eq_u32 s48, 9
s_cselect_b32 s48, 0, s48
s_lshl_b32 s58, s48, 19
s_lshl_b32 s67, s48, 7
s_add_u32 s48, s48, 1
s_cmp_eq_u32 s48, 9
s_cselect_b32 s48, 0, s48
s_lshl_b32 s59, s48, 19
s_lshl_b32 s43, s48, 7
s_add_u32 s48, s48, 1
s_cmp_eq_u32 s48, 9
s_cselect_b32 s48, 0, s48
s_lshl_b32 s60, s48, 19
s_lshl_b32 s45, s48, 7
v_and_b32 v172, 15, v0
v_lshrrev_b32 v173, 4, v0
v_bfe_u32 v174, v0, 2, 2
v_and_b32 v175, 3, v0
v_lshl_add_u32 v177, v173, 3, v174
v_lshlrev_b32 v177, 9, v177
v_lshl_add_u32 v178, v174, 2, v175
v_lshl_add_u32 v177, v178, 4, v177
s_lshl_b32 s36, s38, 8
v_add_u32 v177, s36, v177
v_add_u32 v248, 0x18000, v177
v_xor_b32 v249, 64, v248
v_xor_b32 v250, 128, v248
v_xor_b32 v251, 192, v248
v_add_u32 v220, 0xc000, v177
v_xor_b32 v221, 64, v220
v_xor_b32 v222, 128, v220
v_xor_b32 v223, 192, v220
s_mul_i32 s36, s39, 6144
v_lshlrev_b32 v177, 7, v172
v_add_u32 v177, s36, v177
v_lshrrev_b32 v178, 1, v172
v_xor_b32 v178, v178, v173
v_lshl_add_u32 v224, v178, 4, v177
v_xor_b32 v225, 64, v224
v_add_u32 v252, 0x18000, v224
v_add_u32 v253, 0x18000, v225
s_lshl_b32 s36, s44, 22
s_lshl_b32 s37, s46, 19
s_add_u32 s36, s36, s37
s_add_u32 s8, s8, s36
s_addc_u32 s9, s9, 0
s_and_b32 s9, s9, 0xffff
s_mov_b32 s10, 0x80000
s_mov_b32 s11, 0x20000
s_add_u32 s12, s12, s36
s_addc_u32 s13, s13, 0
s_and_b32 s13, s13, 0xffff
s_mov_b32 s14, 0x80000
s_mov_b32 s15, 0x20000
s_mul_i32 s36, s46, 589824
s_add_u32 s20, s20, s36
s_addc_u32 s21, s21, 0
s_and_b32 s21, s21, 0xffff
s_mov_b32 s22, 0x90000
s_mov_b32 s23, 0x20000
s_lshl_b32 s40, s42, 4
s_add_u32 s40, s40, s44
s_mul_i32 s36, s40, 885760
s_mov_b64 s[28:29], s[72:73]
s_add_u32 s28, s28, s36
s_addc_u32 s29, s29, 0
s_and_b32 s29, s29, 0xffff
s_mov_b32 s30, 0xd8400
s_mov_b32 s31, 0x20000
s_lshr_b32 s49, s2, 3
s_and_b32 s49, s49, 7
s_lshl_b32 s100, s3, 8
s_add_u32 s100, s100, s49
s_lshl_b32 s98, s46, 1
s_add_u32 s98, s98, s44
s_and_b32 s98, s98, 15
s_lshl_b32 s98, s98, 13
s_lshl_b32 s101, s46, 3
s_add_u32 s101, s101, 0xd8000
s_mul_i32 s47, s46, 110592
s_add_u32 s47, s47, s5
s_mov_b32 s34, 0x3e0293ee
s_mov_b32 s35, 0x3e0293ee
s_lshl_b32 s36, s3, 3
v_add_u32 v177, s36, v173
v_lshlrev_b32 v177, 8, v177
s_lshl_b32 s37, s3, 2
v_or_b32 v178, s37, v173
v_xor_b32 v178, v178, v172
v_lshl_add_u32 v16, v178, 4, v177
v_add_u32 v17, 129024, v16
s_lshl_b32 s37, s39, 2
v_or_b32 v178, s37, v173
v_lshlrev_b32 v178, 1, v178
v_xor_b32 v178, v178, v172
v_lshl_add_u32 v18, v178, 4, v177
v_add_u32 v19, 129024, v18
s_lshl_b32 s36, s3, 5
v_lshrrev_b32 v177, 3, v0
v_add_u32 v177, s36, v177
v_mul_u32_u24 v177, 1152, v177
v_lshlrev_b32 v178, 1, v173
v_and_b32 v179, 7, v0
v_xor_b32 v178, v178, v179
v_lshl_add_u32 v24, v178, 4, v177
s_lshl_b32 s36, s38, 11
v_lshrrev_b32 v177, 2, v172
v_lshlrev_b32 v177, 12, v177
v_add_u32 v177, s36, v177
v_lshl_add_u32 v177, v175, 8, v177
v_xor_b32 v178, v173, v172
v_lshl_add_u32 v4, v178, 4, v177
v_xor_b32 v5, 64, v4
v_xor_b32 v6, 128, v4
v_xor_b32 v7, 192, v4
v_lshlrev_b32 v177, 12, v173
v_add_u32 v177, s36, v177
v_lshl_add_u32 v177, v174, 8, v177
v_lshl_add_u32 v177, v175, 3, v177
v_and_b32 v178, 1, v173
v_lshl_or_b32 v178, v178, 2, v174
v_lshl_add_u32 v177, v178, 5, v177
v_add_u32 v8, 0xc000, v177
v_xor_b32 v9, 32, v8
v_xor_b32 v10, 64, v8
v_xor_b32 v11, 96, v8
v_xor_b32 v12, 128, v8
v_xor_b32 v13, 160, v8
v_xor_b32 v14, 192, v8
v_xor_b32 v15, 224, v8
v_lshl_add_u32 v177, v173, 2, v174
v_bfe_u32 v178, v177, 1, 2
s_lshl_b32 s36, s38, 1
v_xor_b32 v178, s36, v178
v_lshlrev_b32 v177, 7, v177
v_lshl_add_u32 v177, v178, 5, v177
v_lshl_add_u32 v2, v175, 3, v177
v_mov_b32 v177, 0x3f803f80
v_accvgpr_write_b32 a228, v177
v_accvgpr_write_b32 a229, v177
v_accvgpr_write_b32 a230, v177
v_accvgpr_write_b32 a231, v177
s_add_u32 m0, s4, 0x1c000
s_add_u32 s32, s52, 0x40000
dl v20,s[16:19],s32,0
dl v21,s[16:19],s32,1024
dl v22,s[16:19],s32,2048
dl v23,s[16:19],s32,3072
s_add_u32 m0, s5, 0x4000
s_nop 0
dl v25,s[24:27],s62,0
dl v26,s[24:27],s62,1024
dl v27,s[24:27],s62,2048
s_waitcnt vmcnt(8)
s_barrier
tr a[232:233],v248,0
tr a[234:235],v248,2048
rq a[0:3],v224,0
rq a[4:7],v224,2048
rq a[8:11],v224,4096
wl 2
mf v[28:31],a[232:235],a[0:3],0
tr a[236:237],v248,8
tr a[238:239],v248,2056
wl 2
mf v[32:35],a[232:235],a[4:7],0
tr a[240:241],v249,0
tr a[242:243],v249,2048
mf v[36:39],a[232:235],a[8:11],0
tr a[244:245],v249,8
tr a[246:247],v249,2056
wl 4
mf v[172:175],a[236:239],a[0:3],0
tr a[248:249],v250,0
tr a[250:251],v250,2048
mf v[176:179],a[236:239],a[4:7],0
tr a[252:253],v250,8
s_add_u32 m0, s4, 0xc000
mf v[180:183],a[236:239],a[8:11],0
tr a[254:255],v250,2056
dl v20,s[16:19],s53,0
wl 6
mf v[40:43],a[240:243],a[0:3],0
tr a[232:233],v251,0
dl v21,s[16:19],s53,1024
mf v[44:47],a[240:243],a[4:7],0
rq a[12:15],v225,0
dl v22,s[16:19],s53,2048
mf v[48:51],a[240:243],a[8:11],0
rq a[16:19],v225,2048
dl v23,s[16:19],s53,3072
wl 7
mf v[184:187],a[244:247],a[0:3],0
tr a[234:235],v251,2048
s_add_u32 m0, s4, 0x10000
mf v[188:191],a[244:247],a[4:7],0
s_waitcnt vmcnt(7)
s_barrier
mf v[192:195],a[244:247],a[8:11],0
rq a[20:23],v225,4096
tr a[236:237],v251,8
wl 7
mf v[52:55],a[248:251],a[0:3],0
tr a[238:239],v251,2056
s_add_u32 s32, s53, 0x40000
mf v[56:59],a[248:251],a[4:7],0
tr a[240:241],v248,16384
dl v20,s[16:19],s32,0
mf v[60:63],a[248:251],a[8:11],0
tr a[242:243],v248,18432
dl v21,s[16:19],s32,1024
wl 7
mf v[196:199],a[252:255],a[0:3],0
tr a[244:245],v248,16392
dl v22,s[16:19],s32,2048
mf v[200:203],a[252:255],a[4:7],0
tr a[246:247],v248,18440
dl v23,s[16:19],s32,3072
mf v[204:207],a[252:255],a[8:11],0
tr a[248:249],v249,16384
s_add_u32 m0, s5, 0x8000
wl 8
mf v[64:67],a[232:235],a[0:3],0
tr a[250:251],v249,18432
dl v25,s[24:27],s63,0
mf v[68:71],a[232:235],a[4:7],0
dl v26,s[24:27],s63,1024
mf v[72:75],a[232:235],a[8:11],0
tr a[252:253],v249,16392
dl v27,s[24:27],s63,2048
wl 6
mf v[208:211],a[236:239],a[0:3],0
tr a[254:255],v249,18440
s_add_u32 m0, s4, 0x14000
mf v[212:215],a[236:239],a[4:7],0
dl v20,s[16:19],s54,0
mf v[216:219],a[236:239],a[8:11],0
tr a[232:233],v250,16384
dl v21,s[16:19],s54,1024
wl 5
mf v[28:31],a[240:243],a[12:15],v[28:31]
tr a[234:235],v250,18432
dl v22,s[16:19],s54,2048
mf v[32:35],a[240:243],a[16:19],v[32:35]
dl v23,s[16:19],s54,3072
mf v[36:39],a[240:243],a[20:23],v[36:39]
tr a[236:237],v250,16392
s_add_u32 m0, s4, 0x20000
mf v[172:175],a[244:247],a[12:15],v[172:175]
tr a[238:239],v250,18440
s_add_u32 s32, s54, 0x40000
mf v[176:179],a[244:247],a[16:19],v[176:179]
dl v20,s[16:19],s32,0
mf v[180:183],a[244:247],a[20:23],v[180:183]
tr a[240:241],v251,16384
dl v21,s[16:19],s32,1024
wl 5
mf v[40:43],a[248:251],a[12:15],v[40:43]
tr a[242:243],v251,18432
dl v22,s[16:19],s32,2048
mf v[44:47],a[248:251],a[16:19],v[44:47]
dl v23,s[16:19],s32,3072
mf v[48:51],a[248:251],a[20:23],v[48:51]
tr a[244:245],v251,16392
s_add_u32 m0, s5, 0x24000
mf v[184:187],a[252:255],a[12:15],v[184:187]
tr a[246:247],v251,18440
dl v25,s[24:27],s64,0
mf v[188:191],a[252:255],a[16:19],v[188:191]
s_waitcnt vmcnt(16)
s_barrier
mf v[192:195],a[252:255],a[20:23],v[192:195]
rq a[24:27],v224,16384
dl v26,s[24:27],s64,1024
wl 5
mf v[52:55],a[232:235],a[12:15],v[52:55]
rq a[28:31],v224,18432
dl v27,s[24:27],s64,2048
mf v[56:59],a[232:235],a[16:19],v[56:59]
rq a[32:35],v224,20480
s_add_u32 m0, s4, 0x18000
mf v[60:63],a[232:235],a[20:23],v[60:63]
tr a[248:249],v220,0
wl 6
mf v[196:199],a[236:239],a[12:15],v[196:199]
tr a[250:251],v220,2048
mf v[200:203],a[236:239],a[16:19],v[200:203]
tr a[252:253],v220,8
mf v[204:207],a[236:239],a[20:23],v[204:207]
tr a[254:255],v220,2056
wl 7
mf v[64:67],a[240:243],a[12:15],v[64:67]
rq a[36:39],v225,16384
mf v[68:71],a[240:243],a[16:19],v[68:71]
rq a[40:43],v225,18432
mf v[72:75],a[240:243],a[20:23],v[72:75]
tr a[232:233],v221,0
mf v[208:211],a[244:247],a[12:15],v[208:211]
rq a[44:47],v225,20480
tr a[234:235],v221,2048
mf v[212:215],a[244:247],a[16:19],v[212:215]
tr a[236:237],v221,8
wl 8
mf v[216:219],a[244:247],a[20:23],v[216:219]
tr a[238:239],v221,2056
dl v20,s[16:19],s55,0
mf v[28:31],a[248:251],a[24:27],v[28:31]
tr a[240:241],v222,0
wl 8
mf v[32:35],a[248:251],a[28:31],v[32:35]
tr a[242:243],v222,2048
mf v[36:39],a[248:251],a[32:35],v[36:39]
tr a[244:245],v222,8
dl v21,s[16:19],s55,1024
mf v[172:175],a[252:255],a[24:27],v[172:175]
tr a[246:247],v222,2056
mf v[176:179],a[252:255],a[28:31],v[176:179]
dl v22,s[16:19],s55,2048
mf v[180:183],a[252:255],a[32:35],v[180:183]
tr a[248:249],v223,0
wl 6
mf v[40:43],a[232:235],a[24:27],v[40:43]
tr a[250:251],v223,2048
wl 6
mf v[44:47],a[232:235],a[28:31],v[44:47]
dl v23,s[16:19],s55,3072
mf v[48:51],a[232:235],a[32:35],v[48:51]
tr a[252:253],v223,8
wl 5
mf v[184:187],a[236:239],a[24:27],v[184:187]
tr a[254:255],v223,2056
mf v[188:191],a[236:239],a[28:31],v[188:191]
s_waitcnt vmcnt(18)
s_barrier
mf v[192:195],a[236:239],a[32:35],v[192:195]
tr a[232:233],v220,16384
s_add_u32 m0, s4, 0x1c000
mf v[52:55],a[240:243],a[24:27],v[52:55]
tr a[234:235],v220,18432
s_add_u32 s32, s55, 0x40000
mf v[56:59],a[240:243],a[28:31],v[56:59]
dl v20,s[16:19],s32,0
mf v[60:63],a[240:243],a[32:35],v[60:63]
tr a[236:237],v220,16392
wl 5
mf v[196:199],a[244:247],a[24:27],v[196:199]
tr a[238:239],v220,18440
mf v[200:203],a[244:247],a[28:31],v[200:203]
dl v21,s[16:19],s32,1024
mf v[204:207],a[244:247],a[32:35],v[204:207]
tr a[240:241],v221,16384
wl 5
mf v[64:67],a[248:251],a[24:27],v[64:67]
tr a[242:243],v221,18432
mf v[68:71],a[248:251],a[28:31],v[68:71]
tr a[244:245],v221,16392
mf v[72:75],a[248:251],a[32:35],v[72:75]
dl v22,s[16:19],s32,2048
mf v[208:211],a[252:255],a[24:27],v[208:211]
tr a[246:247],v221,18440
wl 5
mf v[212:215],a[252:255],a[28:31],v[212:215]
tr a[248:249],v222,16384
mf v[216:219],a[252:255],a[32:35],v[216:219]
dl v23,s[16:19],s32,3072
mf v[28:31],a[232:235],a[36:39],v[28:31]
tr a[250:251],v222,18432
wl 5
mf v[32:35],a[232:235],a[40:43],v[32:35]
tr a[252:253],v222,16392
mf v[36:39],a[232:235],a[44:47],v[36:39]
tr a[254:255],v222,18440
wl 5
mf v[172:175],a[236:239],a[36:39],v[172:175]
tr a[232:233],v223,16384
mf v[176:179],a[236:239],a[40:43],v[176:179]
tr a[234:235],v223,18432
mf v[180:183],a[236:239],a[44:47],v[180:183]
tr a[236:237],v223,16392
wl 6
mf v[40:43],a[240:243],a[36:39],v[40:43]
tr a[238:239],v223,18440
mf v[44:47],a[240:243],a[40:43],v[44:47]
mf v[48:51],a[240:243],a[44:47],v[48:51]
wl 5
mf v[184:187],a[244:247],a[36:39],v[184:187]
mf v[188:191],a[244:247],a[40:43],v[188:191]
s_waitcnt vmcnt(15)
s_barrier
mf v[192:195],a[244:247],a[44:47],v[192:195]
rq a[48:51],v224,32768
wl 3
mf v[52:55],a[248:251],a[36:39],v[52:55]
rq a[52:55],v224,34816
mf v[56:59],a[248:251],a[40:43],v[56:59]
rq a[56:59],v224,36864
mf v[60:63],a[248:251],a[44:47],v[60:63]
tr a[240:241],v220,32768
mf v[196:199],a[252:255],a[36:39],v[196:199]
tr a[242:243],v220,34816
mf v[200:203],a[252:255],a[40:43],v[200:203]
tr a[244:245],v220,32776
mf v[204:207],a[252:255],a[44:47],v[204:207]
tr a[246:247],v220,34824
wl 7
mf v[64:67],a[232:235],a[36:39],v[64:67]
rq a[60:63],v225,32768
mf v[68:71],a[232:235],a[40:43],v[68:71]
rq a[64:67],v225,34816
mf v[72:75],a[232:235],a[44:47],v[72:75]
tr a[248:249],v221,32768
mf v[208:211],a[236:239],a[36:39],v[208:211]
rq a[68:71],v225,36864
tr a[250:251],v221,34816
mf v[212:215],a[236:239],a[40:43],v[212:215]
tr a[252:253],v221,32776
wl 8
mf v[216:219],a[236:239],a[44:47],v[216:219]
tr a[254:255],v221,34824
mf v[28:31],a[240:243],a[48:51],v[28:31]
tr a[232:233],v222,32768
wl 8
mf v[32:35],a[240:243],a[52:55],v[32:35]
tr a[234:235],v222,34816
mf v[36:39],a[240:243],a[56:59],v[36:39]
tr a[236:237],v222,32776
mf v[172:175],a[244:247],a[48:51],v[172:175]
tr a[238:239],v222,34824
mf v[176:179],a[244:247],a[52:55],v[176:179]
tr a[240:241],v223,32768
wl 7
mf v[180:183],a[244:247],a[56:59],v[180:183]
tr a[242:243],v223,34816
mf v[40:43],a[248:251],a[48:51],v[40:43]
tr a[244:245],v223,32776
wl 7
mf v[44:47],a[248:251],a[52:55],v[44:47]
tr a[246:247],v223,34824
mf v[48:51],a[248:251],a[56:59],v[48:51]
wl 6
mf v[184:187],a[252:255],a[48:51],v[184:187]
mf v[188:191],a[252:255],a[52:55],v[188:191]
s_waitcnt vmcnt(11)
s_barrier
mf v[192:195],a[252:255],a[56:59],v[192:195]
tr a[248:249],v248,32768
wl 4
mf v[52:55],a[232:235],a[48:51],v[52:55]
tr a[250:251],v248,34816
mf v[56:59],a[232:235],a[52:55],v[56:59]
tr a[252:253],v248,32776
mf v[60:63],a[232:235],a[56:59],v[60:63]
tr a[254:255],v248,34824
wl 4
mf v[196:199],a[236:239],a[48:51],v[196:199]
tr a[232:233],v249,32768
mf v[200:203],a[236:239],a[52:55],v[200:203]
tr a[234:235],v249,34816
mf v[204:207],a[236:239],a[56:59],v[204:207]
tr a[236:237],v249,32776
mf v[64:67],a[240:243],a[48:51],v[64:67]
tr a[238:239],v249,34824
mf v[68:71],a[240:243],a[52:55],v[68:71]
mf v[72:75],a[240:243],a[56:59],v[72:75]
tr a[240:241],v250,32768
wl 6
mf v[208:211],a[244:247],a[48:51],v[208:211]
tr a[242:243],v250,34816
mf v[212:215],a[244:247],a[52:55],v[212:215]
mf v[216:219],a[244:247],a[56:59],v[216:219]
tr a[244:245],v250,32776
wl 5
mf v[28:31],a[248:251],a[60:63],v[28:31]
tr a[246:247],v250,34824
mf v[32:35],a[248:251],a[64:67],v[32:35]
mf v[36:39],a[248:251],a[68:71],v[36:39]
tr a[248:249],v251,32768
mf v[172:175],a[252:255],a[60:63],v[172:175]
tr a[250:251],v251,34816
mf v[176:179],a[252:255],a[64:67],v[176:179]
mf v[180:183],a[252:255],a[68:71],v[180:183]
tr a[252:253],v251,32776
wl 5
mf v[40:43],a[232:235],a[60:63],v[40:43]
tr a[254:255],v251,34824
mf v[44:47],a[232:235],a[64:67],v[44:47]
mf v[48:51],a[232:235],a[68:71],v[48:51]
mf v[184:187],a[236:239],a[60:63],v[184:187]
mf v[188:191],a[236:239],a[64:67],v[188:191]
s_waitcnt vmcnt(4)
s_barrier
mf v[192:195],a[236:239],a[68:71],v[192:195]
rq a[72:75],v252,49152
s_add_u32 m0, s5, 0x8000
mf v[52:55],a[240:243],a[60:63],v[52:55]
rq a[76:79],v252,51200
wl 3
mf v[56:59],a[240:243],a[64:67],v[56:59]
rq a[80:83],v252,53248
mf v[60:63],a[240:243],a[68:71],v[60:63]
tr a[232:233],v248,0
mf v[196:199],a[244:247],a[60:63],v[196:199]
tr a[234:235],v248,2048
mf v[200:203],a[244:247],a[64:67],v[200:203]
tr a[236:237],v248,8
mf v[204:207],a[244:247],a[68:71],v[204:207]
tr a[238:239],v248,2056
wl 7
mf v[64:67],a[248:251],a[60:63],v[64:67]
rq a[84:87],v253,49152
mf v[68:71],a[248:251],a[64:67],v[68:71]
rq a[88:91],v253,51200
mf v[72:75],a[248:251],a[68:71],v[72:75]
tr a[240:241],v249,0
mf v[208:211],a[252:255],a[60:63],v[208:211]
rq a[92:95],v253,53248
dl v25,s[24:27],s65,0
mf v[212:215],a[252:255],a[64:67],v[212:215]
tr a[242:243],v249,2048
dl v26,s[24:27],s65,1024
mf v[216:219],a[252:255],a[68:71],v[216:219]
tr a[244:245],v249,8
dl v27,s[24:27],s65,2048
wl 7
mf v[28:31],a[232:235],a[72:75],v[28:31]
tr a[246:247],v249,2056
s_add_u32 m0, s4, 0xc000
mf v[32:35],a[232:235],a[76:79],v[32:35]
tr a[248:249],v250,0
wl 7
mf v[36:39],a[232:235],a[80:83],v[36:39]
tr a[250:251],v250,2048
mf v[172:175],a[236:239],a[72:75],v[172:175]
tr a[252:253],v250,8
dl v20,s[16:19],s56,0
mf v[176:179],a[236:239],a[76:79],v[176:179]
tr a[254:255],v250,2056
dl v21,s[16:19],s56,1024
mf v[180:183],a[236:239],a[80:83],v[180:183]
tr a[232:233],v251,0
dl v22,s[16:19],s56,2048
wl 7
mf v[40:43],a[240:243],a[72:75],v[40:43]
tr a[234:235],v251,2048
mf v[44:47],a[240:243],a[76:79],v[44:47]
dl v23,s[16:19],s56,3072
mf v[48:51],a[240:243],a[80:83],v[48:51]
tr a[236:237],v251,8
s_add_u32 m0, s4, 0x10000
wl 6
mf v[184:187],a[244:247],a[72:75],v[184:187]
tr a[238:239],v251,2056
s_add_u32 s32, s56, 0x40000
mf v[188:191],a[244:247],a[76:79],v[188:191]
s_waitcnt vmcnt(7)
s_barrier
mf v[192:195],a[244:247],a[80:83],v[192:195]
tr a[240:241],v248,16384
dl v20,s[16:19],s32,0
wl 5
mf v[52:55],a[248:251],a[72:75],v[52:55]
tr a[242:243],v248,18432
dl v21,s[16:19],s32,1024
mf v[56:59],a[248:251],a[76:79],v[56:59]
dl v22,s[16:19],s32,2048
mf v[60:63],a[248:251],a[80:83],v[60:63]
tr a[244:245],v248,16392
dl v23,s[16:19],s32,3072
mf v[196:199],a[252:255],a[72:75],v[196:199]
tr a[246:247],v248,18440
s_add_u32 m0, s5, 0x20000
mf v[200:203],a[252:255],a[76:79],v[200:203]
dl v25,s[24:27],s66,0
mf v[204:207],a[252:255],a[80:83],v[204:207]
tr a[248:249],v249,16384
wl 5
mf v[64:67],a[232:235],a[72:75],v[64:67]
tr a[250:251],v249,18432
mf v[68:71],a[232:235],a[76:79],v[68:71]
dl v26,s[24:27],s66,1024
mf v[72:75],a[232:235],a[80:83],v[72:75]
tr a[252:253],v249,16392
wl 5
mf v[208:211],a[236:239],a[72:75],v[208:211]
tr a[254:255],v249,18440
mf v[212:215],a[236:239],a[76:79],v[212:215]
dl v27,s[24:27],s66,2048
mf v[216:219],a[236:239],a[80:83],v[216:219]
tr a[232:233],v250,16384
s_add_u32 m0, s4, 0x14000
mf v[28:31],a[240:243],a[84:87],v[28:31]
tr a[234:235],v250,18432
wl 5
mf v[32:35],a[240:243],a[88:91],v[32:35]
dl v20,s[16:19],s57,0
mf v[36:39],a[240:243],a[92:95],v[36:39]
tr a[236:237],v250,16392
wl 5
mf v[172:175],a[244:247],a[84:87],v[172:175]
tr a[238:239],v250,18440
mf v[176:179],a[244:247],a[88:91],v[176:179]
dl v21,s[16:19],s57,1024
mf v[180:183],a[244:247],a[92:95],v[180:183]
tr a[240:241],v251,16384
dl v22,s[16:19],s57,2048
mf v[40:43],a[248:251],a[84:87],v[40:43]
tr a[242:243],v251,18432
wl 5
mf v[44:47],a[248:251],a[88:91],v[44:47]
dl v23,s[16:19],s57,3072
mf v[48:51],a[248:251],a[92:95],v[48:51]
tr a[244:245],v251,16392
s_add_u32 m0, s4, 0x0
mf v[184:187],a[252:255],a[84:87],v[184:187]
tr a[246:247],v251,18440
s_add_u32 s32, s98, 0x0
mf v[188:191],a[252:255],a[88:91],v[188:191]
s_waitcnt vmcnt(11)
s_barrier
mf v[192:195],a[252:255],a[92:95],v[192:195]
rq a[96:99],v224,32768
s_and_b32 s32, s32, 0x1ffff
wl 5
mf v[52:55],a[232:235],a[84:87],v[52:55]
rq a[100:103],v224,34816
dn v16,s[8:11],s32,0
mf v[56:59],a[232:235],a[88:91],v[56:59]
rq a[104:107],v224,36864
dn v16,s[8:11],s32,1024
mf v[60:63],a[232:235],a[92:95],v[60:63]
tr a[248:249],v220,0
dn v17,s[8:11],s32,2048
mf v[196:199],a[236:239],a[84:87],v[196:199]
tr a[250:251],v220,2048
dn v17,s[8:11],s32,3072
mf v[200:203],a[236:239],a[88:91],v[200:203]
tr a[252:253],v220,8
s_add_u32 m0, s4, 0x18000
mf v[204:207],a[236:239],a[92:95],v[204:207]
tr a[254:255],v220,2056
s_add_u32 s32, s57, 0x40000
wl 7
mf v[64:67],a[240:243],a[84:87],v[64:67]
rq a[108:111],v225,32768
mf v[68:71],a[240:243],a[88:91],v[68:71]
rq a[112:115],v225,34816
mf v[72:75],a[240:243],a[92:95],v[72:75]
tr a[232:233],v221,0
mf v[208:211],a[244:247],a[84:87],v[208:211]
rq a[116:119],v225,36864
tr a[234:235],v221,2048
mf v[212:215],a[244:247],a[88:91],v[212:215]
tr a[236:237],v221,8
wl 8
mf v[216:219],a[244:247],a[92:95],v[216:219]
tr a[238:239],v221,2056
dl v20,s[16:19],s32,0
mf v[28:31],a[248:251],a[96:99],v[28:31]
tr a[240:241],v222,0
dl v21,s[16:19],s32,1024
mf v[32:35],a[248:251],a[100:103],v[32:35]
tr a[242:243],v222,2048
wl 8
mf v[36:39],a[248:251],a[104:107],v[36:39]
tr a[244:245],v222,8
dl v22,s[16:19],s32,2048
mf v[172:175],a[252:255],a[96:99],v[172:175]
tr a[246:247],v222,2056
mf v[176:179],a[252:255],a[100:103],v[176:179]
dl v23,s[16:19],s32,3072
mf v[180:183],a[252:255],a[104:107],v[180:183]
tr a[248:249],v223,0
s_add_u32 m0, s5, 0x24000
wl 6
mf v[40:43],a[232:235],a[96:99],v[40:43]
tr a[250:251],v223,2048
wl 6
mf v[44:47],a[232:235],a[100:103],v[44:47]
dl v25,s[24:27],s67,0
mf v[48:51],a[232:235],a[104:107],v[48:51]
tr a[252:253],v223,8
wl 5
mf v[184:187],a[236:239],a[96:99],v[184:187]
tr a[254:255],v223,2056
dl v26,s[24:27],s67,1024
mf v[188:191],a[236:239],a[100:103],v[188:191]
s_waitcnt vmcnt(17)
s_barrier
mf v[192:195],a[236:239],a[104:107],v[192:195]
tr a[232:233],v220,16384
dl v27,s[24:27],s67,2048
mf v[52:55],a[240:243],a[96:99],v[52:55]
tr a[234:235],v220,18432
s_add_u32 m0, s4, 0x1c000
mf v[56:59],a[240:243],a[100:103],v[56:59]
dl v20,s[16:19],s58,0
mf v[60:63],a[240:243],a[104:107],v[60:63]
tr a[236:237],v220,16392
wl 5
mf v[196:199],a[244:247],a[96:99],v[196:199]
tr a[238:239],v220,18440
mf v[200:203],a[244:247],a[100:103],v[200:203]
dl v21,s[16:19],s58,1024
mf v[204:207],a[244:247],a[104:107],v[204:207]
tr a[240:241],v221,16384
wl 5
mf v[64:67],a[248:251],a[96:99],v[64:67]
tr a[242:243],v221,18432
mf v[68:71],a[248:251],a[100:103],v[68:71]
dl v22,s[16:19],s58,2048
mf v[72:75],a[248:251],a[104:107],v[72:75]
tr a[244:245],v221,16392
wl 5
mf v[208:211],a[252:255],a[96:99],v[208:211]
tr a[246:247],v221,18440
mf v[212:215],a[252:255],a[100:103],v[212:215]
dl v23,s[16:19],s58,3072
mf v[216:219],a[252:255],a[104:107],v[216:219]
tr a[248:249],v222,16384
s_add_u32 m0, s4, 0x4000
mf v[28:31],a[232:235],a[108:111],v[28:31]
tr a[250:251],v222,18432
s_add_u32 s32, s98, 0x2000
mf v[32:35],a[232:235],a[112:115],v[32:35]
tr a[252:253],v222,16392
s_and_b32 s32, s32, 0x1ffff
mf v[36:39],a[232:235],a[116:119],v[36:39]
dn v16,s[8:11],s32,0
wl 5
mf v[172:175],a[236:239],a[108:111],v[172:175]
tr a[254:255],v222,18440
mf v[176:179],a[236:239],a[112:115],v[176:179]
dn v16,s[8:11],s32,1024
mf v[180:183],a[236:239],a[116:119],v[180:183]
tr a[232:233],v223,16384
wl 5
mf v[40:43],a[240:243],a[108:111],v[40:43]
tr a[234:235],v223,18432
mf v[44:47],a[240:243],a[112:115],v[44:47]
dn v17,s[8:11],s32,2048
mf v[48:51],a[240:243],a[116:119],v[48:51]
tr a[236:237],v223,16392
wl 4
mf v[184:187],a[244:247],a[108:111],v[184:187]
tr a[238:239],v223,18440
mf v[188:191],a[244:247],a[112:115],v[188:191]
s_waitcnt vmcnt(18)
s_barrier
mf v[192:195],a[244:247],a[116:119],v[192:195]
rq a[120:123],v252,32768
wl 5
mf v[52:55],a[248:251],a[108:111],v[52:55]
rq a[124:127],v252,34816
mf v[56:59],a[248:251],a[112:115],v[56:59]
rq a[128:131],v252,36864
mf v[60:63],a[248:251],a[116:119],v[60:63]
tr a[240:241],v220,32768
dn v17,s[8:11],s32,3072
mf v[196:199],a[252:255],a[108:111],v[196:199]
tr a[242:243],v220,34816
wl 6
mf v[200:203],a[252:255],a[112:115],v[200:203]
tr a[244:245],v220,32776
mf v[204:207],a[252:255],a[116:119],v[204:207]
tr a[246:247],v220,34824
wl 7
mf v[64:67],a[232:235],a[108:111],v[64:67]
rq a[132:135],v253,32768
mf v[68:71],a[232:235],a[112:115],v[68:71]
rq a[136:139],v253,34816
mf v[72:75],a[232:235],a[116:119],v[72:75]
tr a[248:249],v221,32768
mf v[208:211],a[236:239],a[108:111],v[208:211]
rq a[140:143],v253,36864
tr a[250:251],v221,34816
mf v[212:215],a[236:239],a[112:115],v[212:215]
tr a[252:253],v221,32776
wl 8
mf v[216:219],a[236:239],a[116:119],v[216:219]
tr a[254:255],v221,34824
mf v[28:31],a[240:243],a[120:123],v[28:31]
tr a[232:233],v222,32768
wl 8
mf v[32:35],a[240:243],a[124:127],v[32:35]
tr a[234:235],v222,34816
mf v[36:39],a[240:243],a[128:131],v[36:39]
tr a[236:237],v222,32776
mf v[172:175],a[244:247],a[120:123],v[172:175]
tr a[238:239],v222,34824
mf v[176:179],a[244:247],a[124:127],v[176:179]
tr a[240:241],v223,32768
wl 7
mf v[180:183],a[244:247],a[128:131],v[180:183]
tr a[242:243],v223,34816
mf v[40:43],a[248:251],a[120:123],v[40:43]
tr a[244:245],v223,32776
wl 7
mf v[44:47],a[248:251],a[124:127],v[44:47]
tr a[246:247],v223,34824
mf v[48:51],a[248:251],a[128:131],v[48:51]
wl 6
mf v[184:187],a[252:255],a[120:123],v[184:187]
mf v[188:191],a[252:255],a[124:127],v[188:191]
s_waitcnt vmcnt(11)
s_barrier
mf v[192:195],a[252:255],a[128:131],v[192:195]
tr a[248:249],v248,0
s_add_u32 m0, s4, 0x10000
mf v[52:55],a[232:235],a[120:123],v[52:55]
tr a[250:251],v248,2048
s_add_u32 s32, s58, 0x40000
mf v[56:59],a[232:235],a[124:127],v[56:59]
dl v20,s[16:19],s32,0
mf v[60:63],a[232:235],a[128:131],v[60:63]
tr a[252:253],v248,8
wl 3
mf v[196:199],a[236:239],a[120:123],v[196:199]
tr a[254:255],v248,2056
mf v[200:203],a[236:239],a[124:127],v[200:203]
dl v21,s[16:19],s32,1024
mf v[204:207],a[236:239],a[128:131],v[204:207]
tr a[232:233],v249,0
mf v[64:67],a[240:243],a[120:123],v[64:67]
tr a[234:235],v249,2048
mf v[68:71],a[240:243],a[124:127],v[68:71]
dl v22,s[16:19],s32,2048
mf v[72:75],a[240:243],a[128:131],v[72:75]
tr a[236:237],v249,8
wl 5
mf v[208:211],a[244:247],a[120:123],v[208:211]
tr a[238:239],v249,2056
mf v[212:215],a[244:247],a[124:127],v[212:215]
dl v23,s[16:19],s32,3072
mf v[216:219],a[244:247],a[128:131],v[216:219]
tr a[240:241],v250,0
s_add_u32 m0, s5, 0x8000
mf v[28:31],a[248:251],a[132:135],v[28:31]
tr a[242:243],v250,2048
wl 5
mf v[32:35],a[248:251],a[136:139],v[32:35]
dl v25,s[24:27],s43,0
mf v[36:39],a[248:251],a[140:143],v[36:39]
tr a[244:245],v250,8
wl 5
mf v[172:175],a[252:255],a[132:135],v[172:175]
tr a[246:247],v250,2056
mf v[176:179],a[252:255],a[136:139],v[176:179]
dl v26,s[24:27],s43,1024
mf v[180:183],a[252:255],a[140:143],v[180:183]
tr a[248:249],v251,0
dl v27,s[24:27],s43,2048
mf v[40:43],a[232:235],a[132:135],v[40:43]
tr a[250:251],v251,2048
s_add_u32 m0, s4, 0xc000
mf v[44:47],a[232:235],a[136:139],v[44:47]
tr a[252:253],v251,8
s_add_u32 s32, s98, 0x0
mf v[48:51],a[232:235],a[140:143],v[48:51]
tr a[254:255],v251,2056
s_and_b32 s32, s32, 0x1ffff
wl 6
mf v[184:187],a[236:239],a[132:135],v[184:187]
dn v18,s[12:15],s32,0
mf v[188:191],a[236:239],a[136:139],v[188:191]
s_waitcnt vmcnt(12)
s_barrier
mf v[192:195],a[236:239],a[140:143],v[192:195]
rq a[144:147],v252,49152
wl 5
mf v[52:55],a[240:243],a[132:135],v[52:55]
rq a[148:151],v252,51200
mf v[56:59],a[240:243],a[136:139],v[56:59]
rq a[152:155],v252,53248
dn v18,s[12:15],s32,1024
mf v[60:63],a[240:243],a[140:143],v[60:63]
tr a[232:233],v248,16384
dn v19,s[12:15],s32,2048
mf v[196:199],a[244:247],a[132:135],v[196:199]
tr a[234:235],v248,18432
dn v19,s[12:15],s32,3072
mf v[200:203],a[244:247],a[136:139],v[200:203]
tr a[236:237],v248,16392
s_add_u32 m0, s4, 0x14000
mf v[204:207],a[244:247],a[140:143],v[204:207]
tr a[238:239],v248,18440
wl 7
mf v[64:67],a[248:251],a[132:135],v[64:67]
rq a[156:159],v253,49152
mf v[68:71],a[248:251],a[136:139],v[68:71]
rq a[160:163],v253,51200
mf v[72:75],a[248:251],a[140:143],v[72:75]
tr a[240:241],v249,16384
mf v[208:211],a[252:255],a[132:135],v[208:211]
rq a[164:167],v253,53248
dl v20,s[16:19],s59,0
mf v[212:215],a[252:255],a[136:139],v[212:215]
tr a[242:243],v249,18432
wl 7
mf v[216:219],a[252:255],a[140:143],v[216:219]
tr a[244:245],v249,16392
dl v21,s[16:19],s59,1024
mf v[28:31],a[232:235],a[144:147],v[28:31]
tr a[246:247],v249,18440
dl v22,s[16:19],s59,2048
mf v[32:35],a[232:235],a[148:151],v[32:35]
tr a[248:249],v250,16384
wl 7
mf v[36:39],a[232:235],a[152:155],v[36:39]
tr a[250:251],v250,18432
dl v23,s[16:19],s59,3072
mf v[172:175],a[236:239],a[144:147],v[172:175]
tr a[252:253],v250,16392
s_add_u32 m0, s4, 0x20000
mf v[176:179],a[236:239],a[148:151],v[176:179]
tr a[254:255],v250,18440
s_add_u32 s32, s59, 0x40000
mf v[180:183],a[236:239],a[152:155],v[180:183]
tr a[232:233],v251,16384
wl 7
mf v[40:43],a[240:243],a[144:147],v[40:43]
tr a[234:235],v251,18432
mf v[44:47],a[240:243],a[148:151],v[44:47]
dl v20,s[16:19],s32,0
mf v[48:51],a[240:243],a[152:155],v[48:51]
tr a[236:237],v251,16392
wl 6
mf v[184:187],a[244:247],a[144:147],v[184:187]
tr a[238:239],v251,18440
wl 6
mf v[188:191],a[244:247],a[148:151],v[188:191]
s_waitcnt vmcnt(12)
s_barrier
mf v[192:195],a[244:247],a[152:155],v[192:195]
tr a[240:241],v220,16384
dl v21,s[16:19],s32,1024
mf v[52:55],a[248:251],a[144:147],v[52:55]
tr a[242:243],v220,18432
dl v22,s[16:19],s32,2048
mf v[56:59],a[248:251],a[148:151],v[56:59]
dl v23,s[16:19],s32,3072
mf v[60:63],a[248:251],a[152:155],v[60:63]
tr a[244:245],v220,16392
s_add_u32 m0, s5, 0x18000
wl 5
mf v[196:199],a[252:255],a[144:147],v[196:199]
tr a[246:247],v220,18440
mf v[200:203],a[252:255],a[148:151],v[200:203]
dl v25,s[24:27],s45,0
mf v[204:207],a[252:255],a[152:155],v[204:207]
tr a[248:249],v221,16384
wl 5
mf v[64:67],a[232:235],a[144:147],v[64:67]
tr a[250:251],v221,18432
mf v[68:71],a[232:235],a[148:151],v[68:71]
dl v26,s[24:27],s45,1024
mf v[72:75],a[232:235],a[152:155],v[72:75]
tr a[252:253],v221,16392
wl 5
mf v[208:211],a[236:239],a[144:147],v[208:211]
tr a[254:255],v221,18440
mf v[212:215],a[236:239],a[148:151],v[212:215]
dl v27,s[24:27],s45,2048
mf v[216:219],a[236:239],a[152:155],v[216:219]
tr a[232:233],v222,16384
wl 5
mf v[28:31],a[240:243],a[156:159],v[28:31]
tr a[234:235],v222,18432
mf v[32:35],a[240:243],a[160:163],v[32:35]
tr a[236:237],v222,16392
mf v[36:39],a[240:243],a[164:167],v[36:39]
tr a[238:239],v222,18440
wl 6
mf v[172:175],a[244:247],a[156:159],v[172:175]
tr a[240:241],v223,16384
mf v[176:179],a[244:247],a[160:163],v[176:179]
tr a[242:243],v223,18432
mf v[180:183],a[244:247],a[164:167],v[180:183]
tr a[244:245],v223,16392
wl 7
mf v[40:43],a[248:251],a[156:159],v[40:43]
tr a[246:247],v223,18440
mf v[44:47],a[248:251],a[160:163],v[44:47]
mf v[48:51],a[248:251],a[164:167],v[48:51]
wl 5
mf v[184:187],a[252:255],a[156:159],v[184:187]
mf v[188:191],a[252:255],a[160:163],v[188:191]
s_waitcnt vmcnt(7)
s_barrier
mf v[192:195],a[252:255],a[164:167],v[192:195]
rq a[168:171],v224,32768
s_add_u32 m0, s4, 0x1c000
mf v[52:55],a[232:235],a[156:159],v[52:55]
rq a[172:175],v224,34816
wl 3
mf v[56:59],a[232:235],a[160:163],v[56:59]
rq a[176:179],v224,36864
mf v[60:63],a[232:235],a[164:167],v[60:63]
tr a[248:249],v220,32768
mf v[196:199],a[236:239],a[156:159],v[196:199]
tr a[250:251],v220,34816
mf v[200:203],a[236:239],a[160:163],v[200:203]
tr a[252:253],v220,32776
mf v[204:207],a[236:239],a[164:167],v[204:207]
tr a[254:255],v220,34824
wl 7
mf v[64:67],a[240:243],a[156:159],v[64:67]
rq a[180:183],v225,32768
mf v[68:71],a[240:243],a[160:163],v[68:71]
rq a[184:187],v225,34816
mf v[72:75],a[240:243],a[164:167],v[72:75]
tr a[232:233],v221,32768
mf v[208:211],a[244:247],a[156:159],v[208:211]
rq a[188:191],v225,36864
dl v20,s[16:19],s60,0
mf v[212:215],a[244:247],a[160:163],v[212:215]
tr a[234:235],v221,34816
wl 7
mf v[216:219],a[244:247],a[164:167],v[216:219]
tr a[236:237],v221,32776
dl v21,s[16:19],s60,1024
mf v[28:31],a[248:251],a[168:171],v[28:31]
tr a[238:239],v221,34824
dl v22,s[16:19],s60,2048
mf v[32:35],a[248:251],a[172:175],v[32:35]
tr a[240:241],v222,32768
wl 7
mf v[36:39],a[248:251],a[176:179],v[36:39]
tr a[242:243],v222,34816
dl v23,s[16:19],s60,3072
mf v[172:175],a[252:255],a[168:171],v[172:175]
tr a[244:245],v222,32776
s_add_u32 m0, s4, 0x24000
mf v[176:179],a[252:255],a[172:175],v[176:179]
tr a[246:247],v222,34824
s_add_u32 s32, s60, 0x40000
mf v[180:183],a[252:255],a[176:179],v[180:183]
tr a[248:249],v223,32768
wl 7
mf v[40:43],a[232:235],a[168:171],v[40:43]
tr a[250:251],v223,34816
mf v[44:47],a[232:235],a[172:175],v[44:47]
dl v20,s[16:19],s32,0
mf v[48:51],a[232:235],a[176:179],v[48:51]
tr a[252:253],v223,32776
wl 6
mf v[184:187],a[236:239],a[168:171],v[184:187]
tr a[254:255],v223,34824
wl 6
mf v[188:191],a[236:239],a[172:175],v[188:191]
s_waitcnt vmcnt(8)
s_barrier
mf v[192:195],a[236:239],a[176:179],v[192:195]
tr a[232:233],v248,32768
dl v21,s[16:19],s32,1024
mf v[52:55],a[240:243],a[168:171],v[52:55]
tr a[234:235],v248,34816
dl v22,s[16:19],s32,2048
mf v[56:59],a[240:243],a[172:175],v[56:59]
dl v23,s[16:19],s32,3072
mf v[60:63],a[240:243],a[176:179],v[60:63]
tr a[236:237],v248,32776
wl 5
mf v[196:199],a[244:247],a[168:171],v[196:199]
tr a[238:239],v248,34824
mf v[200:203],a[244:247],a[172:175],v[200:203]
tr a[240:241],v249,32768
mf v[204:207],a[244:247],a[176:179],v[204:207]
tr a[242:243],v249,34816
wl 6
mf v[64:67],a[248:251],a[168:171],v[64:67]
tr a[244:245],v249,32776
mf v[68:71],a[248:251],a[172:175],v[68:71]
tr a[246:247],v249,34824
mf v[72:75],a[248:251],a[176:179],v[72:75]
tr a[248:249],v250,32768
wl 7
mf v[208:211],a[252:255],a[168:171],v[208:211]
tr a[250:251],v250,34816
mf v[212:215],a[252:255],a[172:175],v[212:215]
mf v[216:219],a[252:255],a[176:179],v[216:219]
tr a[252:253],v250,32776
wl 6
mf v[28:31],a[232:235],a[180:183],v[28:31]
tr a[254:255],v250,34824
mf v[32:35],a[232:235],a[184:187],v[32:35]
mf v[36:39],a[232:235],a[188:191],v[36:39]
tr a[232:233],v251,32768
wl 5
mf v[172:175],a[236:239],a[180:183],v[172:175]
tr a[234:235],v251,34816
mf v[176:179],a[236:239],a[184:187],v[176:179]
mf v[180:183],a[236:239],a[188:191],v[180:183]
tr a[236:237],v251,32776
mf v[40:43],a[240:243],a[180:183],v[40:43]
tr a[238:239],v251,34824
mf v[44:47],a[240:243],a[184:187],v[44:47]
mf v[48:51],a[240:243],a[188:191],v[48:51]
wl 4
mf v[184:187],a[244:247],a[180:183],v[184:187]
mf v[188:191],a[244:247],a[184:187],v[188:191]
s_waitcnt vmcnt(0)
s_barrier
mf v[192:195],a[244:247],a[188:191],v[192:195]
rq a[192:195],v252,0
s_add_u32 m0, s4, 0x8000
mf v[52:55],a[248:251],a[180:183],v[52:55]
rq a[196:199],v252,2048
s_add_u32 s32, s98, 0x4000
mf v[56:59],a[248:251],a[184:187],v[56:59]
rq a[200:203],v252,4096
mf v[60:63],a[248:251],a[188:191],v[60:63]
rq a[204:207],v253,0
rq a[208:211],v253,2048
mf v[196:199],a[252:255],a[180:183],v[196:199]
tr a[240:241],v248,16384
rq a[212:215],v253,4096
mf v[200:203],a[252:255],a[184:187],v[200:203]
tr a[242:243],v248,18432
s_and_b32 s32, s32, 0x1ffff
mf v[204:207],a[252:255],a[188:191],v[204:207]
tr a[244:245],v248,49152
wl 9
mf v[64:67],a[232:235],a[180:183],v[64:67]
tr a[246:247],v248,51200
mf v[68:71],a[232:235],a[184:187],v[68:71]
tr a[248:249],v248,16392
mf v[72:75],a[232:235],a[188:191],v[72:75]
tr a[250:251],v248,18440
mf v[208:211],a[236:239],a[180:183],v[208:211]
tr a[252:253],v248,49160
mf v[212:215],a[236:239],a[184:187],v[212:215]
tr a[254:255],v248,51208
mf v[216:219],a[236:239],a[188:191],v[216:219]
tr a[232:233],v249,16384
wl 7
mf v[28:31],a[240:243],a[192:195],v[28:31]
tr a[234:235],v249,18432
mf v[32:35],a[240:243],a[196:199],v[32:35]
dn v16,s[8:11],s32,0
mf v[36:39],a[240:243],a[200:203],v[36:39]
tr a[236:237],v249,49152
wl 6
mf v[28:31],a[244:247],a[204:207],v[28:31]
tr a[238:239],v249,51200
wl 6
mf v[32:35],a[244:247],a[208:211],v[32:35]
dn v16,s[8:11],s32,1024
mf v[36:39],a[244:247],a[212:215],v[36:39]
tr a[240:241],v249,16392
wl 5
mf v[172:175],a[248:251],a[192:195],v[172:175]
tr a[242:243],v249,18440
mf v[176:179],a[248:251],a[196:199],v[176:179]
dn v17,s[8:11],s32,2048
mf v[180:183],a[248:251],a[200:203],v[180:183]
tr a[244:245],v249,49160
wl 5
mf v[172:175],a[252:255],a[204:207],v[172:175]
tr a[246:247],v249,51208
mf v[176:179],a[252:255],a[208:211],v[176:179]
dn v17,s[8:11],s32,3072
mf v[180:183],a[252:255],a[212:215],v[180:183]
tr a[248:249],v250,16384
s_add_u32 m0, s4, 0x10000
mf v[40:43],a[232:235],a[192:195],v[40:43]
tr a[250:251],v250,18432
s_add_u32 s32, s98, 0x2000
mf v[44:47],a[232:235],a[196:199],v[44:47]
tr a[252:253],v250,49152
s_and_b32 s32, s32, 0x1ffff
mf v[48:51],a[232:235],a[200:203],v[48:51]
tr a[254:255],v250,51200
v_mul_f32 v28, s34, v28
wl 6
mf v[40:43],a[236:239],a[204:207],v[40:43]
dn v18,s[12:15],s32,0
mf v[44:47],a[236:239],a[208:211],v[44:47]
tr a[232:233],v250,16392
v_mul_f32 v32, s34, v32
mf v[48:51],a[236:239],a[212:215],v[48:51]
tr a[234:235],v250,18440
v_mul_f32 v36, s34, v36
mf v[184:187],a[240:243],a[192:195],v[184:187]
tr a[236:237],v250,49160
v_mul_f32 v29, s34, v29
mf v[188:191],a[240:243],a[196:199],v[188:191]
dn v18,s[12:15],s32,1024
mf v[192:195],a[240:243],a[200:203],v[192:195]
tr a[238:239],v250,51208
v_mul_f32 v33, s34, v33
wl 5
mf v[184:187],a[244:247],a[204:207],v[184:187]
tr a[240:241],v251,16384
v_mul_f32 v37, s34, v37
mf v[188:191],a[244:247],a[208:211],v[188:191]
tr a[242:243],v251,18432
v_mul_f32 v30, s34, v30
mf v[192:195],a[244:247],a[212:215],v[192:195]
dn v19,s[12:15],s32,2048
mf v[52:55],a[248:251],a[192:195],v[52:55]
dn v19,s[12:15],s32,3072
mf v[56:59],a[248:251],a[196:199],v[56:59]
tr a[244:245],v251,49152
v_mul_f32 v34, s34, v34
mf v[60:63],a[248:251],a[200:203],v[60:63]
tr a[246:247],v251,51200
v_mul_f32 v38, s34, v38
wl 5
mf v[52:55],a[252:255],a[204:207],v[52:55]
tr a[248:249],v251,16392
v_mul_f32 v31, s34, v31
mf v[56:59],a[252:255],a[208:211],v[56:59]
tr a[250:251],v251,18440
v_mul_f32 v35, s34, v35
mf v[60:63],a[252:255],a[212:215],v[60:63]
tr a[252:253],v251,49160
v_mul_f32 v39, s34, v39
mf v[196:199],a[232:235],a[192:195],v[196:199]
tr a[254:255],v251,51208
v_mul_f32 v172, s34, v172
mf v[200:203],a[232:235],a[196:199],v[200:203]
v_mul_f32 v176, s34, v176
v_mul_f32 v180, s34, v180
mf v[204:207],a[232:235],a[200:203],v[204:207]
v_mul_f32 v173, s34, v173
v_mul_f32 v177, s34, v177
wl 5
mf v[196:199],a[236:239],a[204:207],v[196:199]
v_mul_f32 v181, s34, v181
v_mul_f32 v174, s34, v174
mf v[200:203],a[236:239],a[208:211],v[200:203]
s_barrier
mf v[204:207],a[236:239],a[212:215],v[204:207]
rq a[232:235],v4,0
s_add_u32 m0, s4, 0x18000
mf v[64:67],a[240:243],a[192:195],v[64:67]
rq a[236:239],v5,0
v_mul_f32 v178, s34, v178
mf v[68:71],a[240:243],a[196:199],v[68:71]
s_add_u32 s32, s56, 0x200
v_mul_f32 v182, s34, v182
mf v[72:75],a[240:243],a[200:203],v[72:75]
dl v20,s[16:19],s32,0
wl 2
mf v[64:67],a[244:247],a[204:207],v[64:67]
dl v21,s[16:19],s32,1024
mf v[68:71],a[244:247],a[208:211],v[68:71]
rq a[240:243],v6,0
v_mul_f32 v175, s34, v175
mf v[72:75],a[244:247],a[212:215],v[72:75]
dl v22,s[16:19],s32,2048
mf v[208:211],a[248:251],a[192:195],v[208:211]
rq a[244:247],v7,0
v_mul_f32 v179, s34, v179
mf v[212:215],a[248:251],a[196:199],v[212:215]
v_mul_f32 v183, s34, v183
cv v28,v28,v29
mf v[216:219],a[248:251],a[200:203],v[216:219]
dl v23,s[16:19],s32,3072
mf v[208:211],a[252:255],a[204:207],v[208:211]
rq a[248:251],v4,0
cv v32,v32,v33
mf v[212:215],a[252:255],a[208:211],v[212:215]
cv v36,v36,v37
cv v29,v30,v31
mf v[216:219],a[252:255],a[212:215],v[216:219]
cv v33,v34,v35
cv v37,v38,v39
cv v30,v172,v173
cv v34,v176,v177
cv v38,v180,v181
cv v31,v174,v175
cv v35,v178,v179
cv v39,v182,v183
v_pk_mul_f32 v[40:41], v[40:41], s[34:35]
v_pk_mul_f32 v[44:45], v[44:45], s[34:35]
v_pk_mul_f32 v[48:49], v[48:49], s[34:35]
v_pk_mul_f32 v[52:53], v[52:53], s[34:35]
v_pk_mul_f32 v[56:57], v[56:57], s[34:35]
v_pk_mul_f32 v[60:61], v[60:61], s[34:35]
v_pk_mul_f32 v[64:65], v[64:65], s[34:35]
v_pk_mul_f32 v[68:69], v[68:69], s[34:35]
v_pk_mul_f32 v[72:73], v[72:73], s[34:35]
v_pk_mul_f32 v[42:43], v[42:43], s[34:35]
v_pk_mul_f32 v[46:47], v[46:47], s[34:35]
v_pk_mul_f32 v[50:51], v[50:51], s[34:35]
v_pk_mul_f32 v[54:55], v[54:55], s[34:35]
v_pk_mul_f32 v[58:59], v[58:59], s[34:35]
v_pk_mul_f32 v[62:63], v[62:63], s[34:35]
v_pk_mul_f32 v[66:67], v[66:67], s[34:35]
v_pk_mul_f32 v[70:71], v[70:71], s[34:35]
v_pk_mul_f32 v[74:75], v[74:75], s[34:35]
v_pk_mul_f32 v[184:185], v[184:185], s[34:35]
v_pk_mul_f32 v[188:189], v[188:189], s[34:35]
v_pk_mul_f32 v[192:193], v[192:193], s[34:35]
v_pk_mul_f32 v[196:197], v[196:197], s[34:35]
v_pk_mul_f32 v[200:201], v[200:201], s[34:35]
v_pk_mul_f32 v[204:205], v[204:205], s[34:35]
v_pk_mul_f32 v[208:209], v[208:209], s[34:35]
v_pk_mul_f32 v[212:213], v[212:213], s[34:35]
v_pk_mul_f32 v[216:217], v[216:217], s[34:35]
v_pk_mul_f32 v[186:187], v[186:187], s[34:35]
v_pk_mul_f32 v[190:191], v[190:191], s[34:35]
v_pk_mul_f32 v[194:195], v[194:195], s[34:35]
v_pk_mul_f32 v[198:199], v[198:199], s[34:35]
v_pk_mul_f32 v[202:203], v[202:203], s[34:35]
v_pk_mul_f32 v[206:207], v[206:207], s[34:35]
v_pk_mul_f32 v[210:211], v[210:211], s[34:35]
v_pk_mul_f32 v[214:215], v[214:215], s[34:35]
v_pk_mul_f32 v[218:219], v[218:219], s[34:35]
cv v40,v40,v41
cv v44,v44,v45
cv v48,v48,v49
cv v52,v52,v53
cv v56,v56,v57
cv v60,v60,v61
cv v64,v64,v65
cv v68,v68,v69
cv v72,v72,v73
cv v41,v42,v43
cv v45,v46,v47
cv v49,v50,v51
cv v53,v54,v55
cv v57,v58,v59
cv v61,v62,v63
cv v65,v66,v67
cv v69,v70,v71
cv v73,v74,v75
cv v42,v184,v185
cv v46,v188,v189
cv v50,v192,v193
cv v54,v196,v197
cv v58,v200,v201
cv v62,v204,v205
cv v66,v208,v209
cv v70,v212,v213
cv v74,v216,v217
cv v43,v186,v187
cv v47,v190,v191
cv v51,v194,v195
cv v55,v198,v199
cv v59,v202,v203
cv v63,v206,v207
cv v67,v210,v211
cv v71,v214,v215
cv v75,v218,v219
wl 2
mf v[196:199],a[232:235],v[28:31],0
rq a[252:255],v5,0
s_add_u32 m0, s4, 0x20000
mf v[200:203],a[232:235],v[32:35],0
s_add_u32 s32, s56, 0x40200
mf v[204:207],a[232:235],v[36:39],0
rq a[232:235],v6,0
mf v[196:199],a[236:239],v[40:43],v[196:199]
mf v[200:203],a[236:239],v[44:47],v[200:203]
dl v20,s[16:19],s32,0
mf v[204:207],a[236:239],v[48:51],v[204:207]
rq a[236:239],v7,0
wl 3
mf v[196:199],a[240:243],v[52:55],v[196:199]
dl v21,s[16:19],s32,1024
mf v[200:203],a[240:243],v[56:59],v[200:203]
mf v[204:207],a[240:243],v[60:63],v[204:207]
rq a[240:243],v4,1024
mf v[196:199],a[244:247],v[64:67],v[196:199]
dl v22,s[16:19],s32,2048
mf v[200:203],a[244:247],v[68:71],v[200:203]
mf v[204:207],a[244:247],v[72:75],v[204:207]
s_nop 4
v_max3_f32 v196, v196, v197, v198
s_nop 0
v_max3_f32 v199, v199, v200, v201
v_max3_f32 v202, v202, v203, v204
v_max3_f32 v205, v205, v206, v207
v_max3_f32 v196, v196, v199, v202
v_max_f32 v196, v196, v205
v_mov_b32 v197, v196
s_nop 1
v_permlane16_swap_b32 v196, v197
v_max_f32 v196, v196, v197
v_mov_b32 v197, v196
s_nop 1
v_permlane32_swap_b32 v196, v197
v_max_f32 v196, v196, v197
v_sub_f32 v244, 0, v196
v_sub_f32 v245, 0, v196
v_sub_f32 v246, 0, v196
v_sub_f32 v247, 0, v196
s_nop 1
mf v[172:175],a[248:251],v[28:31],v[244:247]
dl v23,s[16:19],s32,3072
mf v[176:179],a[248:251],v[32:35],v[244:247]
rq a[244:247],v5,1024
wl 2
mf v[180:183],a[248:251],v[36:39],v[244:247]
rq a[248:251],v6,1024
mf v[172:175],a[252:255],v[40:43],v[172:175]
mf v[176:179],a[252:255],v[44:47],v[176:179]
mf v[180:183],a[252:255],v[48:51],v[180:183]
rq a[252:255],v7,1024
mf v[172:175],a[232:235],v[52:55],v[172:175]
mf v[176:179],a[232:235],v[56:59],v[176:179]
mf v[180:183],a[232:235],v[60:63],v[180:183]
wl 2
mf v[172:175],a[236:239],v[64:67],v[172:175]
mf v[176:179],a[236:239],v[68:71],v[176:179]
s_barrier
mf v[180:183],a[236:239],v[72:75],v[180:183]
rq a[232:235],v4,16384
s_add_u32 m0, s4, 0x14000
mf v[184:187],a[240:243],v[28:31],v[244:247]
rq a[236:239],v5,16384
s_add_u32 s32, s98, 0x4000
mf v[188:191],a[240:243],v[32:35],v[244:247]
ex v172
mf v[192:195],a[240:243],v[36:39],v[244:247]
ex v173
mf v[184:187],a[244:247],v[40:43],v[184:187]
ex v174
mf v[188:191],a[244:247],v[44:47],v[188:191]
ex v175
mf v[192:195],a[244:247],v[48:51],v[192:195]
rq a[240:243],v6,16384
cv v220,v172,v173
wl 3
mf v[184:187],a[248:251],v[52:55],v[184:187]
ex v176
mf v[188:191],a[248:251],v[56:59],v[188:191]
ex v177
mf v[192:195],a[248:251],v[60:63],v[192:195]
rq a[244:247],v7,16384
s_and_b32 s32, s32, 0x1ffff
mf v[184:187],a[252:255],v[64:67],v[184:187]
ex v178
mf v[188:191],a[252:255],v[68:71],v[188:191]
ex v179
mf v[192:195],a[252:255],v[72:75],v[192:195]
rq a[248:251],v4,17408
cv v221,v174,v175
wl 3
mf v[196:199],a[232:235],v[28:31],v[244:247]
ex v180
mf v[200:203],a[232:235],v[32:35],v[244:247]
ex v181
mf v[204:207],a[232:235],v[36:39],v[244:247]
rq a[252:255],v5,17408
cv v224,v176,v177
mf v[196:199],a[236:239],v[40:43],v[196:199]
ex v182
mf v[200:203],a[236:239],v[44:47],v[200:203]
ex v183
mf v[204:207],a[236:239],v[48:51],v[204:207]
rq a[232:235],v6,17408
cv v225,v178,v179
wl 3
mf v[196:199],a[240:243],v[52:55],v[196:199]
ex v184
mf v[200:203],a[240:243],v[56:59],v[200:203]
ex v185
mf v[204:207],a[240:243],v[60:63],v[204:207]
rq a[236:239],v7,17408
dn v18,s[12:15],s32,0
mf v[196:199],a[244:247],v[64:67],v[196:199]
ex v186
mf v[200:203],a[244:247],v[68:71],v[200:203]
ex v187
mf v[204:207],a[244:247],v[72:75],v[204:207]
ex v188
wl 2
mf v[208:211],a[248:251],v[28:31],v[244:247]
ex v189
mf v[212:215],a[248:251],v[32:35],v[244:247]
s_barrier
mf v[216:219],a[248:251],v[36:39],v[244:247]
tr a[240:241],v8,0
dn v18,s[12:15],s32,1024
mf v[208:211],a[252:255],v[40:43],v[208:211]
tr a[242:243],v8,1024
dn v19,s[12:15],s32,2048
mf v[212:215],a[252:255],v[44:47],v[212:215]
ex v190
mf v[216:219],a[252:255],v[48:51],v[216:219]
tr a[244:245],v9,0
dn v19,s[12:15],s32,3072
wl 3
mf v[208:211],a[232:235],v[52:55],v[208:211]
tr a[246:247],v9,1024
s_add_u32 m0, s4, 0x0
mf v[212:215],a[232:235],v[56:59],v[212:215]
ex v191
mf v[216:219],a[232:235],v[60:63],v[216:219]
tr a[248:249],v10,0
s_add_u32 s32, s98, 0x6000
mf v[208:211],a[236:239],v[64:67],v[208:211]
tr a[250:251],v10,1024
s_and_b32 s32, s32, 0x1ffff
mf v[212:215],a[236:239],v[68:71],v[212:215]
ex v192
ex v193
ex v194
ex v195
mf v[216:219],a[236:239],v[72:75],v[216:219]
cv v228,v180,v181
cv v229,v182,v183
cv v222,v184,v185
cv v223,v186,v187
cv v226,v188,v189
cv v227,v190,v191
cv v230,v192,v193
cv v231,v194,v195
mf a[216:219],a[228:231],v[220:223],0
tr a[252:253],v11,0
wl 4
mf a[220:223],a[228:231],v[224:227],0
tr a[254:255],v11,1024
mf a[224:227],a[228:231],v[228:231],0
tr a[232:233],v12,0
wl 5
mf v[76:79],a[240:243],v[220:223],0
tr a[234:235],v12,1024
dn v16,s[8:11],s32,0
mf v[80:83],a[240:243],v[224:227],0
ex v196
mf v[84:87],a[240:243],v[228:231],0
tr a[236:237],v13,0
dn v16,s[8:11],s32,1024
mf v[88:91],a[244:247],v[220:223],0
tr a[238:239],v13,1024
wl 6
mf v[92:95],a[244:247],v[224:227],0
ex v197
mf v[96:99],a[244:247],v[228:231],0
tr a[240:241],v14,0
dn v17,s[8:11],s32,2048
mf v[100:103],a[248:251],v[220:223],0
tr a[242:243],v14,1024
dn v17,s[8:11],s32,3072
mf v[104:107],a[248:251],v[224:227],0
ex v198
mf v[108:111],a[248:251],v[228:231],0
tr a[244:245],v15,0
s_add_u32 m0, s4, 0x1c000
wl 5
mf v[112:115],a[252:255],v[220:223],0
tr a[246:247],v15,1024
s_add_u32 s32, s57, 0x200
mf v[116:119],a[252:255],v[224:227],0
s_waitcnt vmcnt(12)
s_barrier
mf v[120:123],a[252:255],v[228:231],0
tr a[248:249],v248,0
dl v20,s[16:19],s32,0
mf v[124:127],a[232:235],v[220:223],0
tr a[250:251],v248,2048
dl v21,s[16:19],s32,1024
mf v[128:131],a[232:235],v[224:227],0
ex v199
mf v[132:135],a[232:235],v[228:231],0
tr a[252:253],v248,8
dl v22,s[16:19],s32,2048
wl 5
mf v[136:139],a[236:239],v[220:223],0
tr a[254:255],v248,2056
dl v23,s[16:19],s32,3072
mf v[140:143],a[236:239],v[224:227],0
ex v200
mf v[144:147],a[236:239],v[228:231],0
tr a[232:233],v249,0
s_add_u32 m0, s5, 0x24000
mf v[148:151],a[240:243],v[220:223],0
tr a[234:235],v249,2048
cv v232,v196,v197
mf v[152:155],a[240:243],v[224:227],0
ex v201
mf v[156:159],a[240:243],v[228:231],0
tr a[236:237],v249,8
cv v233,v198,v199
wl 5
mf v[160:163],a[244:247],v[220:223],0
tr a[238:239],v249,2056
dl v25,s[24:27],s61,0
mf v[164:167],a[244:247],v[224:227],0
ex v202
mf v[168:171],a[244:247],v[228:231],0
s_cmp_lg_u32 s3, 0
s_cbranch_scc1 L_nz
v_mov_b32 v254, 0
v_mov_b32 v255, 0
s_mov_b64 exec, 1
buffer_store_dwordx2 v[254:255], v254, s[28:31], s101 offen sc1
s_mov_b64 exec, -1
L_nz:
mf a[0:3],a[248:251],a[96:99],0
tr a[240:241],v250,0
dl v26,s[24:27],s61,1024
mf a[4:7],a[248:251],a[100:103],0
tr a[242:243],v250,2048
dl v27,s[24:27],s61,2048
mf a[8:11],a[248:251],a[104:107],0
tr a[244:245],v250,8
s_add_u32 m0, s4, 0x4000
wl 5
mf a[12:15],a[252:255],a[96:99],0
tr a[246:247],v250,2056
s_add_u32 s32, s98, 0x8000
mf a[16:19],a[252:255],a[100:103],0
ex v203
mf a[20:23],a[252:255],a[104:107],0
tr a[248:249],v251,0
s_and_b32 s32, s32, 0x1ffff
mf a[24:27],a[232:235],a[96:99],0
tr a[250:251],v251,2048
cv v236,v200,v201
mf a[28:31],a[232:235],a[100:103],0
ex v204
mf a[32:35],a[232:235],a[104:107],0
tr a[252:253],v251,8
cv v237,v202,v203
wl 5
mf a[36:39],a[236:239],a[96:99],0
tr a[254:255],v251,2056
mf a[40:43],a[236:239],a[100:103],0
s_barrier
mf a[44:47],a[236:239],a[104:107],0
rq a[232:235],v4,32768
dn v16,s[8:11],s32,0
mf a[48:51],a[240:243],a[96:99],0
ex v205
mf a[52:55],a[240:243],a[100:103],0
ex v206
mf a[56:59],a[240:243],a[104:107],0
rq a[236:239],v5,32768
dn v16,s[8:11],s32,1024
wl 4
mf a[60:63],a[244:247],a[96:99],0
ex v207
mf a[64:67],a[244:247],a[100:103],0
ex v208
mf a[68:71],a[244:247],a[104:107],0
rq a[240:243],v6,32768
dn v17,s[8:11],s32,2048
mf a[72:75],a[248:251],a[96:99],0
ex v209
mf a[76:79],a[248:251],a[100:103],0
ex v210
mf a[80:83],a[248:251],a[104:107],0
rq a[244:247],v7,32768
dn v17,s[8:11],s32,3072
wl 3
mf a[84:87],a[252:255],a[96:99],0
ex v211
mf a[88:91],a[252:255],a[100:103],0
ex v212
mf a[92:95],a[252:255],a[104:107],0
rq a[248:251],v4,33792
s_add_u32 m0, s4, 0xc000
mf v[172:175],a[232:235],v[28:31],v[244:247]
ex v213
mf v[176:179],a[232:235],v[32:35],v[244:247]
ex v214
mf v[180:183],a[232:235],v[36:39],v[244:247]
rq a[252:255],v5,33792
s_add_u32 s32, s98, 0x6000
wl 3
mf v[172:175],a[236:239],v[40:43],v[172:175]
ex v215
mf v[176:179],a[236:239],v[44:47],v[176:179]
ex v216
mf v[180:183],a[236:239],v[48:51],v[180:183]
rq a[232:235],v6,33792
s_and_b32 s32, s32, 0x1ffff
mf v[172:175],a[240:243],v[52:55],v[172:175]
ex v217
mf v[176:179],a[240:243],v[56:59],v[176:179]
ex v218
mf v[180:183],a[240:243],v[60:63],v[180:183]
rq a[236:239],v7,33792
dn v18,s[12:15],s32,0
wl 3
mf v[172:175],a[244:247],v[64:67],v[172:175]
ex v219
mf v[176:179],a[244:247],v[68:71],v[176:179]
dn v18,s[12:15],s32,1024
mf v[180:183],a[244:247],v[72:75],v[180:183]
dn v19,s[12:15],s32,2048
mf v[184:187],a[248:251],v[28:31],v[244:247]
dn v19,s[12:15],s32,3072
mf v[188:191],a[248:251],v[32:35],v[244:247]
s_barrier
mf v[192:195],a[248:251],v[36:39],v[244:247]
tr a[240:241],v8,16384
s_add_u32 m0, s4, 0x18000
wl 2
mf v[184:187],a[252:255],v[40:43],v[184:187]
tr a[242:243],v8,17408
cv v240,v204,v205
mf v[188:191],a[252:255],v[44:47],v[188:191]
ex v172
mf v[192:195],a[252:255],v[48:51],v[192:195]
tr a[244:245],v9,16384
s_add_u32 s32, s57, 0x40200
mf v[184:187],a[232:235],v[52:55],v[184:187]
tr a[246:247],v9,17408
cv v241,v206,v207
mf v[188:191],a[232:235],v[56:59],v[188:191]
ex v173
mf v[192:195],a[232:235],v[60:63],v[192:195]
tr a[248:249],v10,16384
cv v234,v208,v209
wl 5
mf v[184:187],a[236:239],v[64:67],v[184:187]
tr a[250:251],v10,17408
cv v235,v210,v211
mf v[188:191],a[236:239],v[68:71],v[188:191]
ex v174
mf v[192:195],a[236:239],v[72:75],v[192:195]
cv v238,v212,v213
cv v239,v214,v215
cv v242,v216,v217
cv v243,v218,v219
mf a[216:219],a[228:231],v[232:235],a[216:219]
tr a[252:253],v11,16384
cv v220,v172,v173
mf a[220:223],a[228:231],v[236:239],a[220:223]
tr a[254:255],v11,17408
wl 4
mf a[224:227],a[228:231],v[240:243],a[224:227]
tr a[232:233],v12,16384
mf v[76:79],a[240:243],v[232:235],v[76:79]
tr a[234:235],v12,17408
mf v[80:83],a[240:243],v[236:239],v[80:83]
ex v175
mf v[84:87],a[240:243],v[240:243],v[84:87]
tr a[236:237],v13,16384
dl v20,s[16:19],s32,0
mf v[88:91],a[244:247],v[232:235],v[88:91]
tr a[238:239],v13,17408
cv v221,v174,v175
mf v[92:95],a[244:247],v[236:239],v[92:95]
ex v176
mf v[96:99],a[244:247],v[240:243],v[96:99]
tr a[240:241],v14,16384
dl v21,s[16:19],s32,1024
wl 5
mf v[100:103],a[248:251],v[232:235],v[100:103]
tr a[242:243],v14,17408
mf v[104:107],a[248:251],v[236:239],v[104:107]
ex v177
mf v[108:111],a[248:251],v[240:243],v[108:111]
tr a[244:245],v15,16384
cv v224,v176,v177
mf v[112:115],a[252:255],v[232:235],v[112:115]
tr a[246:247],v15,17408
dl v22,s[16:19],s32,2048
mf v[116:119],a[252:255],v[236:239],v[116:119]
s_waitcnt vmcnt(26)
s_barrier
mf v[120:123],a[252:255],v[240:243],v[120:123]
tr a[248:249],v248,32768
wl 5
mf v[124:127],a[232:235],v[232:235],v[124:127]
tr a[250:251],v248,34816
dl v23,s[16:19],s32,3072
mf v[128:131],a[232:235],v[236:239],v[128:131]
ex v178
mf v[132:135],a[232:235],v[240:243],v[132:135]
tr a[252:253],v248,32776
s_add_u32 m0, s4, 0x8000
mf v[136:139],a[236:239],v[232:235],v[136:139]
tr a[254:255],v248,34824
s_add_u32 s32, s98, 0xa000
mf v[140:143],a[236:239],v[236:239],v[140:143]
ex v179
mf v[144:147],a[236:239],v[240:243],v[144:147]
tr a[232:233],v249,32768
s_and_b32 s32, s32, 0x1ffff
wl 5
mf v[148:151],a[240:243],v[232:235],v[148:151]
tr a[234:235],v249,34816
cv v225,v178,v179
mf v[152:155],a[240:243],v[236:239],v[152:155]
ex v180
mf v[156:159],a[240:243],v[240:243],v[156:159]
tr a[236:237],v249,32776
wl 5
mf v[160:163],a[244:247],v[232:235],v[160:163]
tr a[238:239],v249,34824
mf v[164:167],a[244:247],v[236:239],v[164:167]
ex v181
mf v[168:171],a[244:247],v[240:243],v[168:171]
tr a[240:241],v250,32768
cv v228,v180,v181
mf a[0:3],a[248:251],a[108:111],a[0:3]
tr a[242:243],v250,34816
wl 5
mf a[4:7],a[248:251],a[112:115],a[4:7]
ex v182
mf a[8:11],a[248:251],a[116:119],a[8:11]
tr a[244:245],v250,32776
wl 5
mf a[12:15],a[252:255],a[108:111],a[12:15]
tr a[246:247],v250,34824
mf a[16:19],a[252:255],a[112:115],a[16:19]
ex v183
mf a[20:23],a[252:255],a[116:119],a[20:23]
tr a[248:249],v251,32768
dn v16,s[8:11],s32,0
mf a[24:27],a[232:235],a[108:111],a[24:27]
tr a[250:251],v251,34816
cv v229,v182,v183
mf a[28:31],a[232:235],a[112:115],a[28:31]
ex v184
mf a[32:35],a[232:235],a[116:119],a[32:35]
tr a[252:253],v251,32776
wl 5
mf a[36:39],a[236:239],a[108:111],a[36:39]
tr a[254:255],v251,34824
dn v16,s[8:11],s32,1024
mf a[40:43],a[236:239],a[112:115],a[40:43]
s_waitcnt vmcnt(21)
s_barrier
mf a[44:47],a[236:239],a[116:119],a[44:47]
rq a[232:235],v4,0
wl 5
mf a[48:51],a[240:243],a[108:111],a[48:51]
ex v185
mf a[52:55],a[240:243],a[112:115],a[52:55]
ex v186
mf a[56:59],a[240:243],a[116:119],a[56:59]
rq a[236:239],v5,0
dn v17,s[8:11],s32,2048
mf a[60:63],a[244:247],a[108:111],a[60:63]
ex v187
mf a[64:67],a[244:247],a[112:115],a[64:67]
ex v188
mf a[68:71],a[244:247],a[116:119],a[68:71]
rq a[240:243],v6,0
dn v17,s[8:11],s32,3072
wl 3
mf a[72:75],a[248:251],a[108:111],a[72:75]
ex v189
mf a[76:79],a[248:251],a[112:115],a[76:79]
ex v190
mf a[80:83],a[248:251],a[116:119],a[80:83]
rq a[244:247],v7,0
s_add_u32 m0, s4, 0x10000
mf a[84:87],a[252:255],a[108:111],a[84:87]
ex v191
mf a[88:91],a[252:255],a[112:115],a[88:91]
ex v192
mf a[92:95],a[252:255],a[116:119],a[92:95]
rq a[248:251],v4,1024
s_add_u32 s32, s98, 0x8000
wl 3
mf v[196:199],a[232:235],v[28:31],v[244:247]
ex v193
mf v[200:203],a[232:235],v[32:35],v[244:247]
ex v194
mf v[204:207],a[232:235],v[36:39],v[244:247]
rq a[252:255],v5,1024
s_and_b32 s32, s32, 0x1ffff
mf v[196:199],a[236:239],v[40:43],v[196:199]
ex v195
mf v[200:203],a[236:239],v[44:47],v[200:203]
dn v18,s[12:15],s32,0
mf v[204:207],a[236:239],v[48:51],v[204:207]
rq a[232:235],v6,1024
cv v222,v184,v185
wl 3
mf v[196:199],a[240:243],v[52:55],v[196:199]
dn v18,s[12:15],s32,1024
mf v[200:203],a[240:243],v[56:59],v[200:203]
dn v19,s[12:15],s32,2048
mf v[204:207],a[240:243],v[60:63],v[204:207]
rq a[236:239],v7,1024
cv v223,v186,v187
mf v[196:199],a[244:247],v[64:67],v[196:199]
dn v19,s[12:15],s32,3072
mf v[200:203],a[244:247],v[68:71],v[200:203]
cv v226,v188,v189
cv v227,v190,v191
mf v[204:207],a[244:247],v[72:75],v[204:207]
cv v230,v192,v193
cv v231,v194,v195
wl 2
mf v[208:211],a[248:251],v[28:31],v[244:247]
mf v[212:215],a[248:251],v[32:35],v[244:247]
s_barrier
mf v[216:219],a[248:251],v[36:39],v[244:247]
tr a[240:241],v8,32768
s_add_u32 m0, s4, 0x20000
mf v[208:211],a[252:255],v[40:43],v[208:211]
tr a[242:243],v8,33792
s_add_u32 s32, s58, 0x200
mf v[212:215],a[252:255],v[44:47],v[212:215]
ex v196
mf v[216:219],a[252:255],v[48:51],v[216:219]
tr a[244:245],v9,32768
wl 3
mf v[208:211],a[232:235],v[52:55],v[208:211]
tr a[246:247],v9,33792
mf v[212:215],a[232:235],v[56:59],v[212:215]
ex v197
mf v[216:219],a[232:235],v[60:63],v[216:219]
tr a[248:249],v10,32768
cv v232,v196,v197
mf v[208:211],a[236:239],v[64:67],v[208:211]
tr a[250:251],v10,33792
mf v[212:215],a[236:239],v[68:71],v[212:215]
ex v198
mf v[216:219],a[236:239],v[72:75],v[216:219]
tr a[252:253],v11,32768
wl 5
mf a[216:219],a[228:231],v[220:223],a[216:219]
tr a[254:255],v11,33792
mf a[220:223],a[228:231],v[224:227],a[220:223]
ex v199
mf a[224:227],a[228:231],v[228:231],a[224:227]
tr a[232:233],v12,32768
cv v233,v198,v199
mf v[76:79],a[240:243],v[220:223],v[76:79]
tr a[234:235],v12,33792
wl 5
mf v[80:83],a[240:243],v[224:227],v[80:83]
ex v200
mf v[84:87],a[240:243],v[228:231],v[84:87]
tr a[236:237],v13,32768
dl v20,s[16:19],s32,0
mf v[88:91],a[244:247],v[220:223],v[88:91]
tr a[238:239],v13,33792
wl 5
mf v[92:95],a[244:247],v[224:227],v[92:95]
ex v201
mf v[96:99],a[244:247],v[228:231],v[96:99]
tr a[240:241],v14,32768
dl v21,s[16:19],s32,1024
mf v[100:103],a[248:251],v[220:223],v[100:103]
tr a[242:243],v14,33792
cv v236,v200,v201
mf v[104:107],a[248:251],v[224:227],v[104:107]
ex v202
mf v[108:111],a[248:251],v[228:231],v[108:111]
tr a[244:245],v15,32768
wl 5
mf v[112:115],a[252:255],v[220:223],v[112:115]
tr a[246:247],v15,33792
dl v22,s[16:19],s32,2048
mf v[116:119],a[252:255],v[224:227],v[116:119]
s_waitcnt vmcnt(26)
s_barrier
mf v[120:123],a[252:255],v[228:231],v[120:123]
tr a[248:249],v248,16384
wl 5
mf v[124:127],a[232:235],v[220:223],v[124:127]
tr a[250:251],v248,18432
dl v23,s[16:19],s32,3072
mf v[128:131],a[232:235],v[224:227],v[128:131]
ex v203
mf v[132:135],a[232:235],v[228:231],v[132:135]
tr a[252:253],v248,16392
s_add_u32 m0, s4, 0x0
mf v[136:139],a[236:239],v[220:223],v[136:139]
tr a[254:255],v248,18440
s_add_u32 s32, s98, 0xc000
mf v[140:143],a[236:239],v[224:227],v[140:143]
ex v204
mf v[144:147],a[236:239],v[228:231],v[144:147]
tr a[232:233],v249,16384
s_and_b32 s32, s32, 0x1ffff
wl 5
mf v[148:151],a[240:243],v[220:223],v[148:151]
tr a[234:235],v249,18432
cv v237,v202,v203
mf v[152:155],a[240:243],v[224:227],v[152:155]
ex v205
mf v[156:159],a[240:243],v[228:231],v[156:159]
tr a[236:237],v249,16392
cv v240,v204,v205
mf v[160:163],a[244:247],v[220:223],v[160:163]
tr a[238:239],v249,18440
wl 5
mf v[164:167],a[244:247],v[224:227],v[164:167]
ex v206
mf v[168:171],a[244:247],v[228:231],v[168:171]
tr a[240:241],v250,16384
wl 5
mf a[0:3],a[248:251],a[120:123],a[0:3]
tr a[242:243],v250,18432
mf a[4:7],a[248:251],a[124:127],a[4:7]
ex v207
mf a[8:11],a[248:251],a[128:131],a[8:11]
tr a[244:245],v250,16392
cv v241,v206,v207
mf a[12:15],a[252:255],a[120:123],a[12:15]
tr a[246:247],v250,18440
wl 5
mf a[16:19],a[252:255],a[124:127],a[16:19]
ex v208
mf a[20:23],a[252:255],a[128:131],a[20:23]
tr a[248:249],v251,16384
dn v16,s[8:11],s32,0
mf a[24:27],a[232:235],a[120:123],a[24:27]
tr a[250:251],v251,18432
wl 5
mf a[28:31],a[232:235],a[124:127],a[28:31]
ex v209
mf a[32:35],a[232:235],a[128:131],a[32:35]
tr a[252:253],v251,16392
cv v234,v208,v209
mf a[36:39],a[236:239],a[120:123],a[36:39]
tr a[254:255],v251,18440
dn v16,s[8:11],s32,1024
mf a[40:43],a[236:239],a[124:127],a[40:43]
s_waitcnt vmcnt(22)
s_barrier
mf a[44:47],a[236:239],a[128:131],a[44:47]
rq a[232:235],v4,16384
wl 5
mf a[48:51],a[240:243],a[120:123],a[48:51]
ex v210
mf a[52:55],a[240:243],a[124:127],a[52:55]
ex v211
mf a[56:59],a[240:243],a[128:131],a[56:59]
rq a[96:99],v252,49152
dn v17,s[8:11],s32,2048
mf a[60:63],a[244:247],a[120:123],a[60:63]
rq a[236:239],v5,16384
dn v17,s[8:11],s32,3072
mf a[64:67],a[244:247],a[124:127],a[64:67]
rq a[100:103],v252,51200
s_add_u32 m0, s4, 0x14000
mf a[68:71],a[244:247],a[128:131],a[68:71]
rq a[104:107],v252,53248
s_add_u32 s32, s98, 0xa000
wl 5
mf a[72:75],a[248:251],a[120:123],a[72:75]
rq a[108:111],v253,49152
s_and_b32 s32, s32, 0x1ffff
mf a[76:79],a[248:251],a[124:127],a[76:79]
rq a[112:115],v253,51200
cv v235,v210,v211
mf a[80:83],a[248:251],a[128:131],a[80:83]
rq a[240:243],v6,16384
wl 7
mf a[84:87],a[252:255],a[120:123],a[84:87]
rq a[116:119],v253,53248
mf a[88:91],a[252:255],a[124:127],a[88:91]
rq a[244:247],v7,16384
mf a[92:95],a[252:255],a[128:131],a[92:95]
rq a[248:251],v4,17408
wl 7
mf v[172:175],a[232:235],v[28:31],v[244:247]
ex v212
mf v[176:179],a[232:235],v[32:35],v[244:247]
ex v213
mf v[180:183],a[232:235],v[36:39],v[244:247]
rq a[252:255],v5,17408
cv v238,v212,v213
mf v[172:175],a[236:239],v[40:43],v[172:175]
ex v214
mf v[176:179],a[236:239],v[44:47],v[176:179]
ex v215
mf v[180:183],a[236:239],v[48:51],v[180:183]
rq a[232:235],v6,17408
cv v239,v214,v215
wl 3
mf v[172:175],a[240:243],v[52:55],v[172:175]
ex v216
mf v[176:179],a[240:243],v[56:59],v[176:179]
ex v217
mf v[180:183],a[240:243],v[60:63],v[180:183]
rq a[236:239],v7,17408
dn v18,s[12:15],s32,0
mf v[172:175],a[244:247],v[64:67],v[172:175]
ex v218
mf v[176:179],a[244:247],v[68:71],v[176:179]
ex v219
mf v[180:183],a[244:247],v[72:75],v[180:183]
dn v18,s[12:15],s32,1024
wl 2
mf v[184:187],a[248:251],v[28:31],v[244:247]
dn v19,s[12:15],s32,2048
mf v[188:191],a[248:251],v[32:35],v[244:247]
s_waitcnt vmcnt(23)
s_barrier
mf v[192:195],a[248:251],v[36:39],v[244:247]
tr a[240:241],v8,0
cv v242,v216,v217
mf v[184:187],a[252:255],v[40:43],v[184:187]
tr a[242:243],v8,1024
dn v19,s[12:15],s32,3072
mf v[188:191],a[252:255],v[44:47],v[188:191]
ex v172
mf v[192:195],a[252:255],v[48:51],v[192:195]
tr a[244:245],v9,0
s_add_u32 m0, s5, 0x1c000
wl 3
mf v[184:187],a[232:235],v[52:55],v[184:187]
tr a[246:247],v9,1024
cv v243,v218,v219
mf v[188:191],a[232:235],v[56:59],v[188:191]
ex v173
mf v[192:195],a[232:235],v[60:63],v[192:195]
tr a[248:249],v10,0
cv v220,v172,v173
mf v[184:187],a[236:239],v[64:67],v[184:187]
tr a[250:251],v10,1024
mf v[188:191],a[236:239],v[68:71],v[188:191]
ex v174
mf v[192:195],a[236:239],v[72:75],v[192:195]
tr a[252:253],v11,0
wl 5
mf a[216:219],a[228:231],v[232:235],a[216:219]
tr a[254:255],v11,1024
mf a[220:223],a[228:231],v[236:239],a[220:223]
ex v175
mf a[224:227],a[228:231],v[240:243],a[224:227]
tr a[232:233],v12,0
dl v25,s[24:27],s62,0
mf v[76:79],a[240:243],v[232:235],v[76:79]
tr a[234:235],v12,1024
cv v221,v174,v175
mf v[80:83],a[240:243],v[236:239],v[80:83]
ex v176
mf v[84:87],a[240:243],v[240:243],v[84:87]
tr a[236:237],v13,0
dl v26,s[24:27],s62,1024
wl 5
mf v[88:91],a[244:247],v[232:235],v[88:91]
tr a[238:239],v13,1024
mf v[92:95],a[244:247],v[236:239],v[92:95]
ex v177
mf v[96:99],a[244:247],v[240:243],v[96:99]
tr a[240:241],v14,0
dl v27,s[24:27],s62,2048
mf v[100:103],a[248:251],v[232:235],v[100:103]
tr a[242:243],v14,1024
cv v224,v176,v177
mf v[104:107],a[248:251],v[236:239],v[104:107]
ex v178
mf v[108:111],a[248:251],v[240:243],v[108:111]
tr a[244:245],v15,0
wl 5
mf v[112:115],a[252:255],v[232:235],v[112:115]
tr a[246:247],v15,1024
mf v[116:119],a[252:255],v[236:239],v[116:119]
s_waitcnt vmcnt(23)
s_barrier
mf v[120:123],a[252:255],v[240:243],v[120:123]
tr a[248:249],v248,0
s_add_u32 m0, s4, 0x4000
mf v[124:127],a[232:235],v[232:235],v[124:127]
tr a[250:251],v248,2048
s_add_u32 s32, s98, 0xe000
mf v[128:131],a[232:235],v[236:239],v[128:131]
ex v179
mf v[132:135],a[232:235],v[240:243],v[132:135]
tr a[252:253],v248,8
cv v225,v178,v179
wl 5
mf v[136:139],a[236:239],v[232:235],v[136:139]
tr a[254:255],v248,2056
s_and_b32 s32, s32, 0x1ffff
mf v[140:143],a[236:239],v[236:239],v[140:143]
ex v180
mf v[144:147],a[236:239],v[240:243],v[144:147]
tr a[232:233],v249,0
wl 5
mf v[148:151],a[240:243],v[232:235],v[148:151]
tr a[234:235],v249,2048
mf v[152:155],a[240:243],v[236:239],v[152:155]
ex v181
mf v[156:159],a[240:243],v[240:243],v[156:159]
tr a[236:237],v249,8
cv v228,v180,v181
mf v[160:163],a[244:247],v[232:235],v[160:163]
tr a[238:239],v249,2056
wl 5
mf v[164:167],a[244:247],v[236:239],v[164:167]
ex v182
mf v[168:171],a[244:247],v[240:243],v[168:171]
tr a[240:241],v250,0
wl 5
mf a[0:3],a[248:251],a[132:135],a[0:3]
tr a[242:243],v250,2048
mf a[4:7],a[248:251],a[136:139],a[4:7]
ex v183
mf a[8:11],a[248:251],a[140:143],a[8:11]
tr a[244:245],v250,8
cv v229,v182,v183
mf a[12:15],a[252:255],a[132:135],a[12:15]
tr a[246:247],v250,2056
wl 5
mf a[16:19],a[252:255],a[136:139],a[16:19]
ex v184
mf a[20:23],a[252:255],a[140:143],a[20:23]
tr a[248:249],v251,0
dn v16,s[8:11],s32,0
mf a[24:27],a[232:235],a[132:135],a[24:27]
tr a[250:251],v251,2048
wl 5
mf a[28:31],a[232:235],a[136:139],a[28:31]
ex v185
mf a[32:35],a[232:235],a[140:143],a[32:35]
tr a[252:253],v251,8
cv v222,v184,v185
mf a[36:39],a[236:239],a[132:135],a[36:39]
tr a[254:255],v251,2056
dn v16,s[8:11],s32,1024
mf a[40:43],a[236:239],a[136:139],a[40:43]
s_waitcnt vmcnt(21)
s_barrier
mf a[44:47],a[236:239],a[140:143],a[44:47]
rq a[232:235],v4,32768
wl 5
mf a[48:51],a[240:243],a[132:135],a[48:51]
ex v186
mf a[52:55],a[240:243],a[136:139],a[52:55]
ex v187
mf a[56:59],a[240:243],a[140:143],a[56:59]
rq a[236:239],v5,32768
dn v17,s[8:11],s32,2048
mf a[60:63],a[244:247],a[132:135],a[60:63]
ex v188
mf a[64:67],a[244:247],a[136:139],a[64:67]
ex v189
mf a[68:71],a[244:247],a[140:143],a[68:71]
rq a[240:243],v6,32768
dn v17,s[8:11],s32,3072
wl 3
mf a[72:75],a[248:251],a[132:135],a[72:75]
ex v190
mf a[76:79],a[248:251],a[136:139],a[76:79]
ex v191
mf a[80:83],a[248:251],a[140:143],a[80:83]
rq a[244:247],v7,32768
s_add_u32 m0, s4, 0x24000
mf a[84:87],a[252:255],a[132:135],a[84:87]
ex v192
mf a[88:91],a[252:255],a[136:139],a[88:91]
ex v193
mf a[92:95],a[252:255],a[140:143],a[92:95]
rq a[248:251],v4,33792
s_add_u32 s32, s58, 0x40200
wl 3
mf v[196:199],a[232:235],v[28:31],v[244:247]
ex v194
mf v[200:203],a[232:235],v[32:35],v[244:247]
ex v195
mf v[204:207],a[232:235],v[36:39],v[244:247]
rq a[252:255],v5,33792
dl v20,s[16:19],s32,0
mf v[196:199],a[236:239],v[40:43],v[196:199]
dl v21,s[16:19],s32,1024
mf v[200:203],a[236:239],v[44:47],v[200:203]
dl v22,s[16:19],s32,2048
mf v[204:207],a[236:239],v[48:51],v[204:207]
rq a[232:235],v6,33792
dl v23,s[16:19],s32,3072
wl 3
mf v[196:199],a[240:243],v[52:55],v[196:199]
rq a[236:239],v7,33792
s_add_u32 m0, s4, 0xc000
mf v[200:203],a[240:243],v[56:59],v[200:203]
s_add_u32 s32, s98, 0xc000
s_and_b32 s32, s32, 0x1ffff
mf v[204:207],a[240:243],v[60:63],v[204:207]
dn v18,s[12:15],s32,0
mf v[196:199],a[244:247],v[64:67],v[196:199]
dn v18,s[12:15],s32,1024
mf v[200:203],a[244:247],v[68:71],v[200:203]
dn v19,s[12:15],s32,2048
mf v[204:207],a[244:247],v[72:75],v[204:207]
dn v19,s[12:15],s32,3072
wl 2
mf v[208:211],a[248:251],v[28:31],v[244:247]
cv v223,v186,v187
cv v226,v188,v189
mf v[212:215],a[248:251],v[32:35],v[244:247]
s_waitcnt vmcnt(27)
s_barrier
mf v[216:219],a[248:251],v[36:39],v[244:247]
tr a[240:241],v8,16384
s_add_u32 m0, s4, 0x18000
mf v[208:211],a[252:255],v[40:43],v[208:211]
tr a[242:243],v8,17408
cv v227,v190,v191
mf v[212:215],a[252:255],v[44:47],v[212:215]
ex v196
mf v[216:219],a[252:255],v[48:51],v[216:219]
tr a[244:245],v9,16384
s_add_u32 s32, s59, 0x200
wl 3
mf v[208:211],a[232:235],v[52:55],v[208:211]
tr a[246:247],v9,17408
cv v230,v192,v193
mf v[212:215],a[232:235],v[56:59],v[212:215]
ex v197
mf v[216:219],a[232:235],v[60:63],v[216:219]
tr a[248:249],v10,16384
cv v231,v194,v195
mf v[208:211],a[236:239],v[64:67],v[208:211]
tr a[250:251],v10,17408
cv v232,v196,v197
mf v[212:215],a[236:239],v[68:71],v[212:215]
ex v198
mf v[216:219],a[236:239],v[72:75],v[216:219]
tr a[252:253],v11,16384
wl 5
mf a[216:219],a[228:231],v[220:223],a[216:219]
tr a[254:255],v11,17408
mf a[220:223],a[228:231],v[224:227],a[220:223]
ex v199
mf a[224:227],a[228:231],v[228:231],a[224:227]
tr a[232:233],v12,16384
cv v233,v198,v199
mf v[76:79],a[240:243],v[220:223],v[76:79]
tr a[234:235],v12,17408
wl 5
mf v[80:83],a[240:243],v[224:227],v[80:83]
ex v200
mf v[84:87],a[240:243],v[228:231],v[84:87]
tr a[236:237],v13,16384
dl v20,s[16:19],s32,0
mf v[88:91],a[244:247],v[220:223],v[88:91]
tr a[238:239],v13,17408
wl 5
mf v[92:95],a[244:247],v[224:227],v[92:95]
ex v201
mf v[96:99],a[244:247],v[228:231],v[96:99]
tr a[240:241],v14,16384
dl v21,s[16:19],s32,1024
mf v[100:103],a[248:251],v[220:223],v[100:103]
tr a[242:243],v14,17408
cv v236,v200,v201
mf v[104:107],a[248:251],v[224:227],v[104:107]
ex v202
mf v[108:111],a[248:251],v[228:231],v[108:111]
tr a[244:245],v15,16384
wl 5
mf v[112:115],a[252:255],v[220:223],v[112:115]
tr a[246:247],v15,17408
dl v22,s[16:19],s32,2048
mf v[116:119],a[252:255],v[224:227],v[116:119]
s_waitcnt vmcnt(26)
s_barrier
mf v[120:123],a[252:255],v[228:231],v[120:123]
tr a[248:249],v248,32768
wl 5
mf v[124:127],a[232:235],v[220:223],v[124:127]
tr a[250:251],v248,34816
dl v23,s[16:19],s32,3072
mf v[128:131],a[232:235],v[224:227],v[128:131]
ex v203
mf v[132:135],a[232:235],v[228:231],v[132:135]
tr a[252:253],v248,32776
s_add_u32 m0, s4, 0x8000
mf v[136:139],a[236:239],v[220:223],v[136:139]
tr a[254:255],v248,34824
s_add_u32 s32, s98, 0x10000
mf v[140:143],a[236:239],v[224:227],v[140:143]
ex v204
mf v[144:147],a[236:239],v[228:231],v[144:147]
tr a[232:233],v249,32768
s_and_b32 s32, s32, 0x1ffff
wl 5
mf v[148:151],a[240:243],v[220:223],v[148:151]
tr a[234:235],v249,34816
cv v237,v202,v203
mf v[152:155],a[240:243],v[224:227],v[152:155]
ex v205
mf v[156:159],a[240:243],v[228:231],v[156:159]
tr a[236:237],v249,32776
cv v240,v204,v205
mf v[160:163],a[244:247],v[220:223],v[160:163]
tr a[238:239],v249,34824
wl 5
mf v[164:167],a[244:247],v[224:227],v[164:167]
ex v206
mf v[168:171],a[244:247],v[228:231],v[168:171]
s_cmp_lg_u32 s100, 0
s_cbranch_scc1 L_hs4
s_mov_b32 s48, s70
s_and_b32 s49, s71, 0xffff
s_mov_b32 s50, 256
s_mov_b32 s51, 0x20000
s_lshl_b32 s36, s40, 3
v_mov_b32 v254, 0
v_mov_b32 v255, 1
s_mov_b64 exec, 1
buffer_atomic_add v255, v254, s[48:51], s36 offen sc1
s_mov_b64 exec, -1
L_hs4:
mf a[0:3],a[248:251],a[144:147],a[0:3]
tr a[240:241],v250,32768
wl 4
mf a[4:7],a[248:251],a[148:151],a[4:7]
tr a[242:243],v250,34816
mf a[8:11],a[248:251],a[152:155],a[8:11]
tr a[244:245],v250,32776
wl 5
mf a[12:15],a[252:255],a[144:147],a[12:15]
tr a[246:247],v250,34824
mf a[16:19],a[252:255],a[148:151],a[16:19]
ex v207
mf a[20:23],a[252:255],a[152:155],a[20:23]
tr a[248:249],v251,32768
dn v16,s[8:11],s32,0
mf a[24:27],a[232:235],a[144:147],a[24:27]
tr a[250:251],v251,34816
cv v241,v206,v207
mf a[28:31],a[232:235],a[148:151],a[28:31]
ex v208
mf a[32:35],a[232:235],a[152:155],a[32:35]
tr a[252:253],v251,32776
wl 5
mf a[36:39],a[236:239],a[144:147],a[36:39]
tr a[254:255],v251,34824
dn v16,s[8:11],s32,1024
mf a[40:43],a[236:239],a[148:151],a[40:43]
s_waitcnt vmcnt(18)
s_barrier
mf a[44:47],a[236:239],a[152:155],a[44:47]
rq a[232:235],v4,0
wl 5
mf a[48:51],a[240:243],a[144:147],a[48:51]
ex v209
mf a[52:55],a[240:243],a[148:151],a[52:55]
ex v210
mf a[56:59],a[240:243],a[152:155],a[56:59]
rq a[120:123],v252,16384
dn v17,s[8:11],s32,2048
mf a[60:63],a[244:247],a[144:147],a[60:63]
rq a[236:239],v5,0
dn v17,s[8:11],s32,3072
mf a[64:67],a[244:247],a[148:151],a[64:67]
rq a[124:127],v252,18432
s_add_u32 m0, s4, 0x10000
mf a[68:71],a[244:247],a[152:155],a[68:71]
rq a[128:131],v252,20480
s_add_u32 s32, s98, 0xe000
wl 5
mf a[72:75],a[248:251],a[144:147],a[72:75]
rq a[132:135],v253,16384
s_and_b32 s32, s32, 0x1ffff
mf a[76:79],a[248:251],a[148:151],a[76:79]
rq a[136:139],v253,18432
cv v234,v208,v209
mf a[80:83],a[248:251],a[152:155],a[80:83]
rq a[240:243],v6,0
wl 7
mf a[84:87],a[252:255],a[144:147],a[84:87]
rq a[140:143],v253,20480
mf a[88:91],a[252:255],a[148:151],a[88:91]
rq a[244:247],v7,0
mf a[92:95],a[252:255],a[152:155],a[92:95]
rq a[248:251],v4,1024
wl 7
mf v[172:175],a[232:235],v[28:31],v[244:247]
ex v211
mf v[176:179],a[232:235],v[32:35],v[244:247]
ex v212
mf v[180:183],a[232:235],v[36:39],v[244:247]
rq a[252:255],v5,1024
cv v235,v210,v211
mf v[172:175],a[236:239],v[40:43],v[172:175]
ex v213
mf v[176:179],a[236:239],v[44:47],v[176:179]
ex v214
mf v[180:183],a[236:239],v[48:51],v[180:183]
rq a[232:235],v6,1024
cv v238,v212,v213
wl 3
mf v[172:175],a[240:243],v[52:55],v[172:175]
ex v215
mf v[176:179],a[240:243],v[56:59],v[176:179]
ex v216
mf v[180:183],a[240:243],v[60:63],v[180:183]
rq a[236:239],v7,1024
dn v18,s[12:15],s32,0
mf v[172:175],a[244:247],v[64:67],v[172:175]
ex v217
mf v[176:179],a[244:247],v[68:71],v[176:179]
ex v218
mf v[180:183],a[244:247],v[72:75],v[180:183]
ex v219
wl 2
mf v[184:187],a[248:251],v[28:31],v[244:247]
dn v18,s[12:15],s32,1024
mf v[188:191],a[248:251],v[32:35],v[244:247]
s_barrier
mf v[192:195],a[248:251],v[36:39],v[244:247]
tr a[240:241],v8,32768
cv v239,v214,v215
mf v[184:187],a[252:255],v[40:43],v[184:187]
tr a[242:243],v8,33792
dn v19,s[12:15],s32,2048
mf v[188:191],a[252:255],v[44:47],v[188:191]
ex v172
mf v[192:195],a[252:255],v[48:51],v[192:195]
tr a[244:245],v9,32768
dn v19,s[12:15],s32,3072
wl 3
mf v[184:187],a[232:235],v[52:55],v[184:187]
tr a[246:247],v9,33792
s_add_u32 m0, s5, 0x20000
mf v[188:191],a[232:235],v[56:59],v[188:191]
ex v173
mf v[192:195],a[232:235],v[60:63],v[192:195]
tr a[248:249],v10,32768
cv v242,v216,v217
mf v[184:187],a[236:239],v[64:67],v[184:187]
tr a[250:251],v10,33792
cv v243,v218,v219
mf v[188:191],a[236:239],v[68:71],v[188:191]
ex v174
mf v[192:195],a[236:239],v[72:75],v[192:195]
tr a[252:253],v11,32768
cv v220,v172,v173
mf a[216:219],a[228:231],v[232:235],a[216:219]
tr a[254:255],v11,33792
wl 5
mf a[220:223],a[228:231],v[236:239],a[220:223]
ex v175
mf a[224:227],a[228:231],v[240:243],a[224:227]
tr a[232:233],v12,32768
dl v25,s[24:27],s63,0
mf v[76:79],a[240:243],v[232:235],v[76:79]
tr a[234:235],v12,33792
cv v221,v174,v175
mf v[80:83],a[240:243],v[236:239],v[80:83]
ex v176
mf v[84:87],a[240:243],v[240:243],v[84:87]
tr a[236:237],v13,32768
dl v26,s[24:27],s63,1024
wl 5
mf v[88:91],a[244:247],v[232:235],v[88:91]
tr a[238:239],v13,33792
mf v[92:95],a[244:247],v[236:239],v[92:95]
ex v177
mf v[96:99],a[244:247],v[240:243],v[96:99]
tr a[240:241],v14,32768
dl v27,s[24:27],s63,2048
mf v[100:103],a[248:251],v[232:235],v[100:103]
tr a[242:243],v14,33792
cv v224,v176,v177
mf v[104:107],a[248:251],v[236:239],v[104:107]
ex v178
mf v[108:111],a[248:251],v[240:243],v[108:111]
tr a[244:245],v15,32768
wl 5
mf v[112:115],a[252:255],v[232:235],v[112:115]
tr a[246:247],v15,33792
mf v[116:119],a[252:255],v[236:239],v[116:119]
s_waitcnt vmcnt(19)
s_barrier
mf v[120:123],a[252:255],v[240:243],v[120:123]
tr a[248:249],v248,49152
s_add_u32 m0, s4, 0x0
mf v[124:127],a[232:235],v[232:235],v[124:127]
tr a[250:251],v248,51200
s_add_u32 s32, s98, 0x12000
mf v[128:131],a[232:235],v[236:239],v[128:131]
ex v179
mf v[132:135],a[232:235],v[240:243],v[132:135]
tr a[252:253],v248,49160
cv v225,v178,v179
wl 5
mf v[136:139],a[236:239],v[232:235],v[136:139]
tr a[254:255],v248,51208
s_and_b32 s32, s32, 0x1ffff
mf v[140:143],a[236:239],v[236:239],v[140:143]
ex v180
mf v[144:147],a[236:239],v[240:243],v[144:147]
tr a[232:233],v249,49152
wl 5
mf v[148:151],a[240:243],v[232:235],v[148:151]
tr a[234:235],v249,51200
mf v[152:155],a[240:243],v[236:239],v[152:155]
ex v181
mf v[156:159],a[240:243],v[240:243],v[156:159]
tr a[236:237],v249,49160
cv v228,v180,v181
mf v[160:163],a[244:247],v[232:235],v[160:163]
tr a[238:239],v249,51208
wl 5
mf v[164:167],a[244:247],v[236:239],v[164:167]
ex v182
mf v[168:171],a[244:247],v[240:243],v[168:171]
s_cmp_lg_u32 s100, 1
s_cbranch_scc1 L_hs5
s_mov_b32 s48, s70
s_and_b32 s49, s71, 0xffff
s_mov_b32 s50, 256
s_mov_b32 s51, 0x20000
s_lshl_b32 s36, s40, 3
v_mov_b32 v254, 0
v_mov_b32 v255, 1
s_mov_b64 exec, 1
buffer_atomic_add v255, v254, s[48:51], s36 offen sc1
s_mov_b64 exec, -1
L_hs5:
mf a[0:3],a[248:251],a[156:159],a[0:3]
tr a[240:241],v250,49152
wl 4
mf a[4:7],a[248:251],a[160:163],a[4:7]
tr a[242:243],v250,51200
mf a[8:11],a[248:251],a[164:167],a[8:11]
tr a[244:245],v250,49160
wl 5
mf a[12:15],a[252:255],a[156:159],a[12:15]
tr a[246:247],v250,51208
mf a[16:19],a[252:255],a[160:163],a[16:19]
ex v183
mf a[20:23],a[252:255],a[164:167],a[20:23]
tr a[248:249],v251,49152
dn v16,s[8:11],s32,0
mf a[24:27],a[232:235],a[156:159],a[24:27]
tr a[250:251],v251,51200
cv v229,v182,v183
mf a[28:31],a[232:235],a[160:163],a[28:31]
ex v184
mf a[32:35],a[232:235],a[164:167],a[32:35]
tr a[252:253],v251,49160
wl 5
mf a[36:39],a[236:239],a[156:159],a[36:39]
tr a[254:255],v251,51208
dn v16,s[8:11],s32,1024
mf a[40:43],a[236:239],a[160:163],a[40:43]
s_barrier
mf a[44:47],a[236:239],a[164:167],a[44:47]
rq a[232:235],v4,16384
wl 5
mf a[48:51],a[240:243],a[156:159],a[48:51]
ex v185
mf a[52:55],a[240:243],a[160:163],a[52:55]
ex v186
mf a[56:59],a[240:243],a[164:167],a[56:59]
rq a[236:239],v5,16384
dn v17,s[8:11],s32,2048
mf a[60:63],a[244:247],a[156:159],a[60:63]
ex v187
mf a[64:67],a[244:247],a[160:163],a[64:67]
ex v188
mf a[68:71],a[244:247],a[164:167],a[68:71]
rq a[240:243],v6,16384
dn v17,s[8:11],s32,3072
wl 3
mf a[72:75],a[248:251],a[156:159],a[72:75]
ex v189
mf a[76:79],a[248:251],a[160:163],a[76:79]
ex v190
mf a[80:83],a[248:251],a[164:167],a[80:83]
rq a[244:247],v7,16384
s_add_u32 m0, s4, 0x1c000
mf a[84:87],a[252:255],a[156:159],a[84:87]
ex v191
mf a[88:91],a[252:255],a[160:163],a[88:91]
ex v192
mf a[92:95],a[252:255],a[164:167],a[92:95]
rq a[248:251],v4,17408
s_add_u32 s32, s59, 0x40200
wl 3
mf v[196:199],a[232:235],v[28:31],v[244:247]
ex v193
mf v[200:203],a[232:235],v[32:35],v[244:247]
ex v194
mf v[204:207],a[232:235],v[36:39],v[244:247]
rq a[252:255],v5,17408
dl v20,s[16:19],s32,0
mf v[196:199],a[236:239],v[40:43],v[196:199]
ex v195
mf v[200:203],a[236:239],v[44:47],v[200:203]
dl v21,s[16:19],s32,1024
mf v[204:207],a[236:239],v[48:51],v[204:207]
rq a[232:235],v6,17408
dl v22,s[16:19],s32,2048
wl 3
mf v[196:199],a[240:243],v[52:55],v[196:199]
dl v23,s[16:19],s32,3072
mf v[200:203],a[240:243],v[56:59],v[200:203]
rq a[236:239],v7,17408
s_add_u32 m0, s4, 0x14000
mf v[204:207],a[240:243],v[60:63],v[204:207]
s_add_u32 s32, s98, 0x10000
s_and_b32 s32, s32, 0x1ffff
mf v[196:199],a[244:247],v[64:67],v[196:199]
dn v18,s[12:15],s32,0
mf v[200:203],a[244:247],v[68:71],v[200:203]
dn v18,s[12:15],s32,1024
mf v[204:207],a[244:247],v[72:75],v[204:207]
dn v19,s[12:15],s32,2048
wl 2
mf v[208:211],a[248:251],v[28:31],v[244:247]
dn v19,s[12:15],s32,3072
mf v[212:215],a[248:251],v[32:35],v[244:247]
s_waitcnt vmcnt(27)
s_barrier
mf v[216:219],a[248:251],v[36:39],v[244:247]
tr a[240:241],v8,0
s_add_u32 m0, s4, 0x24000
mf v[208:211],a[252:255],v[40:43],v[208:211]
tr a[242:243],v8,1024
cv v222,v184,v185
mf v[212:215],a[252:255],v[44:47],v[212:215]
ex v196
mf v[216:219],a[252:255],v[48:51],v[216:219]
tr a[244:245],v9,0
s_add_u32 s32, s60, 0x200
wl 3
mf v[208:211],a[232:235],v[52:55],v[208:211]
tr a[246:247],v9,1024
cv v223,v186,v187
mf v[212:215],a[232:235],v[56:59],v[212:215]
ex v197
mf v[216:219],a[232:235],v[60:63],v[216:219]
tr a[248:249],v10,0
cv v226,v188,v189
mf v[208:211],a[236:239],v[64:67],v[208:211]
tr a[250:251],v10,1024
cv v227,v190,v191
mf v[212:215],a[236:239],v[68:71],v[212:215]
ex v198
mf v[216:219],a[236:239],v[72:75],v[216:219]
cv v230,v192,v193
cv v231,v194,v195
mf a[216:219],a[228:231],v[220:223],a[216:219]
tr a[252:253],v11,0
cv v232,v196,v197
mf a[220:223],a[228:231],v[224:227],a[220:223]
tr a[254:255],v11,1024
wl 4
mf a[224:227],a[228:231],v[228:231],a[224:227]
tr a[232:233],v12,0
mf v[76:79],a[240:243],v[220:223],v[76:79]
tr a[234:235],v12,1024
mf v[80:83],a[240:243],v[224:227],v[80:83]
ex v199
mf v[84:87],a[240:243],v[228:231],v[84:87]
tr a[236:237],v13,0
dl v20,s[16:19],s32,0
mf v[88:91],a[244:247],v[220:223],v[88:91]
tr a[238:239],v13,1024
cv v233,v198,v199
mf v[92:95],a[244:247],v[224:227],v[92:95]
ex v200
mf v[96:99],a[244:247],v[228:231],v[96:99]
tr a[240:241],v14,0
dl v21,s[16:19],s32,1024
wl 5
mf v[100:103],a[248:251],v[220:223],v[100:103]
tr a[242:243],v14,1024
mf v[104:107],a[248:251],v[224:227],v[104:107]
ex v201
mf v[108:111],a[248:251],v[228:231],v[108:111]
tr a[244:245],v15,0
cv v236,v200,v201
mf v[112:115],a[252:255],v[220:223],v[112:115]
tr a[246:247],v15,1024
dl v22,s[16:19],s32,2048
mf v[116:119],a[252:255],v[224:227],v[116:119]
s_waitcnt vmcnt(26)
s_barrier
mf v[120:123],a[252:255],v[228:231],v[120:123]
tr a[248:249],v248,0
wl 5
mf v[124:127],a[232:235],v[220:223],v[124:127]
tr a[250:251],v248,2048
dl v23,s[16:19],s32,3072
mf v[128:131],a[232:235],v[224:227],v[128:131]
ex v202
mf v[132:135],a[232:235],v[228:231],v[132:135]
tr a[252:253],v248,8
s_add_u32 m0, s4, 0x4000
mf v[136:139],a[236:239],v[220:223],v[136:139]
tr a[254:255],v248,2056
s_add_u32 s32, s98, 0x14000
mf v[140:143],a[236:239],v[224:227],v[140:143]
ex v203
mf v[144:147],a[236:239],v[228:231],v[144:147]
tr a[232:233],v249,0
s_and_b32 s32, s32, 0x1ffff
wl 5
mf v[148:151],a[240:243],v[220:223],v[148:151]
tr a[234:235],v249,2048
cv v237,v202,v203
mf v[152:155],a[240:243],v[224:227],v[152:155]
ex v204
mf v[156:159],a[240:243],v[228:231],v[156:159]
tr a[236:237],v249,8
wl 5
mf v[160:163],a[244:247],v[220:223],v[160:163]
tr a[238:239],v249,2056
mf v[164:167],a[244:247],v[224:227],v[164:167]
ex v205
mf v[168:171],a[244:247],v[228:231],v[168:171]
s_cmp_lg_u32 s100, 2
s_cbranch_scc1 L_hs6
s_mov_b32 s48, s70
s_and_b32 s49, s71, 0xffff
s_mov_b32 s50, 256
s_mov_b32 s51, 0x20000
s_lshl_b32 s36, s40, 3
v_mov_b32 v254, 0
v_mov_b32 v255, 1
s_mov_b64 exec, 1
buffer_atomic_add v255, v254, s[48:51], s36 offen sc1
s_mov_b64 exec, -1
L_hs6:
mf a[0:3],a[248:251],a[168:171],a[0:3]
tr a[240:241],v250,0
cv v240,v204,v205
mf a[4:7],a[248:251],a[172:175],a[4:7]
tr a[242:243],v250,2048
wl 4
mf a[8:11],a[248:251],a[176:179],a[8:11]
tr a[244:245],v250,8
mf a[12:15],a[252:255],a[168:171],a[12:15]
tr a[246:247],v250,2056
mf a[16:19],a[252:255],a[172:175],a[16:19]
ex v206
mf a[20:23],a[252:255],a[176:179],a[20:23]
tr a[248:249],v251,0
dn v16,s[8:11],s32,0
mf a[24:27],a[232:235],a[168:171],a[24:27]
tr a[250:251],v251,2048
wl 6
mf a[28:31],a[232:235],a[172:175],a[28:31]
ex v207
mf a[32:35],a[232:235],a[176:179],a[32:35]
tr a[252:253],v251,8
cv v241,v206,v207
mf a[36:39],a[236:239],a[168:171],a[36:39]
tr a[254:255],v251,2056
dn v16,s[8:11],s32,1024
mf a[40:43],a[236:239],a[172:175],a[40:43]
s_waitcnt vmcnt(18)
s_barrier
mf a[44:47],a[236:239],a[176:179],a[44:47]
rq a[232:235],v4,32768
wl 5
mf a[48:51],a[240:243],a[168:171],a[48:51]
ex v208
mf a[52:55],a[240:243],a[172:175],a[52:55]
ex v209
mf a[56:59],a[240:243],a[176:179],a[56:59]
rq a[144:147],v252,32768
dn v17,s[8:11],s32,2048
mf a[60:63],a[244:247],a[168:171],a[60:63]
rq a[236:239],v5,32768
dn v17,s[8:11],s32,3072
mf a[64:67],a[244:247],a[172:175],a[64:67]
rq a[148:151],v252,34816
s_add_u32 m0, s4, 0xc000
mf a[68:71],a[244:247],a[176:179],a[68:71]
rq a[152:155],v252,36864
s_add_u32 s32, s98, 0x12000
wl 5
mf a[72:75],a[248:251],a[168:171],a[72:75]
rq a[156:159],v253,32768
s_and_b32 s32, s32, 0x1ffff
mf a[76:79],a[248:251],a[172:175],a[76:79]
rq a[160:163],v253,34816
cv v234,v208,v209
mf a[80:83],a[248:251],a[176:179],a[80:83]
rq a[240:243],v6,32768
wl 7
mf a[84:87],a[252:255],a[168:171],a[84:87]
rq a[164:167],v253,36864
mf a[88:91],a[252:255],a[172:175],a[88:91]
rq a[244:247],v7,32768
mf a[92:95],a[252:255],a[176:179],a[92:95]
rq a[248:251],v4,33792
wl 7
mf v[172:175],a[232:235],v[28:31],v[244:247]
ex v210
mf v[176:179],a[232:235],v[32:35],v[244:247]
ex v211
mf v[180:183],a[232:235],v[36:39],v[244:247]
rq a[252:255],v5,33792
cv v235,v210,v211
mf v[172:175],a[236:239],v[40:43],v[172:175]
ex v212
mf v[176:179],a[236:239],v[44:47],v[176:179]
ex v213
mf v[180:183],a[236:239],v[48:51],v[180:183]
rq a[232:235],v6,33792
cv v238,v212,v213
wl 3
mf v[172:175],a[240:243],v[52:55],v[172:175]
ex v214
mf v[176:179],a[240:243],v[56:59],v[176:179]
ex v215
mf v[180:183],a[240:243],v[60:63],v[180:183]
rq a[236:239],v7,33792
dn v18,s[12:15],s32,0
mf v[172:175],a[244:247],v[64:67],v[172:175]
ex v216
mf v[176:179],a[244:247],v[68:71],v[176:179]
ex v217
mf v[180:183],a[244:247],v[72:75],v[180:183]
ex v218
wl 2
mf v[184:187],a[248:251],v[28:31],v[244:247]
ex v219
mf v[188:191],a[248:251],v[32:35],v[244:247]
s_barrier
mf v[192:195],a[248:251],v[36:39],v[244:247]
tr a[240:241],v8,16384
dn v18,s[12:15],s32,1024
mf v[184:187],a[252:255],v[40:43],v[184:187]
tr a[242:243],v8,17408
dn v19,s[12:15],s32,2048
mf v[188:191],a[252:255],v[44:47],v[188:191]
ex v172
mf v[192:195],a[252:255],v[48:51],v[192:195]
tr a[244:245],v9,16384
dn v19,s[12:15],s32,3072
wl 3
mf v[184:187],a[232:235],v[52:55],v[184:187]
tr a[246:247],v9,17408
s_add_u32 m0, s5, 0x18000
mf v[188:191],a[232:235],v[56:59],v[188:191]
ex v173
mf v[192:195],a[232:235],v[60:63],v[192:195]
tr a[248:249],v10,16384
cv v239,v214,v215
mf v[184:187],a[236:239],v[64:67],v[184:187]
tr a[250:251],v10,17408
cv v242,v216,v217
mf v[188:191],a[236:239],v[68:71],v[188:191]
ex v174
mf v[192:195],a[236:239],v[72:75],v[192:195]
cv v243,v218,v219
cv v220,v172,v173
mf a[216:219],a[228:231],v[232:235],a[216:219]
tr a[252:253],v11,16384
wl 4
mf a[220:223],a[228:231],v[236:239],a[220:223]
tr a[254:255],v11,17408
mf a[224:227],a[228:231],v[240:243],a[224:227]
tr a[232:233],v12,16384
dl v25,s[24:27],s64,0
mf v[76:79],a[240:243],v[232:235],v[76:79]
tr a[234:235],v12,17408
wl 5
mf v[80:83],a[240:243],v[236:239],v[80:83]
ex v175
mf v[84:87],a[240:243],v[240:243],v[84:87]
tr a[236:237],v13,16384
dl v26,s[24:27],s64,1024
mf v[88:91],a[244:247],v[232:235],v[88:91]
tr a[238:239],v13,17408
cv v221,v174,v175
mf v[92:95],a[244:247],v[236:239],v[92:95]
ex v176
mf v[96:99],a[244:247],v[240:243],v[96:99]
tr a[240:241],v14,16384
dl v27,s[24:27],s64,2048
wl 5
mf v[100:103],a[248:251],v[232:235],v[100:103]
tr a[242:243],v14,17408
mf v[104:107],a[248:251],v[236:239],v[104:107]
ex v177
mf v[108:111],a[248:251],v[240:243],v[108:111]
tr a[244:245],v15,16384
cv v224,v176,v177
mf v[112:115],a[252:255],v[232:235],v[112:115]
tr a[246:247],v15,17408
wl 5
mf v[116:119],a[252:255],v[236:239],v[116:119]
s_waitcnt vmcnt(19)
s_barrier
mf v[120:123],a[252:255],v[240:243],v[120:123]
tr a[248:249],v248,16384
s_add_u32 m0, s4, 0x8000
mf v[124:127],a[232:235],v[232:235],v[124:127]
tr a[250:251],v248,18432
s_add_u32 s32, s98, 0x16000
mf v[128:131],a[232:235],v[236:239],v[128:131]
ex v178
mf v[132:135],a[232:235],v[240:243],v[132:135]
tr a[252:253],v248,16392
s_and_b32 s32, s32, 0x1ffff
wl 5
mf v[136:139],a[236:239],v[232:235],v[136:139]
tr a[254:255],v248,18440
mf v[140:143],a[236:239],v[236:239],v[140:143]
ex v179
mf v[144:147],a[236:239],v[240:243],v[144:147]
tr a[232:233],v249,16384
cv v225,v178,v179
mf v[148:151],a[240:243],v[232:235],v[148:151]
tr a[234:235],v249,18432
wl 5
mf v[152:155],a[240:243],v[236:239],v[152:155]
ex v180
mf v[156:159],a[240:243],v[240:243],v[156:159]
tr a[236:237],v249,16392
wl 5
mf v[160:163],a[244:247],v[232:235],v[160:163]
tr a[238:239],v249,18440
mf v[164:167],a[244:247],v[236:239],v[164:167]
ex v181
mf v[168:171],a[244:247],v[240:243],v[168:171]
s_cmp_lg_u32 s100, 3
s_cbranch_scc1 L_hs7
s_mov_b32 s48, s70
s_and_b32 s49, s71, 0xffff
s_mov_b32 s50, 256
s_mov_b32 s51, 0x20000
s_lshl_b32 s36, s40, 3
v_mov_b32 v254, 0
v_mov_b32 v255, 1
s_mov_b64 exec, 1
buffer_atomic_add v255, v254, s[48:51], s36 offen sc1
s_mov_b64 exec, -1
L_hs7:
mf a[0:3],a[248:251],a[180:183],a[0:3]
tr a[240:241],v250,16384
cv v228,v180,v181
mf a[4:7],a[248:251],a[184:187],a[4:7]
tr a[242:243],v250,18432
wl 4
mf a[8:11],a[248:251],a[188:191],a[8:11]
tr a[244:245],v250,16392
mf a[12:15],a[252:255],a[180:183],a[12:15]
tr a[246:247],v250,18440
mf a[16:19],a[252:255],a[184:187],a[16:19]
ex v182
mf a[20:23],a[252:255],a[188:191],a[20:23]
tr a[248:249],v251,16384
dn v16,s[8:11],s32,0
mf a[24:27],a[232:235],a[180:183],a[24:27]
tr a[250:251],v251,18432
wl 6
mf a[28:31],a[232:235],a[184:187],a[28:31]
ex v183
mf a[32:35],a[232:235],a[188:191],a[32:35]
tr a[252:253],v251,16392
cv v229,v182,v183
mf a[36:39],a[236:239],a[180:183],a[36:39]
tr a[254:255],v251,18440
dn v16,s[8:11],s32,1024
mf a[40:43],a[236:239],a[184:187],a[40:43]
s_barrier
mf a[44:47],a[236:239],a[188:191],a[44:47]
rq a[232:235],v4,0
wl 5
mf a[48:51],a[240:243],a[180:183],a[48:51]
ex v184
mf a[52:55],a[240:243],a[184:187],a[52:55]
ex v185
mf a[56:59],a[240:243],a[188:191],a[56:59]
rq a[236:239],v5,0
dn v17,s[8:11],s32,2048
mf a[60:63],a[244:247],a[180:183],a[60:63]
ex v186
mf a[64:67],a[244:247],a[184:187],a[64:67]
ex v187
mf a[68:71],a[244:247],a[188:191],a[68:71]
rq a[240:243],v6,0
dn v17,s[8:11],s32,3072
wl 3
mf a[72:75],a[248:251],a[180:183],a[72:75]
ex v188
mf a[76:79],a[248:251],a[184:187],a[76:79]
ex v189
mf a[80:83],a[248:251],a[188:191],a[80:83]
rq a[244:247],v7,0
s_add_u32 m0, s4, 0x20000
mf a[84:87],a[252:255],a[180:183],a[84:87]
ex v190
mf a[88:91],a[252:255],a[184:187],a[88:91]
ex v191
mf a[92:95],a[252:255],a[188:191],a[92:95]
rq a[248:251],v4,1024
s_add_u32 s32, s60, 0x40200
wl 3
mf v[196:199],a[232:235],v[28:31],v[244:247]
ex v192
mf v[200:203],a[232:235],v[32:35],v[244:247]
ex v193
mf v[204:207],a[232:235],v[36:39],v[244:247]
rq a[252:255],v5,1024
dl v20,s[16:19],s32,0
mf v[196:199],a[236:239],v[40:43],v[196:199]
ex v194
mf v[200:203],a[236:239],v[44:47],v[200:203]
ex v195
mf v[204:207],a[236:239],v[48:51],v[204:207]
rq a[232:235],v6,1024
dl v21,s[16:19],s32,1024
wl 3
mf v[196:199],a[240:243],v[52:55],v[196:199]
dl v22,s[16:19],s32,2048
mf v[200:203],a[240:243],v[56:59],v[200:203]
dl v23,s[16:19],s32,3072
mf v[204:207],a[240:243],v[60:63],v[204:207]
rq a[236:239],v7,1024
s_add_u32 m0, s4, 0x10000
mf v[196:199],a[244:247],v[64:67],v[196:199]
s_add_u32 s32, s98, 0x14000
s_and_b32 s32, s32, 0x1ffff
mf v[200:203],a[244:247],v[68:71],v[200:203]
dn v18,s[12:15],s32,0
mf v[204:207],a[244:247],v[72:75],v[204:207]
dn v18,s[12:15],s32,1024
wl 2
mf v[208:211],a[248:251],v[28:31],v[244:247]
dn v19,s[12:15],s32,2048
mf v[212:215],a[248:251],v[32:35],v[244:247]
s_waitcnt vmcnt(26)
s_barrier
mf v[216:219],a[248:251],v[36:39],v[244:247]
tr a[240:241],v8,32768
cv v222,v184,v185
mf v[208:211],a[252:255],v[40:43],v[208:211]
tr a[242:243],v8,33792
cv v223,v186,v187
mf v[212:215],a[252:255],v[44:47],v[212:215]
ex v196
mf v[216:219],a[252:255],v[48:51],v[216:219]
tr a[244:245],v9,32768
dn v19,s[12:15],s32,3072
wl 3
mf v[208:211],a[232:235],v[52:55],v[208:211]
tr a[246:247],v9,33792
s_add_u32 m0, s4, 0x1c000
mf v[212:215],a[232:235],v[56:59],v[212:215]
ex v197
mf v[216:219],a[232:235],v[60:63],v[216:219]
tr a[248:249],v10,32768
s_add_u32 s32, s52, 0x200
mf v[208:211],a[236:239],v[64:67],v[208:211]
tr a[250:251],v10,33792
cv v226,v188,v189
mf v[212:215],a[236:239],v[68:71],v[212:215]
ex v198
mf v[216:219],a[236:239],v[72:75],v[216:219]
cv v227,v190,v191
cv v230,v192,v193
cv v231,v194,v195
mf a[216:219],a[228:231],v[220:223],a[216:219]
tr a[252:253],v11,32768
cv v232,v196,v197
mf a[220:223],a[228:231],v[224:227],a[220:223]
tr a[254:255],v11,33792
wl 4
mf a[224:227],a[228:231],v[228:231],a[224:227]
tr a[232:233],v12,32768
mf v[76:79],a[240:243],v[220:223],v[76:79]
tr a[234:235],v12,33792
mf v[80:83],a[240:243],v[224:227],v[80:83]
ex v199
mf v[84:87],a[240:243],v[228:231],v[84:87]
tr a[236:237],v13,32768
dl v20,s[16:19],s32,0
mf v[88:91],a[244:247],v[220:223],v[88:91]
tr a[238:239],v13,33792
cv v233,v198,v199
mf v[92:95],a[244:247],v[224:227],v[92:95]
ex v200
mf v[96:99],a[244:247],v[228:231],v[96:99]
tr a[240:241],v14,32768
dl v21,s[16:19],s32,1024
wl 5
mf v[100:103],a[248:251],v[220:223],v[100:103]
tr a[242:243],v14,33792
mf v[104:107],a[248:251],v[224:227],v[104:107]
ex v201
mf v[108:111],a[248:251],v[228:231],v[108:111]
tr a[244:245],v15,32768
cv v236,v200,v201
mf v[112:115],a[252:255],v[220:223],v[112:115]
tr a[246:247],v15,33792
dl v22,s[16:19],s32,2048
mf v[116:119],a[252:255],v[224:227],v[116:119]
s_waitcnt vmcnt(26)
s_barrier
mf v[120:123],a[252:255],v[228:231],v[120:123]
tr a[248:249],v248,49152
wl 5
mf v[124:127],a[232:235],v[220:223],v[124:127]
tr a[250:251],v248,51200
dl v23,s[16:19],s32,3072
mf v[128:131],a[232:235],v[224:227],v[128:131]
ex v202
mf v[132:135],a[232:235],v[228:231],v[132:135]
tr a[252:253],v248,49160
s_add_u32 m0, s4, 0x0
mf v[136:139],a[236:239],v[220:223],v[136:139]
tr a[254:255],v248,51208
s_add_u32 s32, s98, 0x18000
mf v[140:143],a[236:239],v[224:227],v[140:143]
ex v203
mf v[144:147],a[236:239],v[228:231],v[144:147]
tr a[232:233],v249,49152
s_and_b32 s32, s32, 0x1ffff
wl 5
mf v[148:151],a[240:243],v[220:223],v[148:151]
tr a[234:235],v249,51200
cv v237,v202,v203
mf v[152:155],a[240:243],v[224:227],v[152:155]
ex v204
mf v[156:159],a[240:243],v[228:231],v[156:159]
tr a[236:237],v249,49160
wl 5
mf v[160:163],a[244:247],v[220:223],v[160:163]
tr a[238:239],v249,51208
mf v[164:167],a[244:247],v[224:227],v[164:167]
ex v205
mf v[168:171],a[244:247],v[228:231],v[168:171]
s_cmp_lg_u32 s100, 4
s_cbranch_scc1 L_hs8
s_mov_b32 s48, s70
s_and_b32 s49, s71, 0xffff
s_mov_b32 s50, 256
s_mov_b32 s51, 0x20000
s_lshl_b32 s36, s40, 3
v_mov_b32 v254, 0
v_mov_b32 v255, 1
s_mov_b64 exec, 1
buffer_atomic_add v255, v254, s[48:51], s36 offen sc1
s_mov_b64 exec, -1
L_hs8:
mf a[0:3],a[248:251],a[192:195],a[0:3]
tr a[240:241],v250,49152
cv v240,v204,v205
mf a[4:7],a[248:251],a[196:199],a[4:7]
tr a[242:243],v250,51200
wl 4
mf a[8:11],a[248:251],a[200:203],a[8:11]
tr a[244:245],v250,49160
mf a[12:15],a[252:255],a[192:195],a[12:15]
tr a[246:247],v250,51208
mf a[16:19],a[252:255],a[196:199],a[16:19]
ex v206
mf a[20:23],a[252:255],a[200:203],a[20:23]
tr a[248:249],v251,49152
dn v16,s[8:11],s32,0
mf a[24:27],a[232:235],a[192:195],a[24:27]
tr a[250:251],v251,51200
wl 6
mf a[28:31],a[232:235],a[196:199],a[28:31]
ex v207
mf a[32:35],a[232:235],a[200:203],a[32:35]
tr a[252:253],v251,49160
cv v241,v206,v207
mf a[36:39],a[236:239],a[192:195],a[36:39]
tr a[254:255],v251,51208
dn v16,s[8:11],s32,1024
mf a[40:43],a[236:239],a[196:199],a[40:43]
s_waitcnt vmcnt(18)
s_barrier
mf a[44:47],a[236:239],a[200:203],a[44:47]
rq a[232:235],v4,16384
wl 5
mf a[48:51],a[240:243],a[192:195],a[48:51]
ex v208
mf a[52:55],a[240:243],a[196:199],a[52:55]
ex v209
mf a[56:59],a[240:243],a[200:203],a[56:59]
rq a[168:171],v252,0
dn v17,s[8:11],s32,2048
mf a[60:63],a[244:247],a[192:195],a[60:63]
rq a[236:239],v5,16384
dn v17,s[8:11],s32,3072
mf a[64:67],a[244:247],a[196:199],a[64:67]
rq a[172:175],v252,2048
s_add_u32 m0, s4, 0x14000
mf a[68:71],a[244:247],a[200:203],a[68:71]
rq a[176:179],v252,4096
s_add_u32 s32, s98, 0x16000
wl 5
mf a[72:75],a[248:251],a[192:195],a[72:75]
rq a[180:183],v253,0
s_and_b32 s32, s32, 0x1ffff
mf a[76:79],a[248:251],a[196:199],a[76:79]
rq a[184:187],v253,2048
cv v234,v208,v209
mf a[80:83],a[248:251],a[200:203],a[80:83]
rq a[240:243],v6,16384
wl 7
mf a[84:87],a[252:255],a[192:195],a[84:87]
rq a[188:191],v253,4096
mf a[88:91],a[252:255],a[196:199],a[88:91]
rq a[244:247],v7,16384
mf a[92:95],a[252:255],a[200:203],a[92:95]
rq a[248:251],v4,17408
wl 7
mf v[172:175],a[232:235],v[28:31],v[244:247]
ex v210
mf v[176:179],a[232:235],v[32:35],v[244:247]
ex v211
mf v[180:183],a[232:235],v[36:39],v[244:247]
rq a[252:255],v5,17408
cv v235,v210,v211
mf v[172:175],a[236:239],v[40:43],v[172:175]
ex v212
mf v[176:179],a[236:239],v[44:47],v[176:179]
ex v213
mf v[180:183],a[236:239],v[48:51],v[180:183]
rq a[232:235],v6,17408
cv v238,v212,v213
wl 3
mf v[172:175],a[240:243],v[52:55],v[172:175]
ex v214
mf v[176:179],a[240:243],v[56:59],v[176:179]
ex v215
mf v[180:183],a[240:243],v[60:63],v[180:183]
rq a[236:239],v7,17408
dn v18,s[12:15],s32,0
mf v[172:175],a[244:247],v[64:67],v[172:175]
ex v216
mf v[176:179],a[244:247],v[68:71],v[176:179]
ex v217
mf v[180:183],a[244:247],v[72:75],v[180:183]
ex v218
wl 2
mf v[184:187],a[248:251],v[28:31],v[244:247]
ex v219
mf v[188:191],a[248:251],v[32:35],v[244:247]
s_barrier
mf v[192:195],a[248:251],v[36:39],v[244:247]
tr a[240:241],v8,0
dn v18,s[12:15],s32,1024
mf v[184:187],a[252:255],v[40:43],v[184:187]
tr a[242:243],v8,1024
dn v19,s[12:15],s32,2048
mf v[188:191],a[252:255],v[44:47],v[188:191]
ex v172
mf v[192:195],a[252:255],v[48:51],v[192:195]
tr a[244:245],v9,0
dn v19,s[12:15],s32,3072
wl 3
mf v[184:187],a[232:235],v[52:55],v[184:187]
tr a[246:247],v9,1024
s_add_u32 m0, s4, 0x24000
mf v[188:191],a[232:235],v[56:59],v[188:191]
ex v173
mf v[192:195],a[232:235],v[60:63],v[192:195]
tr a[248:249],v10,0
s_add_u32 s32, s52, 0x40200
mf v[184:187],a[236:239],v[64:67],v[184:187]
tr a[250:251],v10,1024
cv v239,v214,v215
mf v[188:191],a[236:239],v[68:71],v[188:191]
ex v174
mf v[192:195],a[236:239],v[72:75],v[192:195]
cv v242,v216,v217
cv v243,v218,v219
mf a[216:219],a[228:231],v[232:235],a[216:219]
tr a[252:253],v11,0
cv v220,v172,v173
mf a[220:223],a[228:231],v[236:239],a[220:223]
tr a[254:255],v11,1024
wl 4
mf a[224:227],a[228:231],v[240:243],a[224:227]
tr a[232:233],v12,0
mf v[76:79],a[240:243],v[232:235],v[76:79]
tr a[234:235],v12,1024
mf v[80:83],a[240:243],v[236:239],v[80:83]
ex v175
mf v[84:87],a[240:243],v[240:243],v[84:87]
tr a[236:237],v13,0
dl v20,s[16:19],s32,0
mf v[88:91],a[244:247],v[232:235],v[88:91]
tr a[238:239],v13,1024
cv v221,v174,v175
mf v[92:95],a[244:247],v[236:239],v[92:95]
ex v176
mf v[96:99],a[244:247],v[240:243],v[96:99]
tr a[240:241],v14,0
dl v21,s[16:19],s32,1024
wl 5
mf v[100:103],a[248:251],v[232:235],v[100:103]
tr a[242:243],v14,1024
mf v[104:107],a[248:251],v[236:239],v[104:107]
ex v177
mf v[108:111],a[248:251],v[240:243],v[108:111]
tr a[244:245],v15,0
cv v224,v176,v177
mf v[112:115],a[252:255],v[232:235],v[112:115]
tr a[246:247],v15,1024
dl v22,s[16:19],s32,2048
mf v[116:119],a[252:255],v[236:239],v[116:119]
s_waitcnt vmcnt(19)
s_barrier
mf v[120:123],a[252:255],v[240:243],v[120:123]
tr a[248:249],v248,32768
wl 5
mf v[124:127],a[232:235],v[232:235],v[124:127]
tr a[250:251],v248,34816
dl v23,s[16:19],s32,3072
mf v[128:131],a[232:235],v[236:239],v[128:131]
ex v178
mf v[132:135],a[232:235],v[240:243],v[132:135]
tr a[252:253],v248,32776
s_add_u32 m0, s4, 0x4000
mf v[136:139],a[236:239],v[232:235],v[136:139]
tr a[254:255],v248,34824
s_add_u32 s32, s98, 0x1a000
mf v[140:143],a[236:239],v[236:239],v[140:143]
ex v179
mf v[144:147],a[236:239],v[240:243],v[144:147]
tr a[232:233],v249,32768
s_and_b32 s32, s32, 0x1ffff
wl 5
mf v[148:151],a[240:243],v[232:235],v[148:151]
tr a[234:235],v249,34816
cv v225,v178,v179
mf v[152:155],a[240:243],v[236:239],v[152:155]
ex v180
mf v[156:159],a[240:243],v[240:243],v[156:159]
tr a[236:237],v249,32776
wl 5
mf v[160:163],a[244:247],v[232:235],v[160:163]
tr a[238:239],v249,34824
mf v[164:167],a[244:247],v[236:239],v[164:167]
ex v181
mf v[168:171],a[244:247],v[240:243],v[168:171]
s_cmp_lg_u32 s100, 5
s_cbranch_scc1 L_hs9
s_mov_b32 s48, s70
s_and_b32 s49, s71, 0xffff
s_mov_b32 s50, 256
s_mov_b32 s51, 0x20000
s_lshl_b32 s36, s40, 3
v_mov_b32 v254, 0
v_mov_b32 v255, 1
s_mov_b64 exec, 1
buffer_atomic_add v255, v254, s[48:51], s36 offen sc1
s_mov_b64 exec, -1
L_hs9:
mf a[0:3],a[248:251],a[204:207],a[0:3]
tr a[240:241],v250,32768
cv v228,v180,v181
mf a[4:7],a[248:251],a[208:211],a[4:7]
tr a[242:243],v250,34816
wl 4
mf a[8:11],a[248:251],a[212:215],a[8:11]
tr a[244:245],v250,32776
mf a[12:15],a[252:255],a[204:207],a[12:15]
tr a[246:247],v250,34824
mf a[16:19],a[252:255],a[208:211],a[16:19]
ex v182
mf a[20:23],a[252:255],a[212:215],a[20:23]
tr a[248:249],v251,32768
dn v16,s[8:11],s32,0
mf a[24:27],a[232:235],a[204:207],a[24:27]
tr a[250:251],v251,34816
wl 6
mf a[28:31],a[232:235],a[208:211],a[28:31]
ex v183
mf a[32:35],a[232:235],a[212:215],a[32:35]
tr a[252:253],v251,32776
cv v229,v182,v183
mf a[36:39],a[236:239],a[204:207],a[36:39]
tr a[254:255],v251,34824
dn v16,s[8:11],s32,1024
mf a[40:43],a[236:239],a[208:211],a[40:43]
s_barrier
mf a[44:47],a[236:239],a[212:215],a[44:47]
rq a[232:235],v4,32768
wl 5
mf a[48:51],a[240:243],a[204:207],a[48:51]
ex v184
mf a[52:55],a[240:243],a[208:211],a[52:55]
ex v185
mf a[56:59],a[240:243],a[212:215],a[56:59]
rq a[236:239],v5,32768
dn v17,s[8:11],s32,2048
mf a[60:63],a[244:247],a[204:207],a[60:63]
ex v186
mf a[64:67],a[244:247],a[208:211],a[64:67]
ex v187
mf a[68:71],a[244:247],a[212:215],a[68:71]
rq a[240:243],v6,32768
dn v17,s[8:11],s32,3072
wl 3
mf a[72:75],a[248:251],a[204:207],a[72:75]
ex v188
mf a[76:79],a[248:251],a[208:211],a[76:79]
ex v189
mf a[80:83],a[248:251],a[212:215],a[80:83]
rq a[244:247],v7,32768
s_add_u32 m0, s4, 0xc000
mf a[84:87],a[252:255],a[204:207],a[84:87]
ex v190
mf a[88:91],a[252:255],a[208:211],a[88:91]
ex v191
mf a[92:95],a[252:255],a[212:215],a[92:95]
rq a[248:251],v4,33792
s_add_u32 s32, s98, 0x18000
wl 3
mf v[196:199],a[232:235],v[28:31],v[244:247]
ex v192
mf v[200:203],a[232:235],v[32:35],v[244:247]
ex v193
mf v[204:207],a[232:235],v[36:39],v[244:247]
rq a[252:255],v5,33792
s_and_b32 s32, s32, 0x1ffff
mf v[196:199],a[236:239],v[40:43],v[196:199]
ex v194
mf v[200:203],a[236:239],v[44:47],v[200:203]
ex v195
mf v[204:207],a[236:239],v[48:51],v[204:207]
rq a[232:235],v6,33792
cv v222,v184,v185
wl 3
mf v[196:199],a[240:243],v[52:55],v[196:199]
dn v18,s[12:15],s32,0
mf v[200:203],a[240:243],v[56:59],v[200:203]
dn v18,s[12:15],s32,1024
mf v[204:207],a[240:243],v[60:63],v[204:207]
rq a[236:239],v7,33792
cv v223,v186,v187
mf v[196:199],a[244:247],v[64:67],v[196:199]
dn v19,s[12:15],s32,2048
mf v[200:203],a[244:247],v[68:71],v[200:203]
dn v19,s[12:15],s32,3072
mf v[204:207],a[244:247],v[72:75],v[204:207]
cv v226,v188,v189
cv v227,v190,v191
wl 2
mf v[208:211],a[248:251],v[28:31],v[244:247]
cv v230,v192,v193
cv v231,v194,v195
mf v[212:215],a[248:251],v[32:35],v[244:247]
s_waitcnt vmcnt(24)
s_barrier
mf v[216:219],a[248:251],v[36:39],v[244:247]
tr a[240:241],v8,16384
s_add_u32 m0, s4, 0x18000
mf v[208:211],a[252:255],v[40:43],v[208:211]
tr a[242:243],v8,17408
s_add_u32 s32, s53, 0x200
mf v[212:215],a[252:255],v[44:47],v[212:215]
ex v196
mf v[216:219],a[252:255],v[48:51],v[216:219]
tr a[244:245],v9,16384
wl 3
mf v[208:211],a[232:235],v[52:55],v[208:211]
tr a[246:247],v9,17408
mf v[212:215],a[232:235],v[56:59],v[212:215]
ex v197
mf v[216:219],a[232:235],v[60:63],v[216:219]
tr a[248:249],v10,16384
cv v232,v196,v197
mf v[208:211],a[236:239],v[64:67],v[208:211]
tr a[250:251],v10,17408
mf v[212:215],a[236:239],v[68:71],v[212:215]
ex v198
mf v[216:219],a[236:239],v[72:75],v[216:219]
tr a[252:253],v11,16384
wl 5
mf a[216:219],a[228:231],v[220:223],a[216:219]
tr a[254:255],v11,17408
mf a[220:223],a[228:231],v[224:227],a[220:223]
ex v199
mf a[224:227],a[228:231],v[228:231],a[224:227]
tr a[232:233],v12,16384
cv v233,v198,v199
mf v[76:79],a[240:243],v[220:223],v[76:79]
tr a[234:235],v12,17408
wl 5
mf v[80:83],a[240:243],v[224:227],v[80:83]
ex v200
mf v[84:87],a[240:243],v[228:231],v[84:87]
tr a[236:237],v13,16384
dl v20,s[16:19],s32,0
mf v[88:91],a[244:247],v[220:223],v[88:91]
tr a[238:239],v13,17408
wl 5
mf v[92:95],a[244:247],v[224:227],v[92:95]
ex v201
mf v[96:99],a[244:247],v[228:231],v[96:99]
tr a[240:241],v14,16384
dl v21,s[16:19],s32,1024
mf v[100:103],a[248:251],v[220:223],v[100:103]
tr a[242:243],v14,17408
cv v236,v200,v201
mf v[104:107],a[248:251],v[224:227],v[104:107]
ex v202
mf v[108:111],a[248:251],v[228:231],v[108:111]
tr a[244:245],v15,16384
wl 5
mf v[112:115],a[252:255],v[220:223],v[112:115]
tr a[246:247],v15,17408
dl v22,s[16:19],s32,2048
mf v[116:119],a[252:255],v[224:227],v[116:119]
s_waitcnt vmcnt(23)
s_barrier
mf v[120:123],a[252:255],v[228:231],v[120:123]
tr a[248:249],v248,16384
wl 5
mf v[124:127],a[232:235],v[220:223],v[124:127]
tr a[250:251],v248,18432
dl v23,s[16:19],s32,3072
mf v[128:131],a[232:235],v[224:227],v[128:131]
ex v203
mf v[132:135],a[232:235],v[228:231],v[132:135]
tr a[252:253],v248,16392
s_add_u32 m0, s4, 0x8000
mf v[136:139],a[236:239],v[220:223],v[136:139]
tr a[254:255],v248,18440
s_add_u32 s32, s98, 0x1c000
mf v[140:143],a[236:239],v[224:227],v[140:143]
ex v204
mf v[144:147],a[236:239],v[228:231],v[144:147]
tr a[232:233],v249,16384
s_and_b32 s32, s32, 0x1ffff
wl 5
mf v[148:151],a[240:243],v[220:223],v[148:151]
tr a[234:235],v249,18432
cv v237,v202,v203
mf v[152:155],a[240:243],v[224:227],v[152:155]
ex v205
mf v[156:159],a[240:243],v[228:231],v[156:159]
tr a[236:237],v249,16392
cv v240,v204,v205
mf v[160:163],a[244:247],v[220:223],v[160:163]
tr a[238:239],v249,18440
wl 5
mf v[164:167],a[244:247],v[224:227],v[164:167]
ex v206
mf v[168:171],a[244:247],v[228:231],v[168:171]
s_cmp_lg_u32 s100, 6
s_cbranch_scc1 L_hs10
s_mov_b32 s48, s70
s_and_b32 s49, s71, 0xffff
s_mov_b32 s50, 256
s_mov_b32 s51, 0x20000
s_lshl_b32 s36, s40, 3
v_mov_b32 v254, 0
v_mov_b32 v255, 1
s_mov_b64 exec, 1
buffer_atomic_add v255, v254, s[48:51], s36 offen sc1
s_mov_b64 exec, -1
L_hs10:
mf a[0:3],a[248:251],a[96:99],a[0:3]
tr a[240:241],v250,16384
wl 4
mf a[4:7],a[248:251],a[100:103],a[4:7]
tr a[242:243],v250,18432
mf a[8:11],a[248:251],a[104:107],a[8:11]
tr a[244:245],v250,16392
wl 5
mf a[12:15],a[252:255],a[96:99],a[12:15]
tr a[246:247],v250,18440
mf a[16:19],a[252:255],a[100:103],a[16:19]
ex v207
mf a[20:23],a[252:255],a[104:107],a[20:23]
tr a[248:249],v251,16384
dn v16,s[8:11],s32,0
mf a[24:27],a[232:235],a[96:99],a[24:27]
tr a[250:251],v251,18432
cv v241,v206,v207
mf a[28:31],a[232:235],a[100:103],a[28:31]
ex v208
mf a[32:35],a[232:235],a[104:107],a[32:35]
tr a[252:253],v251,16392
wl 5
mf a[36:39],a[236:239],a[96:99],a[36:39]
tr a[254:255],v251,18440
dn v16,s[8:11],s32,1024
mf a[40:43],a[236:239],a[100:103],a[40:43]
s_waitcnt vmcnt(22)
s_barrier
mf a[44:47],a[236:239],a[104:107],a[44:47]
rq a[232:235],v4,0
wl 5
mf a[48:51],a[240:243],a[96:99],a[48:51]
ex v209
mf a[52:55],a[240:243],a[100:103],a[52:55]
ex v210
mf a[56:59],a[240:243],a[104:107],a[56:59]
rq a[236:239],v5,0
dn v17,s[8:11],s32,2048
mf a[60:63],a[244:247],a[96:99],a[60:63]
ex v211
mf a[64:67],a[244:247],a[100:103],a[64:67]
ex v212
mf a[68:71],a[244:247],a[104:107],a[68:71]
rq a[240:243],v6,0
dn v17,s[8:11],s32,3072
wl 3
mf a[72:75],a[248:251],a[96:99],a[72:75]
ex v213
mf a[76:79],a[248:251],a[100:103],a[76:79]
ex v214
mf a[80:83],a[248:251],a[104:107],a[80:83]
rq a[244:247],v7,0
s_add_u32 m0, s4, 0x10000
mf a[84:87],a[252:255],a[96:99],a[84:87]
ex v215
mf a[88:91],a[252:255],a[100:103],a[88:91]
ex v216
mf a[92:95],a[252:255],a[104:107],a[92:95]
rq a[248:251],v4,1024
s_add_u32 s32, s98, 0x1a000
wl 3
mf v[172:175],a[232:235],v[28:31],v[244:247]
ex v217
mf v[176:179],a[232:235],v[32:35],v[244:247]
ex v218
mf v[180:183],a[232:235],v[36:39],v[244:247]
rq a[252:255],v5,1024
s_and_b32 s32, s32, 0x1ffff
mf v[172:175],a[236:239],v[40:43],v[172:175]
ex v219
mf v[176:179],a[236:239],v[44:47],v[176:179]
dn v18,s[12:15],s32,0
mf v[180:183],a[236:239],v[48:51],v[180:183]
rq a[232:235],v6,1024
cv v234,v208,v209
wl 3
mf v[172:175],a[240:243],v[52:55],v[172:175]
dn v18,s[12:15],s32,1024
mf v[176:179],a[240:243],v[56:59],v[176:179]
dn v19,s[12:15],s32,2048
mf v[180:183],a[240:243],v[60:63],v[180:183]
rq a[236:239],v7,1024
cv v235,v210,v211
mf v[172:175],a[244:247],v[64:67],v[172:175]
dn v19,s[12:15],s32,3072
mf v[176:179],a[244:247],v[68:71],v[176:179]
cv v238,v212,v213
cv v239,v214,v215
mf v[180:183],a[244:247],v[72:75],v[180:183]
cv v242,v216,v217
cv v243,v218,v219
wl 2
mf v[184:187],a[248:251],v[28:31],v[244:247]
mf v[188:191],a[248:251],v[32:35],v[244:247]
s_waitcnt vmcnt(24)
s_barrier
mf v[192:195],a[248:251],v[36:39],v[244:247]
tr a[240:241],v8,32768
s_add_u32 m0, s4, 0x1c000
mf v[184:187],a[252:255],v[40:43],v[184:187]
tr a[242:243],v8,33792
s_add_u32 s32, s53, 0x40200
mf v[188:191],a[252:255],v[44:47],v[188:191]
ex v172
mf v[192:195],a[252:255],v[48:51],v[192:195]
tr a[244:245],v9,32768
wl 3
mf v[184:187],a[232:235],v[52:55],v[184:187]
tr a[246:247],v9,33792
mf v[188:191],a[232:235],v[56:59],v[188:191]
ex v173
mf v[192:195],a[232:235],v[60:63],v[192:195]
tr a[248:249],v10,32768
cv v220,v172,v173
mf v[184:187],a[236:239],v[64:67],v[184:187]
tr a[250:251],v10,33792
mf v[188:191],a[236:239],v[68:71],v[188:191]
ex v174
mf v[192:195],a[236:239],v[72:75],v[192:195]
tr a[252:253],v11,32768
wl 5
mf a[216:219],a[228:231],v[232:235],a[216:219]
tr a[254:255],v11,33792
mf a[220:223],a[228:231],v[236:239],a[220:223]
ex v175
mf a[224:227],a[228:231],v[240:243],a[224:227]
tr a[232:233],v12,32768
cv v221,v174,v175
mf v[76:79],a[240:243],v[232:235],v[76:79]
tr a[234:235],v12,33792
wl 5
mf v[80:83],a[240:243],v[236:239],v[80:83]
ex v176
mf v[84:87],a[240:243],v[240:243],v[84:87]
tr a[236:237],v13,32768
dl v20,s[16:19],s32,0
mf v[88:91],a[244:247],v[232:235],v[88:91]
tr a[238:239],v13,33792
wl 5
mf v[92:95],a[244:247],v[236:239],v[92:95]
ex v177
mf v[96:99],a[244:247],v[240:243],v[96:99]
tr a[240:241],v14,32768
dl v21,s[16:19],s32,1024
mf v[100:103],a[248:251],v[232:235],v[100:103]
tr a[242:243],v14,33792
cv v224,v176,v177
mf v[104:107],a[248:251],v[236:239],v[104:107]
ex v178
mf v[108:111],a[248:251],v[240:243],v[108:111]
tr a[244:245],v15,32768
wl 5
mf v[112:115],a[252:255],v[232:235],v[112:115]
tr a[246:247],v15,33792
dl v22,s[16:19],s32,2048
mf v[116:119],a[252:255],v[236:239],v[116:119]
s_waitcnt vmcnt(23)
s_barrier
mf v[120:123],a[252:255],v[240:243],v[120:123]
tr a[248:249],v248,49152
wl 5
mf v[124:127],a[232:235],v[232:235],v[124:127]
tr a[250:251],v248,51200
dl v23,s[16:19],s32,3072
mf v[128:131],a[232:235],v[236:239],v[128:131]
ex v179
mf v[132:135],a[232:235],v[240:243],v[132:135]
tr a[252:253],v248,49160
s_add_u32 m0, s4, 0x0
mf v[136:139],a[236:239],v[232:235],v[136:139]
tr a[254:255],v248,51208
s_add_u32 s32, s98, 0x1e000
mf v[140:143],a[236:239],v[236:239],v[140:143]
ex v180
mf v[144:147],a[236:239],v[240:243],v[144:147]
tr a[232:233],v249,49152
s_and_b32 s32, s32, 0x1ffff
wl 5
mf v[148:151],a[240:243],v[232:235],v[148:151]
tr a[234:235],v249,51200
cv v225,v178,v179
mf v[152:155],a[240:243],v[236:239],v[152:155]
ex v181
mf v[156:159],a[240:243],v[240:243],v[156:159]
tr a[236:237],v249,49160
cv v228,v180,v181
mf v[160:163],a[244:247],v[232:235],v[160:163]
tr a[238:239],v249,51208
wl 5
mf v[164:167],a[244:247],v[236:239],v[164:167]
ex v182
mf v[168:171],a[244:247],v[240:243],v[168:171]
s_cmp_lg_u32 s100, 7
s_cbranch_scc1 L_hs11
s_mov_b32 s48, s70
s_and_b32 s49, s71, 0xffff
s_mov_b32 s50, 256
s_mov_b32 s51, 0x20000
s_lshl_b32 s36, s40, 3
v_mov_b32 v254, 0
v_mov_b32 v255, 1
s_mov_b64 exec, 1
buffer_atomic_add v255, v254, s[48:51], s36 offen sc1
s_mov_b64 exec, -1
L_hs11:
mf a[0:3],a[248:251],a[108:111],a[0:3]
tr a[240:241],v250,49152
wl 4
mf a[4:7],a[248:251],a[112:115],a[4:7]
tr a[242:243],v250,51200
mf a[8:11],a[248:251],a[116:119],a[8:11]
tr a[244:245],v250,49160
wl 5
mf a[12:15],a[252:255],a[108:111],a[12:15]
tr a[246:247],v250,51208
mf a[16:19],a[252:255],a[112:115],a[16:19]
ex v183
mf a[20:23],a[252:255],a[116:119],a[20:23]
tr a[248:249],v251,49152
dn v16,s[8:11],s32,0
mf a[24:27],a[232:235],a[108:111],a[24:27]
tr a[250:251],v251,51200
cv v229,v182,v183
mf a[28:31],a[232:235],a[112:115],a[28:31]
ex v184
mf a[32:35],a[232:235],a[116:119],a[32:35]
tr a[252:253],v251,49160
wl 5
mf a[36:39],a[236:239],a[108:111],a[36:39]
tr a[254:255],v251,51208
dn v16,s[8:11],s32,1024
mf a[40:43],a[236:239],a[112:115],a[40:43]
s_waitcnt vmcnt(22)
s_barrier
mf a[44:47],a[236:239],a[116:119],a[44:47]
rq a[232:235],v4,16384
wl 5
mf a[48:51],a[240:243],a[108:111],a[48:51]
ex v185
mf a[52:55],a[240:243],a[112:115],a[52:55]
ex v186
mf a[56:59],a[240:243],a[116:119],a[56:59]
rq a[236:239],v5,16384
dn v17,s[8:11],s32,2048
mf a[60:63],a[244:247],a[108:111],a[60:63]
ex v187
mf a[64:67],a[244:247],a[112:115],a[64:67]
ex v188
mf a[68:71],a[244:247],a[116:119],a[68:71]
rq a[240:243],v6,16384
dn v17,s[8:11],s32,3072
wl 3
mf a[72:75],a[248:251],a[108:111],a[72:75]
ex v189
mf a[76:79],a[248:251],a[112:115],a[76:79]
ex v190
mf a[80:83],a[248:251],a[116:119],a[80:83]
rq a[244:247],v7,16384
s_add_u32 m0, s4, 0x14000
mf a[84:87],a[252:255],a[108:111],a[84:87]
ex v191
mf a[88:91],a[252:255],a[112:115],a[88:91]
ex v192
mf a[92:95],a[252:255],a[116:119],a[92:95]
rq a[248:251],v4,17408
s_add_u32 s32, s98, 0x1c000
wl 3
mf v[196:199],a[232:235],v[28:31],v[244:247]
ex v193
mf v[200:203],a[232:235],v[32:35],v[244:247]
ex v194
mf v[204:207],a[232:235],v[36:39],v[244:247]
rq a[252:255],v5,17408
s_and_b32 s32, s32, 0x1ffff
mf v[196:199],a[236:239],v[40:43],v[196:199]
ex v195
mf v[200:203],a[236:239],v[44:47],v[200:203]
dn v18,s[12:15],s32,0
mf v[204:207],a[236:239],v[48:51],v[204:207]
rq a[232:235],v6,17408
cv v222,v184,v185
wl 3
mf v[196:199],a[240:243],v[52:55],v[196:199]
dn v18,s[12:15],s32,1024
mf v[200:203],a[240:243],v[56:59],v[200:203]
dn v19,s[12:15],s32,2048
mf v[204:207],a[240:243],v[60:63],v[204:207]
rq a[236:239],v7,17408
cv v223,v186,v187
mf v[196:199],a[244:247],v[64:67],v[196:199]
dn v19,s[12:15],s32,3072
mf v[200:203],a[244:247],v[68:71],v[200:203]
cv v226,v188,v189
cv v227,v190,v191
mf v[204:207],a[244:247],v[72:75],v[204:207]
cv v230,v192,v193
cv v231,v194,v195
wl 2
mf v[208:211],a[248:251],v[28:31],v[244:247]
mf v[212:215],a[248:251],v[32:35],v[244:247]
s_waitcnt vmcnt(24)
s_barrier
mf v[216:219],a[248:251],v[36:39],v[244:247]
tr a[240:241],v8,0
s_add_u32 m0, s4, 0x20000
mf v[208:211],a[252:255],v[40:43],v[208:211]
tr a[242:243],v8,1024
s_add_u32 s32, s54, 0x200
mf v[212:215],a[252:255],v[44:47],v[212:215]
ex v196
mf v[216:219],a[252:255],v[48:51],v[216:219]
tr a[244:245],v9,0
wl 3
mf v[208:211],a[232:235],v[52:55],v[208:211]
tr a[246:247],v9,1024
mf v[212:215],a[232:235],v[56:59],v[212:215]
ex v197
mf v[216:219],a[232:235],v[60:63],v[216:219]
tr a[248:249],v10,0
cv v232,v196,v197
mf v[208:211],a[236:239],v[64:67],v[208:211]
tr a[250:251],v10,1024
mf v[212:215],a[236:239],v[68:71],v[212:215]
ex v198
mf v[216:219],a[236:239],v[72:75],v[216:219]
tr a[252:253],v11,0
wl 5
mf a[216:219],a[228:231],v[220:223],a[216:219]
tr a[254:255],v11,1024
mf a[220:223],a[228:231],v[224:227],a[220:223]
ex v199
mf a[224:227],a[228:231],v[228:231],a[224:227]
tr a[232:233],v12,0
cv v233,v198,v199
mf v[76:79],a[240:243],v[220:223],v[76:79]
tr a[234:235],v12,1024
wl 5
mf v[80:83],a[240:243],v[224:227],v[80:83]
ex v200
mf v[84:87],a[240:243],v[228:231],v[84:87]
tr a[236:237],v13,0
dl v20,s[16:19],s32,0
mf v[88:91],a[244:247],v[220:223],v[88:91]
tr a[238:239],v13,1024
wl 5
mf v[92:95],a[244:247],v[224:227],v[92:95]
ex v201
mf v[96:99],a[244:247],v[228:231],v[96:99]
tr a[240:241],v14,0
dl v21,s[16:19],s32,1024
mf v[100:103],a[248:251],v[220:223],v[100:103]
tr a[242:243],v14,1024
cv v236,v200,v201
mf v[104:107],a[248:251],v[224:227],v[104:107]
ex v202
mf v[108:111],a[248:251],v[228:231],v[108:111]
tr a[244:245],v15,0
wl 5
mf v[112:115],a[252:255],v[220:223],v[112:115]
tr a[246:247],v15,1024
dl v22,s[16:19],s32,2048
mf v[116:119],a[252:255],v[224:227],v[116:119]
s_waitcnt vmcnt(23)
s_barrier
mf v[120:123],a[252:255],v[228:231],v[120:123]
tr a[248:249],v248,0
wl 5
mf v[124:127],a[232:235],v[220:223],v[124:127]
tr a[250:251],v248,2048
dl v23,s[16:19],s32,3072
mf v[128:131],a[232:235],v[224:227],v[128:131]
ex v203
mf v[132:135],a[232:235],v[228:231],v[132:135]
tr a[252:253],v248,8
cv v237,v202,v203
mf v[136:139],a[236:239],v[220:223],v[136:139]
tr a[254:255],v248,2056
wl 5
mf v[140:143],a[236:239],v[224:227],v[140:143]
ex v204
mf v[144:147],a[236:239],v[228:231],v[144:147]
tr a[232:233],v249,0
wl 5
mf v[148:151],a[240:243],v[220:223],v[148:151]
tr a[234:235],v249,2048
mf v[152:155],a[240:243],v[224:227],v[152:155]
ex v205
mf v[156:159],a[240:243],v[228:231],v[156:159]
tr a[236:237],v249,8
cv v240,v204,v205
mf v[160:163],a[244:247],v[220:223],v[160:163]
tr a[238:239],v249,2056
wl 5
mf v[164:167],a[244:247],v[224:227],v[164:167]
ex v206
mf v[168:171],a[244:247],v[228:231],v[168:171]
tr a[240:241],v250,0
wl 5
mf a[0:3],a[248:251],a[120:123],a[0:3]
tr a[242:243],v250,2048
mf a[4:7],a[248:251],a[124:127],a[4:7]
ex v207
mf a[8:11],a[248:251],a[128:131],a[8:11]
tr a[244:245],v250,8
cv v241,v206,v207
mf a[12:15],a[252:255],a[120:123],a[12:15]
tr a[246:247],v250,2056
wl 5
mf a[16:19],a[252:255],a[124:127],a[16:19]
ex v208
mf a[20:23],a[252:255],a[128:131],a[20:23]
tr a[248:249],v251,0
wl 5
mf a[24:27],a[232:235],a[120:123],a[24:27]
tr a[250:251],v251,2048
mf a[28:31],a[232:235],a[124:127],a[28:31]
ex v209
mf a[32:35],a[232:235],a[128:131],a[32:35]
tr a[252:253],v251,8
cv v234,v208,v209
mf a[36:39],a[236:239],a[120:123],a[36:39]
tr a[254:255],v251,2056
wl 5
mf a[40:43],a[236:239],a[124:127],a[40:43]
s_waitcnt vmcnt(20)
s_barrier
mf a[44:47],a[236:239],a[128:131],a[44:47]
rq a[232:235],v4,32768
s_add_u32 m0, s4, 0xc000
mf a[48:51],a[240:243],a[120:123],a[48:51]
ex v210
mf a[52:55],a[240:243],a[124:127],a[52:55]
ex v211
mf a[56:59],a[240:243],a[128:131],a[56:59]
rq a[236:239],v5,32768
s_add_u32 s32, s98, 0x1e000
wl 4
mf a[60:63],a[244:247],a[120:123],a[60:63]
ex v212
mf a[64:67],a[244:247],a[124:127],a[64:67]
ex v213
mf a[68:71],a[244:247],a[128:131],a[68:71]
rq a[240:243],v6,32768
s_and_b32 s32, s32, 0x1ffff
mf a[72:75],a[248:251],a[120:123],a[72:75]
ex v214
mf a[76:79],a[248:251],a[124:127],a[76:79]
ex v215
mf a[80:83],a[248:251],a[128:131],a[80:83]
rq a[244:247],v7,32768
cv v235,v210,v211
wl 3
mf a[84:87],a[252:255],a[120:123],a[84:87]
ex v216
mf a[88:91],a[252:255],a[124:127],a[88:91]
ex v217
mf a[92:95],a[252:255],a[128:131],a[92:95]
rq a[248:251],v4,33792
cv v238,v212,v213
mf v[172:175],a[232:235],v[28:31],v[244:247]
ex v218
mf v[176:179],a[232:235],v[32:35],v[244:247]
ex v219
mf v[180:183],a[232:235],v[36:39],v[244:247]
rq a[252:255],v5,33792
dn v18,s[12:15],s32,0
wl 3
mf v[172:175],a[236:239],v[40:43],v[172:175]
dn v18,s[12:15],s32,1024
mf v[176:179],a[236:239],v[44:47],v[176:179]
dn v19,s[12:15],s32,2048
mf v[180:183],a[236:239],v[48:51],v[180:183]
rq a[232:235],v6,33792
dn v19,s[12:15],s32,3072
mf v[172:175],a[240:243],v[52:55],v[172:175]
rq a[236:239],v7,33792
s_add_u32 m0, s4, 0x24000
mf v[176:179],a[240:243],v[56:59],v[176:179]
s_add_u32 s32, s54, 0x40200
cv v239,v214,v215
mf v[180:183],a[240:243],v[60:63],v[180:183]
dl v20,s[16:19],s32,0
wl 3
mf v[172:175],a[244:247],v[64:67],v[172:175]
dl v21,s[16:19],s32,1024
mf v[176:179],a[244:247],v[68:71],v[176:179]
dl v22,s[16:19],s32,2048
mf v[180:183],a[244:247],v[72:75],v[180:183]
dl v23,s[16:19],s32,3072
mf v[184:187],a[248:251],v[28:31],v[244:247]
cv v242,v216,v217
cv v243,v218,v219
mf v[188:191],a[248:251],v[32:35],v[244:247]
s_waitcnt vmcnt(24)
s_barrier
mf v[192:195],a[248:251],v[36:39],v[244:247]
tr a[240:241],v8,16384
s_add_u32 m0, s4, 0x18000
wl 1
mf v[184:187],a[252:255],v[40:43],v[184:187]
tr a[242:243],v8,17408
s_add_u32 s32, s55, 0x200
mf v[188:191],a[252:255],v[44:47],v[188:191]
ex v172
mf v[192:195],a[252:255],v[48:51],v[192:195]
tr a[244:245],v9,16384
mf v[184:187],a[232:235],v[52:55],v[184:187]
tr a[246:247],v9,17408
mf v[188:191],a[232:235],v[56:59],v[188:191]
ex v173
mf v[192:195],a[232:235],v[60:63],v[192:195]
tr a[248:249],v10,16384
cv v220,v172,v173
mf v[184:187],a[236:239],v[64:67],v[184:187]
tr a[250:251],v10,17408
mf v[188:191],a[236:239],v[68:71],v[188:191]
ex v174
mf v[192:195],a[236:239],v[72:75],v[192:195]
tr a[252:253],v11,16384
wl 5
mf a[216:219],a[228:231],v[232:235],a[216:219]
tr a[254:255],v11,17408
mf a[220:223],a[228:231],v[236:239],a[220:223]
ex v175
mf a[224:227],a[228:231],v[240:243],a[224:227]
tr a[232:233],v12,16384
cv v221,v174,v175
mf v[76:79],a[240:243],v[232:235],v[76:79]
tr a[234:235],v12,17408
wl 5
mf v[80:83],a[240:243],v[236:239],v[80:83]
ex v176
mf v[84:87],a[240:243],v[240:243],v[84:87]
tr a[236:237],v13,16384
dl v20,s[16:19],s32,0
mf v[88:91],a[244:247],v[232:235],v[88:91]
tr a[238:239],v13,17408
wl 5
mf v[92:95],a[244:247],v[236:239],v[92:95]
ex v177
mf v[96:99],a[244:247],v[240:243],v[96:99]
tr a[240:241],v14,16384
dl v21,s[16:19],s32,1024
mf v[100:103],a[248:251],v[232:235],v[100:103]
tr a[242:243],v14,17408
cv v224,v176,v177
mf v[104:107],a[248:251],v[236:239],v[104:107]
ex v178
mf v[108:111],a[248:251],v[240:243],v[108:111]
tr a[244:245],v15,16384
wl 5
mf v[112:115],a[252:255],v[232:235],v[112:115]
tr a[246:247],v15,17408
dl v22,s[16:19],s32,2048
mf v[116:119],a[252:255],v[236:239],v[116:119]
s_waitcnt vmcnt(23)
s_barrier
mf v[120:123],a[252:255],v[240:243],v[120:123]
tr a[248:249],v248,16384
wl 5
mf v[124:127],a[232:235],v[232:235],v[124:127]
tr a[250:251],v248,18432
dl v23,s[16:19],s32,3072
mf v[128:131],a[232:235],v[236:239],v[128:131]
ex v179
mf v[132:135],a[232:235],v[240:243],v[132:135]
tr a[252:253],v248,16392
cv v225,v178,v179
mf v[136:139],a[236:239],v[232:235],v[136:139]
tr a[254:255],v248,18440
wl 5
mf v[140:143],a[236:239],v[236:239],v[140:143]
ex v180
mf v[144:147],a[236:239],v[240:243],v[144:147]
tr a[232:233],v249,16384
wl 5
mf v[148:151],a[240:243],v[232:235],v[148:151]
tr a[234:235],v249,18432
mf v[152:155],a[240:243],v[236:239],v[152:155]
ex v181
mf v[156:159],a[240:243],v[240:243],v[156:159]
tr a[236:237],v249,16392
cv v228,v180,v181
mf v[160:163],a[244:247],v[232:235],v[160:163]
tr a[238:239],v249,18440
wl 5
mf v[164:167],a[244:247],v[236:239],v[164:167]
ex v182
mf v[168:171],a[244:247],v[240:243],v[168:171]
tr a[240:241],v250,16384
wl 5
mf a[0:3],a[248:251],a[132:135],a[0:3]
tr a[242:243],v250,18432
mf a[4:7],a[248:251],a[136:139],a[4:7]
ex v183
mf a[8:11],a[248:251],a[140:143],a[8:11]
tr a[244:245],v250,16392
cv v229,v182,v183
mf a[12:15],a[252:255],a[132:135],a[12:15]
tr a[246:247],v250,18440
wl 5
mf a[16:19],a[252:255],a[136:139],a[16:19]
ex v184
mf a[20:23],a[252:255],a[140:143],a[20:23]
tr a[248:249],v251,16384
wl 5
mf a[24:27],a[232:235],a[132:135],a[24:27]
tr a[250:251],v251,18432
mf a[28:31],a[232:235],a[136:139],a[28:31]
ex v185
mf a[32:35],a[232:235],a[140:143],a[32:35]
tr a[252:253],v251,16392
cv v222,v184,v185
mf a[36:39],a[236:239],a[132:135],a[36:39]
tr a[254:255],v251,18440
wl 5
mf a[40:43],a[236:239],a[136:139],a[40:43]
s_waitcnt vmcnt(20)
s_barrier
mf a[44:47],a[236:239],a[140:143],a[44:47]
rq a[232:235],v4,0
v_add_u32 v16, 0x40000, v16
mf a[48:51],a[240:243],a[132:135],a[48:51]
ex v186
mf a[52:55],a[240:243],a[136:139],a[52:55]
ex v187
mf a[56:59],a[240:243],a[140:143],a[56:59]
rq a[236:239],v5,0
cv v223,v186,v187
wl 4
mf a[60:63],a[244:247],a[132:135],a[60:63]
ex v188
mf a[64:67],a[244:247],a[136:139],a[64:67]
ex v189
mf a[68:71],a[244:247],a[140:143],a[68:71]
rq a[240:243],v6,0
cv v226,v188,v189
mf a[72:75],a[248:251],a[132:135],a[72:75]
ex v190
mf a[76:79],a[248:251],a[136:139],a[76:79]
ex v191
mf a[80:83],a[248:251],a[140:143],a[80:83]
rq a[244:247],v7,0
cv v227,v190,v191
wl 3
mf a[84:87],a[252:255],a[132:135],a[84:87]
ex v192
mf a[88:91],a[252:255],a[136:139],a[88:91]
ex v193
mf a[92:95],a[252:255],a[140:143],a[92:95]
rq a[248:251],v4,1024
cv v230,v192,v193
mf v[196:199],a[232:235],v[28:31],v[244:247]
ex v194
mf v[200:203],a[232:235],v[32:35],v[244:247]
ex v195
mf v[204:207],a[232:235],v[36:39],v[244:247]
rq a[252:255],v5,1024
cv v231,v194,v195
wl 3
mf v[196:199],a[236:239],v[40:43],v[196:199]
rq a[232:235],v6,1024
v_add_u32 v17, 0x40000, v17
mf v[200:203],a[236:239],v[44:47],v[200:203]
s_add_u32 m0, s4, 0x4000
s_add_u32 s32, s98, 0x0
mf v[204:207],a[236:239],v[48:51],v[204:207]
rq a[236:239],v7,1024
s_and_b32 s32, s32, 0x1ffff
mf v[196:199],a[240:243],v[52:55],v[196:199]
dn v16,s[8:11],s32,0
mf v[200:203],a[240:243],v[56:59],v[200:203]
dn v16,s[8:11],s32,1024
mf v[204:207],a[240:243],v[60:63],v[204:207]
dn v17,s[8:11],s32,2048
wl 3
mf v[196:199],a[244:247],v[64:67],v[196:199]
dn v17,s[8:11],s32,3072
mf v[200:203],a[244:247],v[68:71],v[200:203]
mf v[204:207],a[244:247],v[72:75],v[204:207]
wl 1
mf v[208:211],a[248:251],v[28:31],v[244:247]
mf v[212:215],a[248:251],v[32:35],v[244:247]
s_waitcnt vmcnt(20)
s_barrier
mf v[216:219],a[248:251],v[36:39],v[244:247]
tr a[240:241],v8,32768
s_add_u32 m0, s4, 0x1c000
mf v[208:211],a[252:255],v[40:43],v[208:211]
tr a[242:243],v8,33792
s_add_u32 s32, s55, 0x40200
mf v[212:215],a[252:255],v[44:47],v[212:215]
ex v196
mf v[216:219],a[252:255],v[48:51],v[216:219]
tr a[244:245],v9,32768
wl 3
mf v[208:211],a[232:235],v[52:55],v[208:211]
tr a[246:247],v9,33792
mf v[212:215],a[232:235],v[56:59],v[212:215]
ex v197
mf v[216:219],a[232:235],v[60:63],v[216:219]
tr a[248:249],v10,32768
cv v232,v196,v197
mf v[208:211],a[236:239],v[64:67],v[208:211]
tr a[250:251],v10,33792
mf v[212:215],a[236:239],v[68:71],v[212:215]
ex v198
mf v[216:219],a[236:239],v[72:75],v[216:219]
tr a[252:253],v11,32768
wl 5
mf a[216:219],a[228:231],v[220:223],a[216:219]
tr a[254:255],v11,33792
mf a[220:223],a[228:231],v[224:227],a[220:223]
ex v199
mf a[224:227],a[228:231],v[228:231],a[224:227]
tr a[232:233],v12,32768
dl v20,s[16:19],s32,0
mf v[76:79],a[240:243],v[220:223],v[76:79]
tr a[234:235],v12,33792
dl v21,s[16:19],s32,1024
mf v[80:83],a[240:243],v[224:227],v[80:83]
ex v200
mf v[84:87],a[240:243],v[228:231],v[84:87]
tr a[236:237],v13,32768
dl v22,s[16:19],s32,2048
wl 5
mf v[88:91],a[244:247],v[220:223],v[88:91]
tr a[238:239],v13,33792
cv v233,v198,v199
mf v[92:95],a[244:247],v[224:227],v[92:95]
ex v201
mf v[96:99],a[244:247],v[228:231],v[96:99]
tr a[240:241],v14,32768
dl v23,s[16:19],s32,3072
mf v[100:103],a[248:251],v[220:223],v[100:103]
tr a[242:243],v14,33792
s_add_u32 m0, s4, 0x8000
mf v[104:107],a[248:251],v[224:227],v[104:107]
ex v202
mf v[108:111],a[248:251],v[228:231],v[108:111]
tr a[244:245],v15,32768
s_add_u32 s32, s98, 0x2000
wl 5
mf v[112:115],a[252:255],v[220:223],v[112:115]
tr a[246:247],v15,33792
s_and_b32 s32, s32, 0x1ffff
mf v[116:119],a[252:255],v[224:227],v[116:119]
s_waitcnt vmcnt(20)
s_barrier
mf v[120:123],a[252:255],v[228:231],v[120:123]
tr a[248:249],v248,32768
dn v16,s[8:11],s32,0
mf v[124:127],a[232:235],v[220:223],v[124:127]
tr a[250:251],v248,34816
dn v16,s[8:11],s32,1024
mf v[128:131],a[232:235],v[224:227],v[128:131]
ex v203
mf v[132:135],a[232:235],v[228:231],v[132:135]
tr a[252:253],v248,32776
dn v17,s[8:11],s32,2048
wl 5
mf v[136:139],a[236:239],v[220:223],v[136:139]
tr a[254:255],v248,34824
dn v17,s[8:11],s32,3072
mf v[140:143],a[236:239],v[224:227],v[140:143]
ex v204
mf v[144:147],a[236:239],v[228:231],v[144:147]
tr a[232:233],v249,32768
cv v236,v200,v201
mf v[148:151],a[240:243],v[220:223],v[148:151]
tr a[234:235],v249,34816
cv v237,v202,v203
mf v[152:155],a[240:243],v[224:227],v[152:155]
ex v205
mf v[156:159],a[240:243],v[228:231],v[156:159]
tr a[236:237],v249,32776
cv v240,v204,v205
wl 5
mf v[160:163],a[244:247],v[220:223],v[160:163]
tr a[238:239],v249,34824
v_add_u32 v18, 0x40000, v18
mf v[164:167],a[244:247],v[224:227],v[164:167]
ex v206
mf v[168:171],a[244:247],v[228:231],v[168:171]
tr a[240:241],v250,32768
v_add_u32 v19, 0x40000, v19
mf a[0:3],a[248:251],a[144:147],a[0:3]
tr a[242:243],v250,34816
s_add_u32 m0, s4, 0x10000
mf a[4:7],a[248:251],a[148:151],a[4:7]
ex v207
mf a[8:11],a[248:251],a[152:155],a[8:11]
tr a[244:245],v250,32776
s_add_u32 s32, s98, 0x0
wl 5
mf a[12:15],a[252:255],a[144:147],a[12:15]
tr a[246:247],v250,34824
s_and_b32 s32, s32, 0x1ffff
mf a[16:19],a[252:255],a[148:151],a[16:19]
ex v208
mf a[20:23],a[252:255],a[152:155],a[20:23]
tr a[248:249],v251,32768
cv v241,v206,v207
mf a[24:27],a[232:235],a[144:147],a[24:27]
tr a[250:251],v251,34816
wl 5
mf a[28:31],a[232:235],a[148:151],a[28:31]
ex v209
mf a[32:35],a[232:235],a[152:155],a[32:35]
tr a[252:253],v251,32776
cv v234,v208,v209
mf a[36:39],a[236:239],a[144:147],a[36:39]
tr a[254:255],v251,34824
wl 5
mf a[40:43],a[236:239],a[148:151],a[40:43]
s_waitcnt vmcnt(20)
s_barrier
mf a[44:47],a[236:239],a[152:155],a[44:47]
ex v210
mf a[48:51],a[240:243],a[144:147],a[48:51]
ex v211
mf a[52:55],a[240:243],a[148:151],a[52:55]
ex v212
mf a[56:59],a[240:243],a[152:155],a[56:59]
tr a[232:233],v8,0
dn v18,s[12:15],s32,0
wl 3
mf a[60:63],a[244:247],a[144:147],a[60:63]
tr a[234:235],v8,1024
dn v18,s[12:15],s32,1024
mf a[64:67],a[244:247],a[148:151],a[64:67]
ex v213
mf a[68:71],a[244:247],a[152:155],a[68:71]
tr a[236:237],v9,0
dn v19,s[12:15],s32,2048
mf a[72:75],a[248:251],a[144:147],a[72:75]
tr a[238:239],v9,1024
dn v19,s[12:15],s32,3072
mf a[76:79],a[248:251],a[148:151],a[76:79]
ex v214
mf a[80:83],a[248:251],a[152:155],a[80:83]
tr a[240:241],v10,0
s_add_u32 m0, s4, 0x0
wl 5
mf a[84:87],a[252:255],a[144:147],a[84:87]
tr a[242:243],v10,1024
s_add_u32 s32, s98, 0x4000
mf a[88:91],a[252:255],a[148:151],a[88:91]
ex v215
ex v216
ex v217
ex v218
ex v219
mf a[92:95],a[252:255],a[152:155],a[92:95]
cv v235,v210,v211
cv v238,v212,v213
cv v239,v214,v215
cv v242,v216,v217
cv v243,v218,v219
mf a[216:219],a[228:231],v[232:235],a[216:219]
tr a[244:245],v11,0
s_and_b32 s32, s32, 0x1ffff
mf a[220:223],a[228:231],v[236:239],a[220:223]
tr a[246:247],v11,1024
wl 4
mf a[224:227],a[228:231],v[240:243],a[224:227]
tr a[248:249],v12,0
mf v[76:79],a[232:235],v[232:235],v[76:79]
tr a[250:251],v12,1024
mf v[80:83],a[232:235],v[236:239],v[80:83]
dn v16,s[8:11],s32,0
mf v[84:87],a[232:235],v[240:243],v[84:87]
v_accvgpr_read_b32 v244, a216
v_accvgpr_read_b32 v246, a220
v_accvgpr_read_b32 v254, a224
v_add_f32 v245, v244, v246
v_min3_f32 v247, v244, v246, v254
v_add_f32 v245, v245, v254
s_mov_b32 s48, 0x5d800000
s_mov_b32 s49, 0x21800000
v_cmp_nge_f32 vcc, s48, v245
v_cmp_nle_f32 s[50:51], s49, v247
s_nop 1
s_or_b64 vcc, vcc, s[50:51]
s_cbranch_vccz L_ok0
s_mov_b32 s48, 0x0
s_getpc_b64 s[6:7]
s_add_u32 s6, s6, 12
s_addc_u32 s7, s7, 0
s_branch L_slow
L_ok0:
mf v[88:91],a[236:239],v[232:235],v[88:91]
tr a[252:253],v13,0
v_lshlrev_b32 v25, 4, v0
mf v[92:95],a[236:239],v[236:239],v[92:95]
tr a[254:255],v13,1024
s_mul_i32 s37, s3, 4096
mf v[96:99],a[236:239],v[240:243],v[96:99]
tr a[232:233],v14,0
v_add_u32 v26, s37, v25
wl 5
mf v[100:103],a[240:243],v[232:235],v[100:103]
v_rcp_f32 v244, v244
v_rcp_f32 v246, v246
v_rcp_f32 v254, v254
mf v[104:107],a[240:243],v[236:239],v[104:107]
tr a[234:235],v14,1024
s_mul_i32 s37, s39, 4096
mf v[108:111],a[240:243],v[240:243],v[108:111]
tr a[236:237],v15,0
dn v16,s[8:11],s32,1024
mf v[112:115],a[244:247],v[232:235],v[112:115]
tr a[238:239],v15,1024
v_add_u32 v27, s37, v25
mf v[116:119],a[244:247],v[236:239],v[116:119]
s_waitcnt vmcnt(22)
s_barrier
mf v[120:123],a[244:247],v[240:243],v[120:123]
tr a[240:241],v248,49152
v_add_u32 v26, 0x20000, v26
wl 5
mf v[124:127],a[248:251],v[232:235],v[124:127]
tr a[242:243],v248,51200
dn v17,s[8:11],s32,2048
mf v[128:131],a[248:251],v[236:239],v[128:131]
v_add_u32 v27, 0x20000, v27
v_mul_f32 v76, v244, v76
mf v[132:135],a[248:251],v[240:243],v[132:135]
tr a[244:245],v248,49160
dn v17,s[8:11],s32,3072
mf v[136:139],a[252:255],v[232:235],v[136:139]
tr a[246:247],v248,51208
s_add_u32 m0, s4, 0x14000
mf v[140:143],a[252:255],v[236:239],v[140:143]
tr a[248:249],v249,49152
s_add_u32 s32, s98, 0x2000
mf v[144:147],a[252:255],v[240:243],v[144:147]
tr a[250:251],v249,51200
s_and_b32 s32, s32, 0x1ffff
wl 6
mf v[148:151],a[232:235],v[232:235],v[148:151]
dn v18,s[12:15],s32,0
mf v[152:155],a[232:235],v[236:239],v[152:155]
tr a[252:253],v249,49160
v_mul_f32 v80, v246, v80
mf v[156:159],a[232:235],v[240:243],v[156:159]
dn v18,s[12:15],s32,1024
mf v[160:163],a[236:239],v[232:235],v[160:163]
tr a[254:255],v249,51208
v_mul_f32 v84, v254, v84
mf v[164:167],a[236:239],v[236:239],v[164:167]
tr a[232:233],v250,49152
v_mul_f32 v77, v244, v77
mf v[168:171],a[236:239],v[240:243],v[168:171]
dn v19,s[12:15],s32,2048
wl 4
mf a[0:3],a[240:243],a[156:159],a[0:3]
tr a[234:235],v250,51200
v_mul_f32 v81, v246, v81
mf a[4:7],a[240:243],a[160:163],a[4:7]
dn v19,s[12:15],s32,3072
mf a[8:11],a[240:243],a[164:167],a[8:11]
tr a[236:237],v250,49160
v_mul_f32 v85, v254, v85
mf a[12:15],a[244:247],a[156:159],a[12:15]
tr a[238:239],v250,51208
v_mul_f32 v78, v244, v78
mf a[16:19],a[244:247],a[160:163],a[16:19]
tr a[240:241],v251,49152
v_mul_f32 v82, v246, v82
mf a[20:23],a[244:247],a[164:167],a[20:23]
tr a[242:243],v251,51200
v_mul_f32 v86, v254, v86
wl 5
mf a[24:27],a[248:251],a[156:159],a[24:27]
tr a[244:245],v251,49160
v_mul_f32 v79, v244, v79
mf a[28:31],a[248:251],a[160:163],a[28:31]
tr a[246:247],v251,51208
v_mul_f32 v83, v246, v83
mf a[32:35],a[248:251],a[164:167],a[32:35]
v_mul_f32 v87, v254, v87
v_mul_f32 v88, v244, v88
mf a[36:39],a[252:255],a[156:159],a[36:39]
v_mul_f32 v92, v246, v92
v_mul_f32 v96, v254, v96
mf a[40:43],a[252:255],a[160:163],a[40:43]
s_waitcnt vmcnt(16)
s_barrier
mf a[44:47],a[252:255],a[164:167],a[44:47]
tr a[248:249],v248,0
v_mul_f32 v89, v244, v89
wl 4
mf a[48:51],a[232:235],a[156:159],a[48:51]
tr a[250:251],v248,2048
v_mul_f32 v93, v246, v93
mf a[52:55],a[232:235],a[160:163],a[52:55]
tr a[252:253],v248,16384
v_mul_f32 v97, v254, v97
mf a[56:59],a[232:235],a[164:167],a[56:59]
tr a[254:255],v248,18432
v_mul_f32 v90, v244, v90
mf a[60:63],a[236:239],a[156:159],a[60:63]
tr a[232:233],v248,8
v_mul_f32 v94, v246, v94
mf a[64:67],a[236:239],a[160:163],a[64:67]
tr a[234:235],v248,2056
v_mul_f32 v98, v254, v98
mf a[68:71],a[236:239],a[164:167],a[68:71]
tr a[236:237],v248,16392
v_mul_f32 v91, v244, v91
wl 7
mf a[72:75],a[240:243],a[156:159],a[72:75]
tr a[238:239],v248,18440
v_mul_f32 v95, v246, v95
mf a[76:79],a[240:243],a[160:163],a[76:79]
v_mul_f32 v99, v254, v99
cv v76,v76,v77
mf a[80:83],a[240:243],a[164:167],a[80:83]
tr a[240:241],v249,0
cv v80,v80,v81
mf a[84:87],a[244:247],a[156:159],a[84:87]
tr a[242:243],v249,2048
cv v84,v84,v85
mf a[88:91],a[244:247],a[160:163],a[88:91]
cv v77,v78,v79
cv v81,v82,v83
mf a[92:95],a[244:247],a[164:167],a[92:95]
tr a[244:245],v249,16384
cv v85,v86,v87
wl 5
mf a[0:3],a[248:251],a[168:171],a[0:3]
tr a[246:247],v249,18432
cv v78,v88,v89
mf a[4:7],a[248:251],a[172:175],a[4:7]
cv v82,v92,v93
cv v86,v96,v97
mf a[8:11],a[248:251],a[176:179],a[8:11]
tr a[248:249],v249,8
cv v79,v90,v91
mf a[0:3],a[252:255],a[180:183],a[0:3]
ds_write_b128 v26, v[76:79] offset:0
cv v83,v94,v95
mf a[4:7],a[252:255],a[184:187],a[4:7]
ds_write_b128 v26, v[80:83] offset:1024
cv v87,v98,v99
mf a[8:11],a[252:255],a[188:191],a[8:11]
ds_write_b128 v26, v[84:87] offset:2048
v_mul_f32 v100, v244, v100
mf a[12:15],a[232:235],a[168:171],a[12:15]
tr a[250:251],v249,2056
v_mul_f32 v104, v246, v104
mf a[16:19],a[232:235],a[172:175],a[16:19]
tr a[252:253],v249,16392
v_mul_f32 v108, v254, v108
mf a[20:23],a[232:235],a[176:179],a[20:23]
tr a[254:255],v249,18440
v_mul_f32 v101, v244, v101
wl 7
mf a[12:15],a[236:239],a[180:183],a[12:15]
tr a[232:233],v250,0
v_mul_f32 v105, v246, v105
mf a[16:19],a[236:239],a[184:187],a[16:19]
tr a[234:235],v250,2048
v_mul_f32 v109, v254, v109
mf a[20:23],a[236:239],a[188:191],a[20:23]
tr a[236:237],v250,16384
v_mul_f32 v102, v244, v102
mf a[24:27],a[240:243],a[168:171],a[24:27]
tr a[238:239],v250,18432
v_mul_f32 v106, v246, v106
mf a[28:31],a[240:243],a[172:175],a[28:31]
v_mul_f32 v110, v254, v110
v_mul_f32 v103, v244, v103
mf a[32:35],a[240:243],a[176:179],a[32:35]
tr a[240:241],v250,8
v_mul_f32 v107, v246, v107
mf a[24:27],a[244:247],a[180:183],a[24:27]
tr a[242:243],v250,2056
v_mul_f32 v111, v254, v111
mf a[28:31],a[244:247],a[184:187],a[28:31]
v_mul_f32 v112, v244, v112
v_mul_f32 v116, v246, v116
mf a[32:35],a[244:247],a[188:191],a[32:35]
tr a[244:245],v250,16392
v_mul_f32 v120, v254, v120
wl 5
mf a[36:39],a[248:251],a[168:171],a[36:39]
tr a[246:247],v250,18440
v_mul_f32 v113, v244, v113
mf a[40:43],a[248:251],a[172:175],a[40:43]
v_mul_f32 v117, v246, v117
v_mul_f32 v121, v254, v121
mf a[44:47],a[248:251],a[176:179],a[44:47]
tr a[248:249],v251,0
v_mul_f32 v114, v244, v114
mf a[36:39],a[252:255],a[180:183],a[36:39]
tr a[250:251],v251,2048
v_mul_f32 v118, v246, v118
mf a[40:43],a[252:255],a[184:187],a[40:43]
v_mul_f32 v122, v254, v122
v_mul_f32 v115, v244, v115
mf a[44:47],a[252:255],a[188:191],a[44:47]
tr a[252:253],v251,16384
v_mul_f32 v119, v246, v119
mf a[48:51],a[232:235],a[168:171],a[48:51]
tr a[254:255],v251,18432
v_mul_f32 v123, v254, v123
mf a[52:55],a[232:235],a[172:175],a[52:55]
cv v100,v100,v101
cv v104,v104,v105
mf a[56:59],a[232:235],a[176:179],a[56:59]
tr a[232:233],v251,8
cv v108,v108,v109
wl 5
mf a[48:51],a[236:239],a[180:183],a[48:51]
tr a[234:235],v251,2056
cv v101,v102,v103
mf a[52:55],a[236:239],a[184:187],a[52:55]
cv v105,v106,v107
cv v109,v110,v111
mf a[56:59],a[236:239],a[188:191],a[56:59]
tr a[236:237],v251,16392
cv v102,v112,v113
mf a[60:63],a[240:243],a[168:171],a[60:63]
cv v103,v114,v115
cv v106,v116,v117
mf a[64:67],a[240:243],a[172:175],a[64:67]
ds_write_b128 v26, v[100:103] offset:3072
cv v110,v120,v121
mf a[68:71],a[240:243],a[176:179],a[68:71]
tr a[238:239],v251,18440
cv v107,v118,v119
mf a[60:63],a[244:247],a[180:183],a[60:63]
cv v111,v122,v123
v_mul_f32 v124, v244, v124
mf a[64:67],a[244:247],a[184:187],a[64:67]
wl 1
s_barrier
mf a[68:71],a[244:247],a[188:191],a[68:71]
ds_write_b128 v26, v[104:107] offset:16384
s_add_u32 m0, s4, 0xc000
mf a[72:75],a[248:251],a[168:171],a[72:75]
ds_write_b128 v26, v[108:111] offset:17408
v_mul_f32 v128, v246, v128
mf a[76:79],a[248:251],a[172:175],a[76:79]
rq a[96:99],v27,0
v_mul_f32 v132, v254, v132
mf a[80:83],a[248:251],a[176:179],a[80:83]
rq a[240:243],v4,16384
v_mul_f32 v125, v244, v125
mf a[72:75],a[252:255],a[180:183],a[72:75]
rq a[144:147],v27,8192
v_mul_f32 v129, v246, v129
mf a[76:79],a[252:255],a[184:187],a[76:79]
rq a[100:103],v27,1024
s_add_u32 s32, s98, 0x4000
mf a[80:83],a[252:255],a[188:191],a[80:83]
rq a[244:247],v5,16384
v_mul_f32 v133, v254, v133
mf a[84:87],a[232:235],a[168:171],a[84:87]
rq a[148:151],v27,9216
v_mul_f32 v126, v244, v126
mf a[88:91],a[232:235],a[172:175],a[88:91]
rq a[104:107],v27,2048
v_mul_f32 v130, v246, v130
mf a[92:95],a[232:235],a[176:179],a[92:95]
rq a[248:251],v6,16384
v_mul_f32 v134, v254, v134
wl 7
mf a[84:87],a[236:239],a[180:183],a[84:87]
rq a[152:155],v27,10240
s_and_b32 s32, s32, 0x1ffff
mf a[88:91],a[236:239],a[184:187],a[88:91]
rq a[108:111],v27,3072
v_mul_f32 v127, v244, v127
mf a[92:95],a[236:239],a[188:191],a[92:95]
v_mul_f32 v131, v246, v131
v_mul_f32 v135, v254, v135
v_mul_f32 v136, v244, v136
v_mul_f32 v140, v246, v140
v_mul_f32 v144, v254, v144
v_mul_f32 v137, v244, v137
v_mul_f32 v141, v246, v141
v_mul_f32 v145, v254, v145
v_mul_f32 v138, v244, v138
v_mul_f32 v142, v246, v142
v_mul_f32 v146, v254, v146
v_mul_f32 v139, v244, v139
v_mul_f32 v143, v246, v143
v_mul_f32 v147, v254, v147
cv v124,v124,v125
cv v128,v128,v129
cv v132,v132,v133
cv v125,v126,v127
cv v129,v130,v131
cv v133,v134,v135
cv v126,v136,v137
cv v130,v140,v141
cv v134,v144,v145
cv v127,v138,v139
cv v131,v142,v143
cv v135,v146,v147
v_mul_f32 v148, v244, v148
v_mul_f32 v152, v246, v152
v_mul_f32 v156, v254, v156
v_mul_f32 v149, v244, v149
v_mul_f32 v153, v246, v153
v_mul_f32 v157, v254, v157
v_mul_f32 v150, v244, v150
v_mul_f32 v154, v246, v154
v_mul_f32 v158, v254, v158
v_mul_f32 v151, v244, v151
v_mul_f32 v155, v246, v155
v_mul_f32 v159, v254, v159
v_mul_f32 v160, v244, v160
v_mul_f32 v164, v246, v164
v_mul_f32 v168, v254, v168
v_mul_f32 v161, v244, v161
v_mul_f32 v165, v246, v165
v_mul_f32 v169, v254, v169
v_mul_f32 v162, v244, v162
v_mul_f32 v166, v246, v166
v_mul_f32 v170, v254, v170
v_mul_f32 v163, v244, v163
v_mul_f32 v167, v246, v167
v_mul_f32 v171, v254, v171
cv v148,v148,v149
cv v152,v152,v153
cv v156,v156,v157
cv v149,v150,v151
cv v153,v154,v155
cv v157,v158,v159
cv v150,v160,v161
cv v154,v164,v165
cv v158,v168,v169
cv v151,v162,v163
cv v155,v166,v167
cv v159,v170,v171
v_accvgpr_read_b32 v172, a0
v_accvgpr_read_b32 v180, a4
v_accvgpr_read_b32 v188, a8
v_accvgpr_read_b32 v173, a1
v_accvgpr_read_b32 v174, a2
v_accvgpr_read_b32 v175, a3
v_accvgpr_read_b32 v176, a12
v_accvgpr_read_b32 v177, a13
v_accvgpr_read_b32 v178, a14
v_accvgpr_read_b32 v179, a15
v_pk_mul_f32 v[172:173], v[172:173], s[34:35]
v_pk_mul_f32 v[174:175], v[174:175], s[34:35]
v_pk_mul_f32 v[176:177], v[176:177], s[34:35]
v_pk_mul_f32 v[178:179], v[178:179], s[34:35]
cv v28,v172,v173
cv v29,v174,v175
cv v30,v176,v177
cv v31,v178,v179
v_accvgpr_read_b32 v172, a24
v_accvgpr_read_b32 v181, a5
v_accvgpr_read_b32 v182, a6
v_accvgpr_read_b32 v183, a7
v_accvgpr_read_b32 v184, a16
v_accvgpr_read_b32 v185, a17
v_accvgpr_read_b32 v186, a18
v_accvgpr_read_b32 v187, a19
v_pk_mul_f32 v[180:181], v[180:181], s[34:35]
v_pk_mul_f32 v[182:183], v[182:183], s[34:35]
v_pk_mul_f32 v[184:185], v[184:185], s[34:35]
v_pk_mul_f32 v[186:187], v[186:187], s[34:35]
cv v32,v180,v181
cv v33,v182,v183
cv v34,v184,v185
cv v35,v186,v187
v_accvgpr_read_b32 v180, a28
v_accvgpr_read_b32 v189, a9
v_accvgpr_read_b32 v190, a10
v_accvgpr_read_b32 v191, a11
v_accvgpr_read_b32 v192, a20
v_accvgpr_read_b32 v193, a21
v_accvgpr_read_b32 v194, a22
v_accvgpr_read_b32 v195, a23
v_pk_mul_f32 v[188:189], v[188:189], s[34:35]
v_pk_mul_f32 v[190:191], v[190:191], s[34:35]
v_pk_mul_f32 v[192:193], v[192:193], s[34:35]
v_pk_mul_f32 v[194:195], v[194:195], s[34:35]
cv v36,v188,v189
cv v37,v190,v191
cv v38,v192,v193
cv v39,v194,v195
v_accvgpr_read_b32 v188, a32
v_accvgpr_read_b32 v173, a25
v_accvgpr_read_b32 v174, a26
v_accvgpr_read_b32 v175, a27
v_accvgpr_read_b32 v176, a36
v_accvgpr_read_b32 v177, a37
v_accvgpr_read_b32 v178, a38
v_accvgpr_read_b32 v179, a39
v_pk_mul_f32 v[172:173], v[172:173], s[34:35]
v_pk_mul_f32 v[174:175], v[174:175], s[34:35]
v_pk_mul_f32 v[176:177], v[176:177], s[34:35]
v_pk_mul_f32 v[178:179], v[178:179], s[34:35]
cv v40,v172,v173
cv v41,v174,v175
cv v42,v176,v177
cv v43,v178,v179
v_accvgpr_read_b32 v172, a48
v_accvgpr_read_b32 v181, a29
v_accvgpr_read_b32 v182, a30
v_accvgpr_read_b32 v183, a31
v_accvgpr_read_b32 v184, a40
v_accvgpr_read_b32 v185, a41
v_accvgpr_read_b32 v186, a42
v_accvgpr_read_b32 v187, a43
v_pk_mul_f32 v[180:181], v[180:181], s[34:35]
v_pk_mul_f32 v[182:183], v[182:183], s[34:35]
v_pk_mul_f32 v[184:185], v[184:185], s[34:35]
v_pk_mul_f32 v[186:187], v[186:187], s[34:35]
cv v44,v180,v181
cv v45,v182,v183
cv v46,v184,v185
cv v47,v186,v187
v_accvgpr_read_b32 v180, a52
v_accvgpr_read_b32 v189, a33
v_accvgpr_read_b32 v190, a34
v_accvgpr_read_b32 v191, a35
v_accvgpr_read_b32 v192, a44
v_accvgpr_read_b32 v193, a45
v_accvgpr_read_b32 v194, a46
v_accvgpr_read_b32 v195, a47
v_pk_mul_f32 v[188:189], v[188:189], s[34:35]
v_pk_mul_f32 v[190:191], v[190:191], s[34:35]
v_pk_mul_f32 v[192:193], v[192:193], s[34:35]
v_pk_mul_f32 v[194:195], v[194:195], s[34:35]
cv v48,v188,v189
cv v49,v190,v191
cv v50,v192,v193
cv v51,v194,v195
v_accvgpr_read_b32 v188, a56
v_accvgpr_read_b32 v173, a49
v_accvgpr_read_b32 v174, a50
v_accvgpr_read_b32 v175, a51
v_accvgpr_read_b32 v176, a60
v_accvgpr_read_b32 v177, a61
v_accvgpr_read_b32 v178, a62
v_accvgpr_read_b32 v179, a63
v_pk_mul_f32 v[172:173], v[172:173], s[34:35]
v_pk_mul_f32 v[174:175], v[174:175], s[34:35]
v_pk_mul_f32 v[176:177], v[176:177], s[34:35]
v_pk_mul_f32 v[178:179], v[178:179], s[34:35]
cv v52,v172,v173
cv v53,v174,v175
cv v54,v176,v177
cv v55,v178,v179
v_accvgpr_read_b32 v172, a72
v_accvgpr_read_b32 v181, a53
v_accvgpr_read_b32 v182, a54
v_accvgpr_read_b32 v183, a55
v_accvgpr_read_b32 v184, a64
v_accvgpr_read_b32 v185, a65
v_accvgpr_read_b32 v186, a66
v_accvgpr_read_b32 v187, a67
v_pk_mul_f32 v[180:181], v[180:181], s[34:35]
v_pk_mul_f32 v[182:183], v[182:183], s[34:35]
v_pk_mul_f32 v[184:185], v[184:185], s[34:35]
v_pk_mul_f32 v[186:187], v[186:187], s[34:35]
cv v56,v180,v181
cv v57,v182,v183
cv v58,v184,v185
cv v59,v186,v187
v_accvgpr_read_b32 v180, a76
v_accvgpr_read_b32 v189, a57
v_accvgpr_read_b32 v190, a58
v_accvgpr_read_b32 v191, a59
v_accvgpr_read_b32 v192, a68
v_accvgpr_read_b32 v193, a69
v_accvgpr_read_b32 v194, a70
v_accvgpr_read_b32 v195, a71
v_pk_mul_f32 v[188:189], v[188:189], s[34:35]
v_pk_mul_f32 v[190:191], v[190:191], s[34:35]
v_pk_mul_f32 v[192:193], v[192:193], s[34:35]
v_pk_mul_f32 v[194:195], v[194:195], s[34:35]
cv v60,v188,v189
cv v61,v190,v191
cv v62,v192,v193
cv v63,v194,v195
v_accvgpr_read_b32 v188, a80
v_accvgpr_read_b32 v173, a73
v_accvgpr_read_b32 v181, a77
v_accvgpr_read_b32 v189, a81
v_accvgpr_read_b32 v174, a74
v_accvgpr_read_b32 v182, a78
v_accvgpr_read_b32 v190, a82
v_accvgpr_read_b32 v175, a75
v_accvgpr_read_b32 v183, a79
v_accvgpr_read_b32 v191, a83
v_accvgpr_read_b32 v176, a84
v_accvgpr_read_b32 v184, a88
v_accvgpr_read_b32 v192, a92
v_accvgpr_read_b32 v177, a85
v_accvgpr_read_b32 v185, a89
v_accvgpr_read_b32 v193, a93
v_accvgpr_read_b32 v178, a86
v_accvgpr_read_b32 v186, a90
v_accvgpr_read_b32 v194, a94
v_accvgpr_read_b32 v179, a87
v_accvgpr_read_b32 v187, a91
v_accvgpr_read_b32 v195, a95
v_pk_mul_f32 v[172:173], v[172:173], s[34:35]
v_pk_mul_f32 v[180:181], v[180:181], s[34:35]
v_pk_mul_f32 v[188:189], v[188:189], s[34:35]
v_pk_mul_f32 v[174:175], v[174:175], s[34:35]
v_pk_mul_f32 v[182:183], v[182:183], s[34:35]
v_pk_mul_f32 v[190:191], v[190:191], s[34:35]
v_pk_mul_f32 v[176:177], v[176:177], s[34:35]
v_pk_mul_f32 v[184:185], v[184:185], s[34:35]
v_pk_mul_f32 v[192:193], v[192:193], s[34:35]
v_pk_mul_f32 v[178:179], v[178:179], s[34:35]
v_pk_mul_f32 v[186:187], v[186:187], s[34:35]
v_pk_mul_f32 v[194:195], v[194:195], s[34:35]
cv v64,v172,v173
cv v68,v180,v181
cv v72,v188,v189
cv v65,v174,v175
cv v69,v182,v183
cv v73,v190,v191
cv v66,v176,v177
cv v70,v184,v185
cv v74,v192,v193
cv v67,v178,v179
cv v71,v186,v187
cv v75,v194,v195
wl 6
mf v[196:199],a[240:243],v[28:31],0
ds_write_b128 v26, v[124:127] offset:18432
ds_write_b128 v26, v[128:131] offset:19456
mf v[200:203],a[240:243],v[32:35],0
rq a[252:255],v7,16384
rq a[156:159],v27,11264
mf v[204:207],a[240:243],v[36:39],0
rq a[232:235],v4,16384
v_add_u32 v248, 0x18000, v2
wl 8
mf v[196:199],a[244:247],v[40:43],v[196:199]
rq a[236:239],v5,16384
v_xor_b32 v249, 32, v248
mf v[200:203],a[244:247],v[44:47],v[200:203]
dn v18,s[12:15],s32,0
mf v[204:207],a[244:247],v[48:51],v[204:207]
rq a[240:243],v6,16384
wl 7
mf v[196:199],a[248:251],v[52:55],v[196:199]
dn v18,s[12:15],s32,1024
mf v[200:203],a[248:251],v[56:59],v[200:203]
rq a[244:247],v7,16384
mf v[204:207],a[248:251],v[60:63],v[204:207]
rq a[248:251],v4,17408
wl 5
mf v[196:199],a[252:255],v[64:67],v[196:199]
dn v19,s[12:15],s32,2048
mf v[200:203],a[252:255],v[68:71],v[200:203]
dn v19,s[12:15],s32,3072
mf v[204:207],a[252:255],v[72:75],v[204:207]
s_nop 3
v_max3_f32 v196, v196, v197, v198
s_nop 0
v_max3_f32 v199, v199, v200, v201
s_nop 0
v_max3_f32 v202, v202, v203, v204
v_max3_f32 v205, v205, v206, v207
v_max3_f32 v196, v196, v199, v202
v_max_f32 v196, v196, v205
v_mov_b32 v197, v196
s_nop 1
v_permlane16_swap_b32 v196, v197
v_max_f32 v196, v196, v197
v_mov_b32 v197, v196
s_nop 1
v_permlane32_swap_b32 v196, v197
v_max_f32 v196, v196, v197
v_sub_f32 v244, 0, v196
v_sub_f32 v245, 0, v196
v_sub_f32 v246, 0, v196
v_sub_f32 v247, 0, v196
wl 3
s_nop 0
mf v[172:175],a[232:235],v[28:31],v[244:247]
rq a[252:255],v5,17408
mf v[176:179],a[232:235],v[32:35],v[244:247]
mf v[180:183],a[232:235],v[36:39],v[244:247]
rq a[232:235],v6,17408
wl 3
mf v[172:175],a[236:239],v[40:43],v[172:175]
mf v[176:179],a[236:239],v[44:47],v[176:179]
mf v[180:183],a[236:239],v[48:51],v[180:183]
rq a[236:239],v7,17408
mf v[172:175],a[240:243],v[52:55],v[172:175]
mf v[176:179],a[240:243],v[56:59],v[176:179]
mf v[180:183],a[240:243],v[60:63],v[180:183]
wl 2
mf v[172:175],a[244:247],v[64:67],v[172:175]
mf v[176:179],a[244:247],v[68:71],v[176:179]
s_waitcnt vmcnt(16)
s_barrier
mf v[180:183],a[244:247],v[72:75],v[180:183]
ds_write_b128 v26, v[132:135] offset:0
v_mov_b32 v20, v24
mf v[184:187],a[248:251],v[28:31],v[244:247]
ds_write_b128 v26, v[148:151] offset:1024
v_add_u32 v21, 8192, v24
mf v[188:191],a[248:251],v[32:35],v[244:247]
ds_write_b128 v26, v[152:155] offset:2048
mf v[192:195],a[248:251],v[36:39],v[244:247]
ds_write_b128 v26, v[156:159] offset:3072
rq a[112:115],v27,16384
mf v[184:187],a[252:255],v[40:43],v[184:187]
rq a[240:243],v4,32768
v_add_u32 v22, 16384, v24
mf v[188:191],a[252:255],v[44:47],v[188:191]
rq a[160:163],v27,24576
wl 7
mf v[192:195],a[252:255],v[48:51],v[192:195]
rq a[116:119],v27,17408
rq a[244:247],v5,32768
mf v[184:187],a[232:235],v[52:55],v[184:187]
rq a[164:167],v27,25600
v_add_u32 v23, 24576, v24
mf v[188:191],a[232:235],v[56:59],v[188:191]
rq a[120:123],v27,18432
mf v[192:195],a[232:235],v[60:63],v[192:195]
rq a[248:251],v6,32768
mf v[184:187],a[236:239],v[64:67],v[184:187]
rq a[192:195],v27,26624
mf v[188:191],a[236:239],v[68:71],v[188:191]
rq a[124:127],v27,19456
wl 8
mf v[192:195],a[236:239],v[72:75],v[192:195]
rq a[252:255],v7,32768
mf v[196:199],a[240:243],v[28:31],v[244:247]
rq a[196:199],v27,27648
wl 7
mf v[200:203],a[240:243],v[32:35],v[244:247]
rq a[232:235],v4,33792
mf v[204:207],a[240:243],v[36:39],v[244:247]
rq a[236:239],v5,33792
mf v[196:199],a[244:247],v[40:43],v[196:199]
ex v172
mf v[200:203],a[244:247],v[44:47],v[200:203]
ex v173
mf v[204:207],a[244:247],v[48:51],v[204:207]
rq a[240:243],v6,33792
cv v220,v172,v173
wl 5
mf v[196:199],a[248:251],v[52:55],v[196:199]
ex v174
mf v[200:203],a[248:251],v[56:59],v[200:203]
ex v175
mf v[204:207],a[248:251],v[60:63],v[204:207]
rq a[244:247],v7,33792
cv v221,v174,v175
wl 3
mf v[196:199],a[252:255],v[64:67],v[196:199]
ex v176
mf v[200:203],a[252:255],v[68:71],v[200:203]
ex v177
mf v[204:207],a[252:255],v[72:75],v[204:207]
ex v178
mf v[208:211],a[232:235],v[28:31],v[244:247]
ex v179
mf v[212:215],a[232:235],v[32:35],v[244:247]
s_waitcnt vmcnt(12)
s_barrier
mf v[216:219],a[232:235],v[36:39],v[244:247]
tr a[248:249],v8,16384
cv v224,v176,v177
wl 2
mf v[208:211],a[236:239],v[40:43],v[208:211]
tr a[250:251],v8,17408
cv v225,v178,v179
mf v[212:215],a[236:239],v[44:47],v[212:215]
ex v180
mf v[216:219],a[236:239],v[48:51],v[216:219]
tr a[252:253],v9,16384
wl 3
mf v[208:211],a[240:243],v[52:55],v[208:211]
tr a[254:255],v9,17408
mf v[212:215],a[240:243],v[56:59],v[212:215]
ex v181
mf v[216:219],a[240:243],v[60:63],v[216:219]
tr a[232:233],v10,16384
cv v228,v180,v181
mf v[208:211],a[244:247],v[64:67],v[208:211]
tr a[234:235],v10,17408
mf v[212:215],a[244:247],v[68:71],v[212:215]
ex v182
ex v183
ex v184
ex v185
ex v186
ex v187
ex v188
ex v189
ex v190
ex v191
ex v192
ex v193
ex v194
ex v195
mf v[216:219],a[244:247],v[72:75],v[216:219]
cv v229,v182,v183
cv v222,v184,v185
cv v223,v186,v187
cv v226,v188,v189
cv v227,v190,v191
cv v230,v192,v193
cv v231,v194,v195
mf a[216:219],a[228:231],v[220:223],0
tr a[236:237],v11,16384
wl 4
mf a[220:223],a[228:231],v[224:227],0
tr a[238:239],v11,17408
mf a[224:227],a[228:231],v[228:231],0
tr a[240:241],v12,16384
wl 5
mf v[76:79],a[248:251],v[220:223],0
tr a[242:243],v12,17408
mf v[80:83],a[248:251],v[224:227],0
ex v196
mf v[84:87],a[248:251],v[228:231],0
tr a[244:245],v13,16384
wl 5
mf v[88:91],a[252:255],v[220:223],0
tr a[246:247],v13,17408
mf v[92:95],a[252:255],v[224:227],0
ex v197
mf v[96:99],a[252:255],v[228:231],0
tr a[248:249],v14,16384
cv v232,v196,v197
mf v[100:103],a[232:235],v[220:223],0
tr a[250:251],v14,17408
wl 5
mf v[104:107],a[232:235],v[224:227],0
ex v198
mf v[108:111],a[232:235],v[228:231],0
tr a[252:253],v15,16384
wl 5
mf v[112:115],a[236:239],v[220:223],0
tr a[254:255],v15,17408
mf v[116:119],a[236:239],v[224:227],0
s_waitcnt vmcnt(8)
s_barrier
mf v[120:123],a[236:239],v[228:231],0
rq a[128:131],v27,0
wl 5
mf v[124:127],a[240:243],v[220:223],0
rq a[232:235],v4,0
mf v[128:131],a[240:243],v[224:227],0
rq a[200:203],v27,8192
mf v[132:135],a[240:243],v[228:231],0
rq a[132:135],v27,1024
wl 6
mf v[136:139],a[244:247],v[220:223],0
rq a[236:239],v5,0
mf v[140:143],a[244:247],v[224:227],0
rq a[204:207],v27,9216
mf v[144:147],a[244:247],v[228:231],0
rq a[136:139],v27,2048
wl 7
mf v[148:151],a[248:251],v[220:223],0
rq a[240:243],v6,0
mf v[152:155],a[248:251],v[224:227],0
rq a[208:211],v27,10240
mf v[156:159],a[248:251],v[228:231],0
rq a[140:143],v27,3072
wl 7
mf v[160:163],a[252:255],v[220:223],0
rq a[244:247],v7,0
mf v[164:167],a[252:255],v[224:227],0
rq a[212:215],v27,11264
mf v[168:171],a[252:255],v[228:231],0
rq a[248:251],v4,1024
wl 7
mf v[172:175],a[232:235],v[28:31],v[244:247]
ex v199
mf v[176:179],a[232:235],v[32:35],v[244:247]
ex v200
mf v[180:183],a[232:235],v[36:39],v[244:247]
rq a[252:255],v5,1024
cv v233,v198,v199
mf v[172:175],a[236:239],v[40:43],v[172:175]
ex v201
mf v[176:179],a[236:239],v[44:47],v[176:179]
ex v202
mf v[180:183],a[236:239],v[48:51],v[180:183]
rq a[232:235],v6,1024
cv v236,v200,v201
wl 3
mf v[172:175],a[240:243],v[52:55],v[172:175]
ex v203
mf v[176:179],a[240:243],v[56:59],v[176:179]
ex v204
mf v[180:183],a[240:243],v[60:63],v[180:183]
rq a[236:239],v7,1024
cv v237,v202,v203
mf v[172:175],a[244:247],v[64:67],v[172:175]
ex v205
mf v[176:179],a[244:247],v[68:71],v[176:179]
ex v206
mf v[180:183],a[244:247],v[72:75],v[180:183]
ex v207
wl 2
mf v[184:187],a[248:251],v[28:31],v[244:247]
ex v208
mf v[188:191],a[248:251],v[32:35],v[244:247]
s_waitcnt vmcnt(4)
s_barrier
mf v[192:195],a[248:251],v[36:39],v[244:247]
tr a[240:241],v8,32768
cv v240,v204,v205
mf v[184:187],a[252:255],v[40:43],v[184:187]
tr a[242:243],v8,33792
cv v241,v206,v207
mf v[188:191],a[252:255],v[44:47],v[188:191]
ex v209
mf v[192:195],a[252:255],v[48:51],v[192:195]
tr a[244:245],v9,32768
cv v234,v208,v209
wl 3
mf v[184:187],a[232:235],v[52:55],v[184:187]
tr a[246:247],v9,33792
mf v[188:191],a[232:235],v[56:59],v[188:191]
ex v210
mf v[192:195],a[232:235],v[60:63],v[192:195]
tr a[248:249],v10,32768
mf v[184:187],a[236:239],v[64:67],v[184:187]
tr a[250:251],v10,33792
mf v[188:191],a[236:239],v[68:71],v[188:191]
ex v211
ex v212
ex v213
ex v214
ex v215
ex v216
ex v217
ex v218
ex v219
mf v[192:195],a[236:239],v[72:75],v[192:195]
cv v235,v210,v211
cv v238,v212,v213
cv v239,v214,v215
cv v242,v216,v217
cv v243,v218,v219
mf a[216:219],a[228:231],v[232:235],a[216:219]
tr a[252:253],v11,32768
wl 4
mf a[220:223],a[228:231],v[236:239],a[220:223]
tr a[254:255],v11,33792
mf a[224:227],a[228:231],v[240:243],a[224:227]
tr a[232:233],v12,32768
wl 5
mf v[76:79],a[240:243],v[232:235],v[76:79]
tr a[234:235],v12,33792
mf v[80:83],a[240:243],v[236:239],v[80:83]
ex v172
mf v[84:87],a[240:243],v[240:243],v[84:87]
tr a[236:237],v13,32768
wl 5
mf v[88:91],a[244:247],v[232:235],v[88:91]
tr a[238:239],v13,33792
mf v[92:95],a[244:247],v[236:239],v[92:95]
ex v173
mf v[96:99],a[244:247],v[240:243],v[96:99]
tr a[240:241],v14,32768
cv v220,v172,v173
mf v[100:103],a[248:251],v[232:235],v[100:103]
tr a[242:243],v14,33792
wl 5
mf v[104:107],a[248:251],v[236:239],v[104:107]
ex v174
mf v[108:111],a[248:251],v[240:243],v[108:111]
tr a[244:245],v15,32768
wl 5
mf v[112:115],a[252:255],v[232:235],v[112:115]
s_add_u32 s52, s41, 0
s_sub_u32 s32, s52, 1152
s_min_u32 s52, s52, s32
s_add_u32 s53, s41, 128
s_sub_u32 s32, s53, 1152
s_min_u32 s53, s53, s32
s_add_u32 s54, s41, 256
s_sub_u32 s32, s54, 1152
s_min_u32 s54, s54, s32
s_add_u32 s55, s41, 384
s_sub_u32 s32, s55, 1152
s_min_u32 s55, s55, s32
s_add_u32 s56, s41, 512
s_sub_u32 s32, s56, 1152
s_min_u32 s56, s56, s32
s_add_u32 s57, s41, 640
s_sub_u32 s32, s57, 1152
s_min_u32 s57, s57, s32
s_add_u32 s58, s41, 768
s_sub_u32 s32, s58, 1152
s_min_u32 s58, s58, s32
s_add_u32 s59, s41, 896
s_sub_u32 s32, s59, 1152
s_min_u32 s59, s59, s32
s_add_u32 s60, s41, 1024
s_sub_u32 s32, s60, 1152
s_min_u32 s60, s60, s32
s_add_u32 m0, s4, 0x18000
s_nop 0
dl v20,s[20:23],s52,0
dl v21,s[20:23],s52,1024
dl v22,s[20:23],s52,2048
dl v23,s[20:23],s52,3072
s_add_u32 m0, s4, 0x4000
s_add_u32 s32, s98, 0x6000
s_and_b32 s32, s32, 0x1ffff
dn v16,s[8:11],s32,0
dn v16,s[8:11],s32,1024
dn v17,s[8:11],s32,2048
dn v17,s[8:11],s32,3072
mf v[116:119],a[252:255],v[236:239],v[116:119]
s_waitcnt vmcnt(0)
s_barrier
mf v[120:123],a[252:255],v[240:243],v[120:123]
tr a[246:247],v15,33792
s_add_u32 m0, s4, 0x8000
mf v[124:127],a[232:235],v[232:235],v[124:127]
rq a[248:251],v4,16384
s_add_u32 s32, s98, 0x8000
mf v[128:131],a[232:235],v[236:239],v[128:131]
ex v175
mf v[132:135],a[232:235],v[240:243],v[132:135]
rq a[252:255],v5,16384
s_and_b32 s32, s32, 0x1ffff
wl 4
mf v[136:139],a[236:239],v[232:235],v[136:139]
ex v176
mf v[140:143],a[236:239],v[236:239],v[140:143]
ex v177
mf v[144:147],a[236:239],v[240:243],v[144:147]
rq a[232:235],v6,16384
dn v16,s[8:11],s32,0
mf v[148:151],a[240:243],v[232:235],v[148:151]
ex v178
mf v[152:155],a[240:243],v[236:239],v[152:155]
ex v179
mf v[156:159],a[240:243],v[240:243],v[156:159]
rq a[236:239],v7,16384
dn v16,s[8:11],s32,1024
wl 3
mf v[160:163],a[244:247],v[232:235],v[160:163]
ex v180
mf v[164:167],a[244:247],v[236:239],v[164:167]
ex v181
mf v[168:171],a[244:247],v[240:243],v[168:171]
rq a[240:243],v4,17408
dn v17,s[8:11],s32,2048
mf v[196:199],a[248:251],v[28:31],v[244:247]
ex v182
mf v[200:203],a[248:251],v[32:35],v[244:247]
ex v183
mf v[204:207],a[248:251],v[36:39],v[244:247]
rq a[244:247],v5,17408
dn v17,s[8:11],s32,3072
wl 3
mf v[196:199],a[252:255],v[40:43],v[196:199]
ex v184
mf v[200:203],a[252:255],v[44:47],v[200:203]
ex v185
mf v[204:207],a[252:255],v[48:51],v[204:207]
rq a[248:251],v6,17408
s_add_u32 m0, s4, 0x1c000
mf v[196:199],a[232:235],v[52:55],v[196:199]
ex v186
mf v[200:203],a[232:235],v[56:59],v[200:203]
ex v187
mf v[204:207],a[232:235],v[60:63],v[204:207]
rq a[252:255],v7,17408
s_add_u32 s32, s52, 0x24000
wl 3
mf v[196:199],a[236:239],v[64:67],v[196:199]
ex v188
mf v[200:203],a[236:239],v[68:71],v[200:203]
ex v189
mf v[204:207],a[236:239],v[72:75],v[204:207]
ex v190
mf v[208:211],a[240:243],v[28:31],v[244:247]
ex v191
mf v[212:215],a[240:243],v[32:35],v[244:247]
s_barrier
mf v[216:219],a[240:243],v[36:39],v[244:247]
tr a[232:233],v8,0
dl v20,s[20:23],s32,0
wl 2
mf v[208:211],a[244:247],v[40:43],v[208:211]
tr a[234:235],v8,1024
dl v21,s[20:23],s32,1024
mf v[212:215],a[244:247],v[44:47],v[212:215]
ex v192
mf v[216:219],a[244:247],v[48:51],v[216:219]
tr a[236:237],v9,0
dl v22,s[20:23],s32,2048
mf v[208:211],a[248:251],v[52:55],v[208:211]
tr a[238:239],v9,1024
dl v23,s[20:23],s32,3072
mf v[212:215],a[248:251],v[56:59],v[212:215]
ex v193
mf v[216:219],a[248:251],v[60:63],v[216:219]
tr a[240:241],v10,0
s_add_u32 m0, s4, 0x10000
wl 5
mf v[208:211],a[252:255],v[64:67],v[208:211]
tr a[242:243],v10,1024
s_add_u32 s32, s98, 0x6000
mf v[212:215],a[252:255],v[68:71],v[212:215]
ex v194
ex v195
mf v[216:219],a[252:255],v[72:75],v[216:219]
cv v221,v174,v175
cv v224,v176,v177
cv v225,v178,v179
cv v228,v180,v181
cv v229,v182,v183
cv v222,v184,v185
cv v223,v186,v187
cv v226,v188,v189
cv v227,v190,v191
cv v230,v192,v193
cv v231,v194,v195
mf a[216:219],a[228:231],v[220:223],a[216:219]
tr a[244:245],v11,0
s_and_b32 s32, s32, 0x1ffff
mf a[220:223],a[228:231],v[224:227],a[220:223]
tr a[246:247],v11,1024
dn v18,s[12:15],s32,0
mf a[224:227],a[228:231],v[228:231],a[224:227]
tr a[248:249],v12,0
dn v18,s[12:15],s32,1024
wl 5
mf v[76:79],a[232:235],v[220:223],v[76:79]
tr a[250:251],v12,1024
dn v19,s[12:15],s32,2048
mf v[80:83],a[232:235],v[224:227],v[80:83]
ex v196
mf v[84:87],a[232:235],v[228:231],v[84:87]
tr a[252:253],v13,0
dn v19,s[12:15],s32,3072
mf v[88:91],a[236:239],v[220:223],v[88:91]
tr a[254:255],v13,1024
s_add_u32 m0, s4, 0x0
mf v[92:95],a[236:239],v[224:227],v[92:95]
ex v197
mf v[96:99],a[236:239],v[228:231],v[96:99]
tr a[232:233],v14,0
s_add_u32 s32, s98, 0xa000
wl 5
mf v[100:103],a[240:243],v[220:223],v[100:103]
tr a[234:235],v14,1024
s_and_b32 s32, s32, 0x1ffff
mf v[104:107],a[240:243],v[224:227],v[104:107]
ex v198
mf v[108:111],a[240:243],v[228:231],v[108:111]
tr a[236:237],v15,0
dn v16,s[8:11],s32,0
mf v[112:115],a[244:247],v[220:223],v[112:115]
tr a[238:239],v15,1024
dn v16,s[8:11],s32,1024
mf v[116:119],a[244:247],v[224:227],v[116:119]
s_barrier
mf v[120:123],a[244:247],v[228:231],v[120:123]
tr a[240:241],v248,0
dn v17,s[8:11],s32,2048
wl 5
mf v[124:127],a[248:251],v[220:223],v[124:127]
tr a[242:243],v248,2048
dn v17,s[8:11],s32,3072
mf v[128:131],a[248:251],v[224:227],v[128:131]
ex v199
mf v[132:135],a[248:251],v[228:231],v[132:135]
tr a[244:245],v249,0
s_add_u32 m0, s4, 0x14000
mf v[136:139],a[252:255],v[220:223],v[136:139]
tr a[246:247],v249,2048
s_add_u32 s32, s98, 0x8000
mf v[140:143],a[252:255],v[224:227],v[140:143]
ex v200
mf v[144:147],a[252:255],v[228:231],v[144:147]
tr a[248:249],v248,4096
s_and_b32 s32, s32, 0x1ffff
wl 5
mf v[148:151],a[232:235],v[220:223],v[148:151]
tr a[250:251],v248,6144
dn v18,s[12:15],s32,0
mf v[152:155],a[232:235],v[224:227],v[152:155]
ex v201
mf v[156:159],a[232:235],v[228:231],v[156:159]
tr a[252:253],v249,4096
dn v18,s[12:15],s32,1024
mf v[160:163],a[236:239],v[220:223],v[160:163]
tr a[254:255],v249,6144
dn v19,s[12:15],s32,2048
mf v[164:167],a[236:239],v[224:227],v[164:167]
ex v202
mf v[168:171],a[236:239],v[228:231],v[168:171]
tr a[232:233],v248,8192
dn v19,s[12:15],s32,3072
wl 5
mf a[0:3],a[240:243],a[96:99],0
tr a[234:235],v248,10240
s_add_u32 m0, s4, 0x24000
mf a[4:7],a[240:243],a[100:103],0
ex v203
mf a[8:11],a[240:243],a[104:107],0
tr a[236:237],v249,8192
dl v20,s[20:23],s53,0
mf a[12:15],a[244:247],a[96:99],0
tr a[238:239],v249,10240
dl v21,s[20:23],s53,1024
mf a[16:19],a[244:247],a[100:103],0
ex v204
mf a[20:23],a[244:247],a[104:107],0
tr a[240:241],v248,12288
dl v22,s[20:23],s53,2048
wl 5
mf a[0:3],a[248:251],a[108:111],a[0:3]
tr a[242:243],v248,14336
dl v23,s[20:23],s53,3072
mf a[4:7],a[248:251],a[112:115],a[4:7]
ex v205
mf a[8:11],a[248:251],a[116:119],a[8:11]
tr a[244:245],v249,12288
s_add_u32 m0, s4, 0x4000
mf a[12:15],a[252:255],a[108:111],a[12:15]
tr a[246:247],v249,14336
s_add_u32 s32, s98, 0xc000
mf a[16:19],a[252:255],a[112:115],a[16:19]
s_waitcnt vmcnt(20)
s_barrier
mf a[20:23],a[252:255],a[116:119],a[20:23]
rq a[248:251],v4,32768
s_and_b32 s32, s32, 0x1ffff
wl 5
mf a[0:3],a[232:235],a[120:123],a[0:3]
ex v206
mf a[4:7],a[232:235],a[124:127],a[4:7]
ex v207
mf a[8:11],a[232:235],a[128:131],a[8:11]
rq a[252:255],v5,32768
dn v16,s[8:11],s32,0
mf a[12:15],a[236:239],a[120:123],a[12:15]
ex v208
mf a[16:19],a[236:239],a[124:127],a[16:19]
ex v209
mf a[20:23],a[236:239],a[128:131],a[20:23]
rq a[232:235],v6,32768
dn v16,s[8:11],s32,1024
wl 3
mf a[0:3],a[240:243],a[132:135],a[0:3]
ex v210
mf a[4:7],a[240:243],a[136:139],a[4:7]
ex v211
mf a[8:11],a[240:243],a[140:143],a[8:11]
rq a[236:239],v7,32768
dn v17,s[8:11],s32,2048
mf a[12:15],a[244:247],a[132:135],a[12:15]
ex v212
mf a[16:19],a[244:247],a[136:139],a[16:19]
ex v213
mf a[20:23],a[244:247],a[140:143],a[20:23]
rq a[240:243],v4,33792
dn v17,s[8:11],s32,3072
wl 3
mf v[172:175],a[248:251],v[28:31],v[244:247]
ex v214
mf v[176:179],a[248:251],v[32:35],v[244:247]
ex v215
mf v[180:183],a[248:251],v[36:39],v[244:247]
rq a[244:247],v5,33792
s_add_u32 m0, s4, 0xc000
mf v[172:175],a[252:255],v[40:43],v[172:175]
ex v216
mf v[176:179],a[252:255],v[44:47],v[176:179]
ex v217
mf v[180:183],a[252:255],v[48:51],v[180:183]
rq a[248:251],v6,33792
s_add_u32 s32, s98, 0xa000
wl 3
mf v[172:175],a[232:235],v[52:55],v[172:175]
ex v218
mf v[176:179],a[232:235],v[56:59],v[176:179]
ex v219
mf v[180:183],a[232:235],v[60:63],v[180:183]
rq a[252:255],v7,33792
s_and_b32 s32, s32, 0x1ffff
mf v[172:175],a[236:239],v[64:67],v[172:175]
dn v18,s[12:15],s32,0
mf v[176:179],a[236:239],v[68:71],v[176:179]
dn v18,s[12:15],s32,1024
mf v[180:183],a[236:239],v[72:75],v[180:183]
dn v19,s[12:15],s32,2048
wl 2
mf v[184:187],a[240:243],v[28:31],v[244:247]
dn v19,s[12:15],s32,3072
mf v[188:191],a[240:243],v[32:35],v[244:247]
s_waitcnt vmcnt(20)
s_barrier
mf v[192:195],a[240:243],v[36:39],v[244:247]
tr a[232:233],v8,16384
s_add_u32 m0, s4, 0x20000
mf v[184:187],a[244:247],v[40:43],v[184:187]
tr a[234:235],v8,17408
cv v232,v196,v197
mf v[188:191],a[244:247],v[44:47],v[188:191]
ex v172
mf v[192:195],a[244:247],v[48:51],v[192:195]
tr a[236:237],v9,16384
s_add_u32 s32, s53, 0x24000
wl 3
mf v[184:187],a[248:251],v[52:55],v[184:187]
tr a[238:239],v9,17408
cv v233,v198,v199
mf v[188:191],a[248:251],v[56:59],v[188:191]
ex v173
mf v[192:195],a[248:251],v[60:63],v[192:195]
tr a[240:241],v10,16384
cv v236,v200,v201
mf v[184:187],a[252:255],v[64:67],v[184:187]
tr a[242:243],v10,17408
cv v237,v202,v203
mf v[188:191],a[252:255],v[68:71],v[188:191]
ex v174
mf v[192:195],a[252:255],v[72:75],v[192:195]
cv v240,v204,v205
cv v241,v206,v207
cv v234,v208,v209
cv v235,v210,v211
cv v238,v212,v213
cv v239,v214,v215
cv v242,v216,v217
cv v243,v218,v219
mf a[216:219],a[228:231],v[232:235],a[216:219]
tr a[244:245],v11,16384
cv v220,v172,v173
mf a[220:223],a[228:231],v[236:239],a[220:223]
tr a[246:247],v11,17408
wl 4
mf a[224:227],a[228:231],v[240:243],a[224:227]
tr a[248:249],v12,16384
mf v[76:79],a[232:235],v[232:235],v[76:79]
tr a[250:251],v12,17408
mf v[80:83],a[232:235],v[236:239],v[80:83]
ex v175
mf v[84:87],a[232:235],v[240:243],v[84:87]
tr a[252:253],v13,16384
dl v20,s[20:23],s32,0
mf v[88:91],a[236:239],v[232:235],v[88:91]
tr a[254:255],v13,17408
cv v221,v174,v175
mf v[92:95],a[236:239],v[236:239],v[92:95]
ex v176
mf v[96:99],a[236:239],v[240:243],v[96:99]
tr a[232:233],v14,16384
dl v21,s[20:23],s32,1024
wl 5
mf v[100:103],a[240:243],v[232:235],v[100:103]
tr a[234:235],v14,17408
mf v[104:107],a[240:243],v[236:239],v[104:107]
ex v177
mf v[108:111],a[240:243],v[240:243],v[108:111]
tr a[236:237],v15,16384
cv v224,v176,v177
mf v[112:115],a[244:247],v[232:235],v[112:115]
tr a[238:239],v15,17408
dl v22,s[20:23],s32,2048
mf v[116:119],a[244:247],v[236:239],v[116:119]
s_barrier
mf v[120:123],a[244:247],v[240:243],v[120:123]
tr a[240:241],v248,16384
wl 5
mf v[124:127],a[248:251],v[232:235],v[124:127]
tr a[242:243],v248,18432
dl v23,s[20:23],s32,3072
mf v[128:131],a[248:251],v[236:239],v[128:131]
ex v178
mf v[132:135],a[248:251],v[240:243],v[132:135]
tr a[244:245],v249,16384
s_add_u32 m0, s4, 0x8000
mf v[136:139],a[252:255],v[232:235],v[136:139]
tr a[246:247],v249,18432
s_add_u32 s32, s98, 0xe000
mf v[140:143],a[252:255],v[236:239],v[140:143]
ex v179
mf v[144:147],a[252:255],v[240:243],v[144:147]
tr a[248:249],v248,20480
s_and_b32 s32, s32, 0x1ffff
wl 5
mf v[148:151],a[232:235],v[232:235],v[148:151]
tr a[250:251],v248,22528
cv v225,v178,v179
mf v[152:155],a[232:235],v[236:239],v[152:155]
ex v180
mf v[156:159],a[232:235],v[240:243],v[156:159]
tr a[252:253],v249,20480
wl 5
mf v[160:163],a[236:239],v[232:235],v[160:163]
tr a[254:255],v249,22528
mf v[164:167],a[236:239],v[236:239],v[164:167]
ex v181
mf v[168:171],a[236:239],v[240:243],v[168:171]
tr a[232:233],v248,24576
cv v228,v180,v181
mf a[0:3],a[240:243],a[144:147],a[0:3]
tr a[234:235],v248,26624
wl 5
mf a[4:7],a[240:243],a[148:151],a[4:7]
ex v182
mf a[8:11],a[240:243],a[152:155],a[8:11]
tr a[236:237],v249,24576
wl 5
mf a[12:15],a[244:247],a[144:147],a[12:15]
tr a[238:239],v249,26624
mf a[16:19],a[244:247],a[148:151],a[16:19]
ex v183
mf a[20:23],a[244:247],a[152:155],a[20:23]
tr a[240:241],v248,28672
dn v16,s[8:11],s32,0
mf a[0:3],a[248:251],a[156:159],a[0:3]
tr a[242:243],v248,30720
cv v229,v182,v183
mf a[4:7],a[248:251],a[160:163],a[4:7]
ex v184
mf a[8:11],a[248:251],a[164:167],a[8:11]
tr a[244:245],v249,28672
wl 5
mf a[12:15],a[252:255],a[156:159],a[12:15]
tr a[246:247],v249,30720
dn v16,s[8:11],s32,1024
mf a[16:19],a[252:255],a[160:163],a[16:19]
s_waitcnt vmcnt(22)
s_barrier
mf a[20:23],a[252:255],a[164:167],a[20:23]
rq a[248:251],v4,0
wl 5
mf a[0:3],a[232:235],a[192:195],a[0:3]
ex v185
mf a[4:7],a[232:235],a[196:199],a[4:7]
ex v186
mf a[8:11],a[232:235],a[200:203],a[8:11]
rq a[252:255],v5,0
dn v17,s[8:11],s32,2048
mf a[12:15],a[236:239],a[192:195],a[12:15]
ex v187
mf a[16:19],a[236:239],a[196:199],a[16:19]
ex v188
mf a[20:23],a[236:239],a[200:203],a[20:23]
rq a[232:235],v6,0
dn v17,s[8:11],s32,3072
wl 3
mf a[0:3],a[240:243],a[204:207],a[0:3]
ex v189
mf a[4:7],a[240:243],a[208:211],a[4:7]
ex v190
mf a[8:11],a[240:243],a[212:215],a[8:11]
rq a[236:239],v7,0
s_add_u32 m0, s4, 0x10000
mf a[12:15],a[244:247],a[204:207],a[12:15]
ex v191
mf a[16:19],a[244:247],a[208:211],a[16:19]
ex v192
mf a[20:23],a[244:247],a[212:215],a[20:23]
rq a[240:243],v4,1024
s_add_u32 s32, s98, 0xc000
wl 3
mf v[196:199],a[248:251],v[28:31],v[244:247]
ex v193
mf v[200:203],a[248:251],v[32:35],v[244:247]
ex v194
mf v[204:207],a[248:251],v[36:39],v[244:247]
rq a[244:247],v5,1024
s_and_b32 s32, s32, 0x1ffff
mf v[196:199],a[252:255],v[40:43],v[196:199]
ex v195
mf v[200:203],a[252:255],v[44:47],v[200:203]
dn v18,s[12:15],s32,0
mf v[204:207],a[252:255],v[48:51],v[204:207]
rq a[248:251],v6,1024
cv v222,v184,v185
wl 3
mf v[196:199],a[232:235],v[52:55],v[196:199]
dn v18,s[12:15],s32,1024
mf v[200:203],a[232:235],v[56:59],v[200:203]
dn v19,s[12:15],s32,2048
mf v[204:207],a[232:235],v[60:63],v[204:207]
rq a[252:255],v7,1024
cv v223,v186,v187
mf v[196:199],a[236:239],v[64:67],v[196:199]
dn v19,s[12:15],s32,3072
mf v[200:203],a[236:239],v[68:71],v[200:203]
cv v226,v188,v189
cv v227,v190,v191
mf v[204:207],a[236:239],v[72:75],v[204:207]
cv v230,v192,v193
cv v231,v194,v195
wl 2
mf v[208:211],a[240:243],v[28:31],v[244:247]
v_accvgpr_read_b32 v26, a0
v_accvgpr_read_b32 v27, a1
mf v[212:215],a[240:243],v[32:35],v[244:247]
s_waitcnt vmcnt(24)
s_barrier
mf v[216:219],a[240:243],v[36:39],v[244:247]
tr a[232:233],v8,32768
s_add_u32 m0, s4, 0x18000
mf v[208:211],a[244:247],v[40:43],v[208:211]
tr a[234:235],v8,33792
cv v26,v26,v27
mf v[212:215],a[244:247],v[44:47],v[212:215]
ex v196
mf v[216:219],a[244:247],v[48:51],v[216:219]
tr a[236:237],v9,32768
v_accvgpr_write_b32 a48, v26
wl 3
mf v[208:211],a[248:251],v[52:55],v[208:211]
tr a[238:239],v9,33792
v_accvgpr_read_b32 v1, a2
mf v[212:215],a[248:251],v[56:59],v[212:215]
ex v197
mf v[216:219],a[248:251],v[60:63],v[216:219]
tr a[240:241],v10,32768
cv v232,v196,v197
mf v[208:211],a[252:255],v[64:67],v[208:211]
tr a[242:243],v10,33792
v_accvgpr_read_b32 v3, a3
mf v[212:215],a[252:255],v[68:71],v[212:215]
ex v198
mf v[216:219],a[252:255],v[72:75],v[216:219]
tr a[244:245],v11,32768
cv v1,v1,v3
mf a[216:219],a[228:231],v[220:223],a[216:219]
tr a[246:247],v11,33792
v_accvgpr_write_b32 a49, v1
mf a[220:223],a[228:231],v[224:227],a[220:223]
ex v199
mf a[224:227],a[228:231],v[228:231],a[224:227]
tr a[248:249],v12,32768
dl v20,s[20:23],s54,0
wl 5
mf v[76:79],a[232:235],v[220:223],v[76:79]
tr a[250:251],v12,33792
cv v233,v198,v199
mf v[80:83],a[232:235],v[224:227],v[80:83]
ex v200
mf v[84:87],a[232:235],v[228:231],v[84:87]
tr a[252:253],v13,32768
dl v21,s[20:23],s54,1024
mf v[88:91],a[236:239],v[220:223],v[88:91]
tr a[254:255],v13,33792
v_accvgpr_read_b32 v26, a4
mf v[92:95],a[236:239],v[224:227],v[92:95]
ex v201
mf v[96:99],a[236:239],v[228:231],v[96:99]
tr a[232:233],v14,32768
dl v22,s[20:23],s54,2048
wl 5
mf v[100:103],a[240:243],v[220:223],v[100:103]
tr a[234:235],v14,33792
cv v236,v200,v201
mf v[104:107],a[240:243],v[224:227],v[104:107]
ex v202
mf v[108:111],a[240:243],v[228:231],v[108:111]
tr a[236:237],v15,32768
v_accvgpr_read_b32 v27, a5
mf v[112:115],a[244:247],v[220:223],v[112:115]
tr a[238:239],v15,33792
dl v23,s[20:23],s54,3072
mf v[116:119],a[244:247],v[224:227],v[116:119]
s_waitcnt vmcnt(24)
s_barrier
mf v[120:123],a[244:247],v[228:231],v[120:123]
tr a[240:241],v248,49152
s_add_u32 m0, s4, 0x0
wl 5
mf v[124:127],a[248:251],v[220:223],v[124:127]
tr a[242:243],v248,51200
cv v26,v26,v27
mf v[128:131],a[248:251],v[224:227],v[128:131]
ex v203
mf v[132:135],a[248:251],v[228:231],v[132:135]
tr a[244:245],v249,49152
s_add_u32 s32, s98, 0x10000
mf v[136:139],a[252:255],v[220:223],v[136:139]
tr a[246:247],v249,51200
cv v237,v202,v203
mf v[140:143],a[252:255],v[224:227],v[140:143]
ex v204
mf v[144:147],a[252:255],v[228:231],v[144:147]
tr a[248:249],v248,53248
s_and_b32 s32, s32, 0x1ffff
wl 5
mf v[148:151],a[232:235],v[220:223],v[148:151]
tr a[250:251],v248,55296
v_accvgpr_write_b32 a50, v26
mf v[152:155],a[232:235],v[224:227],v[152:155]
ex v205
mf v[156:159],a[232:235],v[228:231],v[156:159]
tr a[252:253],v249,53248
cv v240,v204,v205
mf v[160:163],a[236:239],v[220:223],v[160:163]
tr a[254:255],v249,55296
v_accvgpr_read_b32 v1, a6
mf v[164:167],a[236:239],v[224:227],v[164:167]
ex v206
mf v[168:171],a[236:239],v[228:231],v[168:171]
s_cmp_lg_u32 s100, 0
s_cbranch_scc1 L_hc4
s_mov_b32 s48, s70
s_and_b32 s49, s71, 0xffff
s_mov_b32 s50, 256
s_mov_b32 s51, 0x20000
s_lshl_b32 s36, s40, 3
v_mov_b32 v255, 0
s_nop 0
buffer_load_dword v255, v255, s[48:51], s36 offen sc1
L_hc4:
wl 4
mf a[24:27],a[240:243],a[96:99],0
tr a[232:233],v248,57344
v_accvgpr_read_b32 v3, a7
mf a[28:31],a[240:243],a[100:103],0
tr a[234:235],v248,59392
cv v1,v1,v3
mf a[32:35],a[240:243],a[104:107],0
tr a[236:237],v249,57344
v_accvgpr_write_b32 a51, v1
mf a[36:39],a[244:247],a[96:99],0
tr a[238:239],v249,59392
v_accvgpr_read_b32 v26, a8
mf a[40:43],a[244:247],a[100:103],0
ex v207
mf a[44:47],a[244:247],a[104:107],0
tr a[240:241],v248,61440
dn v16,s[8:11],s32,0
wl 5
mf a[24:27],a[248:251],a[108:111],a[24:27]
tr a[242:243],v248,63488
cv v241,v206,v207
mf a[28:31],a[248:251],a[112:115],a[28:31]
ex v208
mf a[32:35],a[248:251],a[116:119],a[32:35]
tr a[244:245],v249,61440
v_accvgpr_read_b32 v27, a9
mf a[36:39],a[252:255],a[108:111],a[36:39]
tr a[246:247],v249,63488
dn v16,s[8:11],s32,1024
mf a[40:43],a[252:255],a[112:115],a[40:43]
s_waitcnt vmcnt(22)
s_barrier
mf a[44:47],a[252:255],a[116:119],a[44:47]
rq a[248:251],v4,16384
cv v26,v26,v27
wl 5
mf a[24:27],a[232:235],a[120:123],a[24:27]
ex v209
mf a[28:31],a[232:235],a[124:127],a[28:31]
ex v210
mf a[32:35],a[232:235],a[128:131],a[32:35]
rq a[252:255],v5,16384
dn v17,s[8:11],s32,2048
mf a[36:39],a[236:239],a[120:123],a[36:39]
ex v211
mf a[40:43],a[236:239],a[124:127],a[40:43]
ex v212
mf a[44:47],a[236:239],a[128:131],a[44:47]
rq a[232:235],v6,16384
dn v17,s[8:11],s32,3072
wl 3
mf a[24:27],a[240:243],a[132:135],a[24:27]
ex v213
mf a[28:31],a[240:243],a[136:139],a[28:31]
ex v214
mf a[32:35],a[240:243],a[140:143],a[32:35]
rq a[236:239],v7,16384
s_add_u32 m0, s4, 0x14000
mf a[36:39],a[244:247],a[132:135],a[36:39]
ex v215
mf a[40:43],a[244:247],a[136:139],a[40:43]
ex v216
mf a[44:47],a[244:247],a[140:143],a[44:47]
rq a[240:243],v4,17408
s_add_u32 s32, s98, 0xe000
wl 3
mf v[172:175],a[248:251],v[28:31],v[244:247]
ex v217
mf v[176:179],a[248:251],v[32:35],v[244:247]
ex v218
mf v[180:183],a[248:251],v[36:39],v[244:247]
rq a[244:247],v5,17408
s_and_b32 s32, s32, 0x1ffff
mf v[172:175],a[252:255],v[40:43],v[172:175]
ex v219
mf v[176:179],a[252:255],v[44:47],v[176:179]
dn v18,s[12:15],s32,0
mf v[180:183],a[252:255],v[48:51],v[180:183]
rq a[248:251],v6,17408
cv v234,v208,v209
wl 3
mf v[172:175],a[232:235],v[52:55],v[172:175]
dn v18,s[12:15],s32,1024
mf v[176:179],a[232:235],v[56:59],v[176:179]
dn v19,s[12:15],s32,2048
mf v[180:183],a[232:235],v[60:63],v[180:183]
rq a[252:255],v7,17408
cv v235,v210,v211
mf v[172:175],a[236:239],v[64:67],v[172:175]
dn v19,s[12:15],s32,3072
mf v[176:179],a[236:239],v[68:71],v[176:179]
cv v238,v212,v213
cv v239,v214,v215
mf v[180:183],a[236:239],v[72:75],v[180:183]
cv v242,v216,v217
cv v243,v218,v219
wl 2
mf v[184:187],a[240:243],v[28:31],v[244:247]
v_accvgpr_write_b32 a52, v26
v_accvgpr_read_b32 v1, a10
mf v[188:191],a[240:243],v[32:35],v[244:247]
s_waitcnt vmcnt(24)
s_barrier
mf v[192:195],a[240:243],v[36:39],v[244:247]
tr a[232:233],v8,0
s_add_u32 m0, s4, 0x1c000
mf v[184:187],a[244:247],v[40:43],v[184:187]
tr a[234:235],v8,1024
v_accvgpr_read_b32 v3, a11
mf v[188:191],a[244:247],v[44:47],v[188:191]
ex v172
mf v[192:195],a[244:247],v[48:51],v[192:195]
tr a[236:237],v9,0
s_add_u32 s32, s54, 0x24000
wl 3
mf v[184:187],a[248:251],v[52:55],v[184:187]
tr a[238:239],v9,1024
cv v1,v1,v3
mf v[188:191],a[248:251],v[56:59],v[188:191]
ex v173
mf v[192:195],a[248:251],v[60:63],v[192:195]
tr a[240:241],v10,0
v_accvgpr_write_b32 a53, v1
mf v[184:187],a[252:255],v[64:67],v[184:187]
tr a[242:243],v10,1024
v_accvgpr_read_b32 v26, a12
mf v[188:191],a[252:255],v[68:71],v[188:191]
ex v174
mf v[192:195],a[252:255],v[72:75],v[192:195]
tr a[244:245],v11,0
v_accvgpr_read_b32 v27, a13
mf a[216:219],a[228:231],v[232:235],a[216:219]
tr a[246:247],v11,1024
cv v26,v26,v27
mf a[220:223],a[228:231],v[236:239],a[220:223]
ex v175
mf a[224:227],a[228:231],v[240:243],a[224:227]
tr a[248:249],v12,0
v_accvgpr_write_b32 a54, v26
wl 5
mf v[76:79],a[232:235],v[232:235],v[76:79]
tr a[250:251],v12,1024
v_accvgpr_read_b32 v1, a14
mf v[80:83],a[232:235],v[236:239],v[80:83]
ex v176
mf v[84:87],a[232:235],v[240:243],v[84:87]
tr a[252:253],v13,0
dl v20,s[20:23],s32,0
mf v[88:91],a[236:239],v[232:235],v[88:91]
tr a[254:255],v13,1024
v_accvgpr_read_b32 v3, a15
mf v[92:95],a[236:239],v[236:239],v[92:95]
ex v177
mf v[96:99],a[236:239],v[240:243],v[96:99]
tr a[232:233],v14,0
dl v21,s[20:23],s32,1024
wl 5
mf v[100:103],a[240:243],v[232:235],v[100:103]
tr a[234:235],v14,1024
cv v1,v1,v3
mf v[104:107],a[240:243],v[236:239],v[104:107]
ex v178
mf v[108:111],a[240:243],v[240:243],v[108:111]
tr a[236:237],v15,0
v_accvgpr_write_b32 a55, v1
mf v[112:115],a[244:247],v[232:235],v[112:115]
tr a[238:239],v15,1024
dl v22,s[20:23],s32,2048
mf v[116:119],a[244:247],v[236:239],v[116:119]
s_waitcnt vmcnt(23)
s_barrier
mf v[120:123],a[244:247],v[240:243],v[120:123]
tr a[240:241],v248,32768
cv v220,v172,v173
wl 5
mf v[124:127],a[248:251],v[232:235],v[124:127]
tr a[242:243],v248,34816
dl v23,s[20:23],s32,3072
mf v[128:131],a[248:251],v[236:239],v[128:131]
ex v179
mf v[132:135],a[248:251],v[240:243],v[132:135]
tr a[244:245],v249,32768
s_add_u32 m0, s4, 0x4000
mf v[136:139],a[252:255],v[232:235],v[136:139]
tr a[246:247],v249,34816
s_add_u32 s32, s98, 0x12000
mf v[140:143],a[252:255],v[236:239],v[140:143]
ex v180
mf v[144:147],a[252:255],v[240:243],v[144:147]
tr a[248:249],v248,36864
s_and_b32 s32, s32, 0x1ffff
wl 5
mf v[148:151],a[232:235],v[232:235],v[148:151]
tr a[250:251],v248,38912
cv v221,v174,v175
mf v[152:155],a[232:235],v[236:239],v[152:155]
ex v181
mf v[156:159],a[232:235],v[240:243],v[156:159]
tr a[252:253],v249,36864
v_accvgpr_read_b32 v26, a16
mf v[160:163],a[236:239],v[232:235],v[160:163]
tr a[254:255],v249,38912
cv v224,v176,v177
mf v[164:167],a[236:239],v[236:239],v[164:167]
ex v182
mf v[168:171],a[236:239],v[240:243],v[168:171]
s_cmp_lg_u32 s100, 1
s_cbranch_scc1 L_hc5
s_mov_b32 s48, s70
s_and_b32 s49, s71, 0xffff
s_mov_b32 s50, 256
s_mov_b32 s51, 0x20000
s_lshl_b32 s36, s40, 3
v_mov_b32 v255, 0
s_nop 0
buffer_load_dword v255, v255, s[48:51], s36 offen sc1
L_hc5:
wl 4
mf a[24:27],a[240:243],a[144:147],a[24:27]
tr a[232:233],v248,40960
cv v225,v178,v179
mf a[28:31],a[240:243],a[148:151],a[28:31]
tr a[234:235],v248,43008
cv v228,v180,v181
mf a[32:35],a[240:243],a[152:155],a[32:35]
tr a[236:237],v249,40960
v_accvgpr_read_b32 v27, a17
mf a[36:39],a[244:247],a[144:147],a[36:39]
tr a[238:239],v249,43008
cv v26,v26,v27
mf a[40:43],a[244:247],a[148:151],a[40:43]
ex v183
mf a[44:47],a[244:247],a[152:155],a[44:47]
tr a[240:241],v248,45056
dn v16,s[8:11],s32,0
wl 5
mf a[24:27],a[248:251],a[156:159],a[24:27]
tr a[242:243],v248,47104
cv v229,v182,v183
mf a[28:31],a[248:251],a[160:163],a[28:31]
ex v184
mf a[32:35],a[248:251],a[164:167],a[32:35]
tr a[244:245],v249,45056
v_accvgpr_write_b32 a56, v26
mf a[36:39],a[252:255],a[156:159],a[36:39]
tr a[246:247],v249,47104
dn v16,s[8:11],s32,1024
mf a[40:43],a[252:255],a[160:163],a[40:43]
s_waitcnt vmcnt(22)
s_barrier
mf a[44:47],a[252:255],a[164:167],a[44:47]
rq a[248:251],v4,32768
v_accvgpr_read_b32 v1, a18
wl 5
mf a[24:27],a[232:235],a[192:195],a[24:27]
ex v185
mf a[28:31],a[232:235],a[196:199],a[28:31]
ex v186
mf a[32:35],a[232:235],a[200:203],a[32:35]
rq a[252:255],v5,32768
dn v17,s[8:11],s32,2048
mf a[36:39],a[236:239],a[192:195],a[36:39]
ex v187
mf a[40:43],a[236:239],a[196:199],a[40:43]
ex v188
mf a[44:47],a[236:239],a[200:203],a[44:47]
rq a[232:235],v6,32768
dn v17,s[8:11],s32,3072
wl 3
mf a[24:27],a[240:243],a[204:207],a[24:27]
ex v189
mf a[28:31],a[240:243],a[208:211],a[28:31]
ex v190
mf a[32:35],a[240:243],a[212:215],a[32:35]
rq a[236:239],v7,32768
s_add_u32 m0, s4, 0xc000
mf a[36:39],a[244:247],a[204:207],a[36:39]
ex v191
mf a[40:43],a[244:247],a[208:211],a[40:43]
ex v192
mf a[44:47],a[244:247],a[212:215],a[44:47]
rq a[240:243],v4,33792
s_add_u32 s32, s98, 0x10000
wl 3
mf v[196:199],a[248:251],v[28:31],v[244:247]
ex v193
mf v[200:203],a[248:251],v[32:35],v[244:247]
ex v194
mf v[204:207],a[248:251],v[36:39],v[244:247]
v_accvgpr_read_b32 v3, a19
cv v1,v1,v3
v_accvgpr_write_b32 a57, v1
v_accvgpr_read_b32 v26, a20
v_accvgpr_read_b32 v27, a21
cv v26,v26,v27
v_accvgpr_write_b32 a58, v26
v_accvgpr_read_b32 v1, a22
v_accvgpr_read_b32 v3, a23
cv v1,v1,v3
v_accvgpr_write_b32 a59, v1
mf v[196:199],a[252:255],v[40:43],v[196:199]
rq a[244:247],v5,33792
s_and_b32 s32, s32, 0x1ffff
mf v[200:203],a[252:255],v[44:47],v[200:203]
ex v195
mf v[204:207],a[252:255],v[48:51],v[204:207]
rq a[248:251],v6,33792
cv v222,v184,v185
wl 3
mf v[196:199],a[232:235],v[52:55],v[196:199]
dn v18,s[12:15],s32,0
mf v[200:203],a[232:235],v[56:59],v[200:203]
dn v18,s[12:15],s32,1024
mf v[204:207],a[232:235],v[60:63],v[204:207]
rq a[252:255],v7,33792
cv v223,v186,v187
mf v[196:199],a[236:239],v[64:67],v[196:199]
dn v19,s[12:15],s32,2048
mf v[200:203],a[236:239],v[68:71],v[200:203]
dn v19,s[12:15],s32,3072
mf v[204:207],a[236:239],v[72:75],v[204:207]
cv v226,v188,v189
cv v227,v190,v191
wl 2
mf v[208:211],a[240:243],v[28:31],v[244:247]
cv v230,v192,v193
cv v231,v194,v195
mf v[212:215],a[240:243],v[32:35],v[244:247]
s_waitcnt vmcnt(24)
s_barrier
mf v[216:219],a[240:243],v[36:39],v[244:247]
tr a[232:233],v8,16384
s_add_u32 m0, s4, 0x24000
mf v[208:211],a[244:247],v[40:43],v[208:211]
tr a[234:235],v8,17408
v_accvgpr_read_b32 v26, a24
mf v[212:215],a[244:247],v[44:47],v[212:215]
ex v196
mf v[216:219],a[244:247],v[48:51],v[216:219]
tr a[236:237],v9,16384
v_accvgpr_read_b32 v27, a25
wl 3
mf v[208:211],a[248:251],v[52:55],v[208:211]
tr a[238:239],v9,17408
cv v26,v26,v27
mf v[212:215],a[248:251],v[56:59],v[212:215]
ex v197
mf v[216:219],a[248:251],v[60:63],v[216:219]
tr a[240:241],v10,16384
v_accvgpr_write_b32 a60, v26
mf v[208:211],a[252:255],v[64:67],v[208:211]
tr a[242:243],v10,17408
cv v232,v196,v197
mf v[212:215],a[252:255],v[68:71],v[212:215]
ex v198
mf v[216:219],a[252:255],v[72:75],v[216:219]
tr a[244:245],v11,16384
v_accvgpr_read_b32 v1, a26
mf a[216:219],a[228:231],v[220:223],a[216:219]
tr a[246:247],v11,17408
v_accvgpr_read_b32 v3, a27
mf a[220:223],a[228:231],v[224:227],a[220:223]
ex v199
mf a[224:227],a[228:231],v[228:231],a[224:227]
tr a[248:249],v12,16384
dl v20,s[20:23],s55,0
wl 5
mf v[76:79],a[232:235],v[220:223],v[76:79]
tr a[250:251],v12,17408
cv v233,v198,v199
mf v[80:83],a[232:235],v[224:227],v[80:83]
ex v200
mf v[84:87],a[232:235],v[228:231],v[84:87]
tr a[252:253],v13,16384
dl v21,s[20:23],s55,1024
mf v[88:91],a[236:239],v[220:223],v[88:91]
tr a[254:255],v13,17408
cv v1,v1,v3
mf v[92:95],a[236:239],v[224:227],v[92:95]
ex v201
mf v[96:99],a[236:239],v[228:231],v[96:99]
tr a[232:233],v14,16384
dl v22,s[20:23],s55,2048
wl 5
mf v[100:103],a[240:243],v[220:223],v[100:103]
tr a[234:235],v14,17408
cv v236,v200,v201
mf v[104:107],a[240:243],v[224:227],v[104:107]
ex v202
mf v[108:111],a[240:243],v[228:231],v[108:111]
tr a[236:237],v15,16384
v_accvgpr_write_b32 a61, v1
mf v[112:115],a[244:247],v[220:223],v[112:115]
tr a[238:239],v15,17408
dl v23,s[20:23],s55,3072
mf v[116:119],a[244:247],v[224:227],v[116:119]
s_waitcnt vmcnt(24)
s_barrier
mf v[120:123],a[244:247],v[228:231],v[120:123]
tr a[240:241],v248,0
s_add_u32 m0, s4, 0x8000
wl 5
mf v[124:127],a[248:251],v[220:223],v[124:127]
tr a[242:243],v248,2048
v_accvgpr_read_b32 v26, a28
mf v[128:131],a[248:251],v[224:227],v[128:131]
ex v203
mf v[132:135],a[248:251],v[228:231],v[132:135]
tr a[244:245],v249,0
s_add_u32 s32, s98, 0x14000
mf v[136:139],a[252:255],v[220:223],v[136:139]
tr a[246:247],v249,2048
cv v237,v202,v203
mf v[140:143],a[252:255],v[224:227],v[140:143]
ex v204
mf v[144:147],a[252:255],v[228:231],v[144:147]
tr a[248:249],v248,4096
s_and_b32 s32, s32, 0x1ffff
wl 5
mf v[148:151],a[232:235],v[220:223],v[148:151]
tr a[250:251],v248,6144
v_accvgpr_read_b32 v27, a29
mf v[152:155],a[232:235],v[224:227],v[152:155]
ex v205
mf v[156:159],a[232:235],v[228:231],v[156:159]
tr a[252:253],v249,4096
cv v240,v204,v205
mf v[160:163],a[236:239],v[220:223],v[160:163]
tr a[254:255],v249,6144
cv v26,v26,v27
mf v[164:167],a[236:239],v[224:227],v[164:167]
ex v206
mf v[168:171],a[236:239],v[228:231],v[168:171]
s_cmp_lg_u32 s100, 2
s_cbranch_scc1 L_hc6
s_mov_b32 s48, s70
s_and_b32 s49, s71, 0xffff
s_mov_b32 s50, 256
s_mov_b32 s51, 0x20000
s_lshl_b32 s36, s40, 3
v_mov_b32 v255, 0
s_nop 0
buffer_load_dword v255, v255, s[48:51], s36 offen sc1
L_hc6:
wl 4
mf a[0:3],a[240:243],a[96:99],0
tr a[232:233],v248,8192
v_accvgpr_write_b32 a62, v26
mf a[4:7],a[240:243],a[100:103],0
tr a[234:235],v248,10240
v_accvgpr_read_b32 v1, a30
mf a[8:11],a[240:243],a[104:107],0
tr a[236:237],v249,8192
v_accvgpr_read_b32 v3, a31
mf a[12:15],a[244:247],a[96:99],0
tr a[238:239],v249,10240
cv v1,v1,v3
mf a[16:19],a[244:247],a[100:103],0
ex v207
mf a[20:23],a[244:247],a[104:107],0
tr a[240:241],v248,12288
dn v16,s[8:11],s32,0
wl 5
mf a[0:3],a[248:251],a[108:111],a[0:3]
tr a[242:243],v248,14336
cv v241,v206,v207
mf a[4:7],a[248:251],a[112:115],a[4:7]
ex v208
mf a[8:11],a[248:251],a[116:119],a[8:11]
tr a[244:245],v249,12288
v_accvgpr_write_b32 a63, v1
mf a[12:15],a[252:255],a[108:111],a[12:15]
tr a[246:247],v249,14336
dn v16,s[8:11],s32,1024
mf a[16:19],a[252:255],a[112:115],a[16:19]
s_waitcnt vmcnt(22)
s_barrier
mf a[20:23],a[252:255],a[116:119],a[20:23]
rq a[248:251],v4,0
v_accvgpr_read_b32 v26, a32
wl 5
mf a[0:3],a[232:235],a[120:123],a[0:3]
ex v209
mf a[4:7],a[232:235],a[124:127],a[4:7]
ex v210
mf a[8:11],a[232:235],a[128:131],a[8:11]
rq a[252:255],v5,0
dn v17,s[8:11],s32,2048
mf a[12:15],a[236:239],a[120:123],a[12:15]
ex v211
mf a[16:19],a[236:239],a[124:127],a[16:19]
ex v212
mf a[20:23],a[236:239],a[128:131],a[20:23]
rq a[232:235],v6,0
dn v17,s[8:11],s32,3072
wl 3
mf a[0:3],a[240:243],a[132:135],a[0:3]
ex v213
mf a[4:7],a[240:243],a[136:139],a[4:7]
ex v214
mf a[8:11],a[240:243],a[140:143],a[8:11]
rq a[236:239],v7,0
s_add_u32 m0, s4, 0x10000
mf a[12:15],a[244:247],a[132:135],a[12:15]
ex v215
mf a[16:19],a[244:247],a[136:139],a[16:19]
ex v216
mf a[20:23],a[244:247],a[140:143],a[20:23]
rq a[240:243],v4,1024
s_add_u32 s32, s98, 0x12000
wl 3
mf v[172:175],a[248:251],v[28:31],v[244:247]
ex v217
mf v[176:179],a[248:251],v[32:35],v[244:247]
ex v218
mf v[180:183],a[248:251],v[36:39],v[244:247]
rq a[244:247],v5,1024
s_and_b32 s32, s32, 0x1ffff
mf v[172:175],a[252:255],v[40:43],v[172:175]
ex v219
mf v[176:179],a[252:255],v[44:47],v[176:179]
dn v18,s[12:15],s32,0
mf v[180:183],a[252:255],v[48:51],v[180:183]
rq a[248:251],v6,1024
cv v234,v208,v209
wl 3
mf v[172:175],a[232:235],v[52:55],v[172:175]
dn v18,s[12:15],s32,1024
mf v[176:179],a[232:235],v[56:59],v[176:179]
dn v19,s[12:15],s32,2048
mf v[180:183],a[232:235],v[60:63],v[180:183]
rq a[252:255],v7,1024
cv v235,v210,v211
mf v[172:175],a[236:239],v[64:67],v[172:175]
dn v19,s[12:15],s32,3072
mf v[176:179],a[236:239],v[68:71],v[176:179]
cv v238,v212,v213
cv v239,v214,v215
mf v[180:183],a[236:239],v[72:75],v[180:183]
cv v242,v216,v217
cv v243,v218,v219
wl 2
mf v[184:187],a[240:243],v[28:31],v[244:247]
v_accvgpr_read_b32 v27, a33
cv v26,v26,v27
mf v[188:191],a[240:243],v[32:35],v[244:247]
s_waitcnt vmcnt(24)
s_barrier
mf v[192:195],a[240:243],v[36:39],v[244:247]
tr a[232:233],v8,32768
s_add_u32 m0, s4, 0x20000
mf v[184:187],a[244:247],v[40:43],v[184:187]
tr a[234:235],v8,33792
v_accvgpr_write_b32 a64, v26
mf v[188:191],a[244:247],v[44:47],v[188:191]
ex v172
mf v[192:195],a[244:247],v[48:51],v[192:195]
tr a[236:237],v9,32768
s_add_u32 s32, s55, 0x24000
wl 3
mf v[184:187],a[248:251],v[52:55],v[184:187]
tr a[238:239],v9,33792
v_accvgpr_read_b32 v1, a34
mf v[188:191],a[248:251],v[56:59],v[188:191]
ex v173
mf v[192:195],a[248:251],v[60:63],v[192:195]
tr a[240:241],v10,32768
v_accvgpr_read_b32 v3, a35
mf v[184:187],a[252:255],v[64:67],v[184:187]
tr a[242:243],v10,33792
cv v1,v1,v3
mf v[188:191],a[252:255],v[68:71],v[188:191]
ex v174
mf v[192:195],a[252:255],v[72:75],v[192:195]
tr a[244:245],v11,32768
v_accvgpr_write_b32 a65, v1
mf a[216:219],a[228:231],v[232:235],a[216:219]
tr a[246:247],v11,33792
v_accvgpr_read_b32 v26, a36
mf a[220:223],a[228:231],v[236:239],a[220:223]
ex v175
mf a[224:227],a[228:231],v[240:243],a[224:227]
tr a[248:249],v12,32768
v_accvgpr_read_b32 v27, a37
wl 5
mf v[76:79],a[232:235],v[232:235],v[76:79]
tr a[250:251],v12,33792
cv v26,v26,v27
mf v[80:83],a[232:235],v[236:239],v[80:83]
ex v176
mf v[84:87],a[232:235],v[240:243],v[84:87]
tr a[252:253],v13,32768
dl v20,s[20:23],s32,0
mf v[88:91],a[236:239],v[232:235],v[88:91]
tr a[254:255],v13,33792
v_accvgpr_write_b32 a66, v26
mf v[92:95],a[236:239],v[236:239],v[92:95]
ex v177
mf v[96:99],a[236:239],v[240:243],v[96:99]
tr a[232:233],v14,32768
dl v21,s[20:23],s32,1024
wl 5
mf v[100:103],a[240:243],v[232:235],v[100:103]
tr a[234:235],v14,33792
v_accvgpr_read_b32 v1, a38
mf v[104:107],a[240:243],v[236:239],v[104:107]
ex v178
mf v[108:111],a[240:243],v[240:243],v[108:111]
tr a[236:237],v15,32768
v_accvgpr_read_b32 v3, a39
mf v[112:115],a[244:247],v[232:235],v[112:115]
tr a[238:239],v15,33792
dl v22,s[20:23],s32,2048
mf v[116:119],a[244:247],v[236:239],v[116:119]
s_waitcnt vmcnt(23)
s_barrier
mf v[120:123],a[244:247],v[240:243],v[120:123]
tr a[240:241],v248,16384
cv v1,v1,v3
wl 5
mf v[124:127],a[248:251],v[232:235],v[124:127]
tr a[242:243],v248,18432
dl v23,s[20:23],s32,3072
mf v[128:131],a[248:251],v[236:239],v[128:131]
ex v179
mf v[132:135],a[248:251],v[240:243],v[132:135]
tr a[244:245],v249,16384
s_add_u32 m0, s4, 0x0
mf v[136:139],a[252:255],v[232:235],v[136:139]
tr a[246:247],v249,18432
s_add_u32 s32, s98, 0x16000
mf v[140:143],a[252:255],v[236:239],v[140:143]
ex v180
mf v[144:147],a[252:255],v[240:243],v[144:147]
tr a[248:249],v248,20480
s_and_b32 s32, s32, 0x1ffff
wl 5
mf v[148:151],a[232:235],v[232:235],v[148:151]
tr a[250:251],v248,22528
v_accvgpr_write_b32 a67, v1
mf v[152:155],a[232:235],v[236:239],v[152:155]
ex v181
mf v[156:159],a[232:235],v[240:243],v[156:159]
tr a[252:253],v249,20480
cv v220,v172,v173
mf v[160:163],a[236:239],v[232:235],v[160:163]
tr a[254:255],v249,22528
cv v221,v174,v175
mf v[164:167],a[236:239],v[236:239],v[164:167]
ex v182
mf v[168:171],a[236:239],v[240:243],v[168:171]
s_cmp_lg_u32 s100, 3
s_cbranch_scc1 L_hc7
s_mov_b32 s48, s70
s_and_b32 s49, s71, 0xffff
s_mov_b32 s50, 256
s_mov_b32 s51, 0x20000
s_lshl_b32 s36, s40, 3
v_mov_b32 v255, 0
s_nop 0
buffer_load_dword v255, v255, s[48:51], s36 offen sc1
L_hc7:
wl 4
mf a[0:3],a[240:243],a[144:147],a[0:3]
tr a[232:233],v248,24576
v_accvgpr_read_b32 v26, a40
mf a[4:7],a[240:243],a[148:151],a[4:7]
tr a[234:235],v248,26624
cv v224,v176,v177
mf a[8:11],a[240:243],a[152:155],a[8:11]
tr a[236:237],v249,24576
cv v225,v178,v179
mf a[12:15],a[244:247],a[144:147],a[12:15]
tr a[238:239],v249,26624
cv v228,v180,v181
mf a[16:19],a[244:247],a[148:151],a[16:19]
ex v183
mf a[20:23],a[244:247],a[152:155],a[20:23]
tr a[240:241],v248,28672
dn v16,s[8:11],s32,0
wl 5
mf a[0:3],a[248:251],a[156:159],a[0:3]
tr a[242:243],v248,30720
cv v229,v182,v183
mf a[4:7],a[248:251],a[160:163],a[4:7]
ex v184
mf a[8:11],a[248:251],a[164:167],a[8:11]
tr a[244:245],v249,28672
v_accvgpr_read_b32 v27, a41
mf a[12:15],a[252:255],a[156:159],a[12:15]
tr a[246:247],v249,30720
dn v16,s[8:11],s32,1024
mf a[16:19],a[252:255],a[160:163],a[16:19]
s_waitcnt vmcnt(22)
s_barrier
mf a[20:23],a[252:255],a[164:167],a[20:23]
rq a[248:251],v4,16384
cv v26,v26,v27
wl 5
mf a[0:3],a[232:235],a[192:195],a[0:3]
ex v185
mf a[4:7],a[232:235],a[196:199],a[4:7]
ex v186
mf a[8:11],a[232:235],a[200:203],a[8:11]
rq a[252:255],v5,16384
dn v17,s[8:11],s32,2048
mf a[12:15],a[236:239],a[192:195],a[12:15]
ex v187
mf a[16:19],a[236:239],a[196:199],a[16:19]
ex v188
mf a[20:23],a[236:239],a[200:203],a[20:23]
rq a[232:235],v6,16384
dn v17,s[8:11],s32,3072
wl 3
mf a[0:3],a[240:243],a[204:207],a[0:3]
ex v189
mf a[4:7],a[240:243],a[208:211],a[4:7]
ex v190
mf a[8:11],a[240:243],a[212:215],a[8:11]
rq a[236:239],v7,16384
s_add_u32 m0, s4, 0x14000
mf a[12:15],a[244:247],a[204:207],a[12:15]
ex v191
mf a[16:19],a[244:247],a[208:211],a[16:19]
ex v192
mf a[20:23],a[244:247],a[212:215],a[20:23]
rq a[240:243],v4,17408
s_add_u32 s32, s98, 0x14000
wl 3
mf v[196:199],a[248:251],v[28:31],v[244:247]
ex v193
mf v[200:203],a[248:251],v[32:35],v[244:247]
ex v194
mf v[204:207],a[248:251],v[36:39],v[244:247]
v_accvgpr_write_b32 a68, v26
v_accvgpr_read_b32 v1, a42
v_accvgpr_read_b32 v3, a43
cv v1,v1,v3
v_accvgpr_write_b32 a69, v1
v_accvgpr_read_b32 v26, a44
v_accvgpr_read_b32 v27, a45
cv v26,v26,v27
v_accvgpr_write_b32 a70, v26
v_accvgpr_read_b32 v1, a46
v_accvgpr_read_b32 v3, a47
cv v1,v1,v3
v_accvgpr_write_b32 a71, v1
mf v[196:199],a[252:255],v[40:43],v[196:199]
rq a[244:247],v5,17408
s_and_b32 s32, s32, 0x1ffff
mf v[200:203],a[252:255],v[44:47],v[200:203]
ex v195
mf v[204:207],a[252:255],v[48:51],v[204:207]
rq a[248:251],v6,17408
cv v222,v184,v185
wl 3
mf v[196:199],a[232:235],v[52:55],v[196:199]
dn v18,s[12:15],s32,0
mf v[200:203],a[232:235],v[56:59],v[200:203]
dn v18,s[12:15],s32,1024
mf v[204:207],a[232:235],v[60:63],v[204:207]
rq a[252:255],v7,17408
cv v223,v186,v187
mf v[196:199],a[236:239],v[64:67],v[196:199]
dn v19,s[12:15],s32,2048
mf v[200:203],a[236:239],v[68:71],v[200:203]
dn v19,s[12:15],s32,3072
mf v[204:207],a[236:239],v[72:75],v[204:207]
cv v226,v188,v189
cv v227,v190,v191
wl 2
mf v[208:211],a[240:243],v[28:31],v[244:247]
cv v230,v192,v193
cv v231,v194,v195
mf v[212:215],a[240:243],v[32:35],v[244:247]
s_waitcnt vmcnt(24)
s_barrier
mf v[216:219],a[240:243],v[36:39],v[244:247]
tr a[232:233],v8,0
s_add_u32 m0, s4, 0x18000
mf v[208:211],a[244:247],v[40:43],v[208:211]
tr a[234:235],v8,1024
v_accvgpr_read_b32 v26, a0
mf v[212:215],a[244:247],v[44:47],v[212:215]
ex v196
mf v[216:219],a[244:247],v[48:51],v[216:219]
tr a[236:237],v9,0
v_accvgpr_read_b32 v27, a1
wl 3
mf v[208:211],a[248:251],v[52:55],v[208:211]
tr a[238:239],v9,1024
cv v26,v26,v27
mf v[212:215],a[248:251],v[56:59],v[212:215]
ex v197
mf v[216:219],a[248:251],v[60:63],v[216:219]
tr a[240:241],v10,0
v_accvgpr_write_b32 a72, v26
mf v[208:211],a[252:255],v[64:67],v[208:211]
tr a[242:243],v10,1024
cv v232,v196,v197
mf v[212:215],a[252:255],v[68:71],v[212:215]
ex v198
mf v[216:219],a[252:255],v[72:75],v[216:219]
tr a[244:245],v11,0
v_accvgpr_read_b32 v1, a2
mf a[216:219],a[228:231],v[220:223],a[216:219]
tr a[246:247],v11,1024
v_accvgpr_read_b32 v3, a3
mf a[220:223],a[228:231],v[224:227],a[220:223]
ex v199
mf a[224:227],a[228:231],v[228:231],a[224:227]
tr a[248:249],v12,0
dl v20,s[20:23],s56,0
wl 5
mf v[76:79],a[232:235],v[220:223],v[76:79]
tr a[250:251],v12,1024
cv v233,v198,v199
mf v[80:83],a[232:235],v[224:227],v[80:83]
ex v200
mf v[84:87],a[232:235],v[228:231],v[84:87]
tr a[252:253],v13,0
dl v21,s[20:23],s56,1024
mf v[88:91],a[236:239],v[220:223],v[88:91]
tr a[254:255],v13,1024
cv v1,v1,v3
mf v[92:95],a[236:239],v[224:227],v[92:95]
ex v201
mf v[96:99],a[236:239],v[228:231],v[96:99]
tr a[232:233],v14,0
dl v22,s[20:23],s56,2048
wl 5
mf v[100:103],a[240:243],v[220:223],v[100:103]
tr a[234:235],v14,1024
cv v236,v200,v201
mf v[104:107],a[240:243],v[224:227],v[104:107]
ex v202
mf v[108:111],a[240:243],v[228:231],v[108:111]
tr a[236:237],v15,0
v_accvgpr_write_b32 a73, v1
mf v[112:115],a[244:247],v[220:223],v[112:115]
tr a[238:239],v15,1024
dl v23,s[20:23],s56,3072
mf v[116:119],a[244:247],v[224:227],v[116:119]
s_waitcnt vmcnt(24)
s_barrier
mf v[120:123],a[244:247],v[228:231],v[120:123]
tr a[240:241],v248,49152
s_add_u32 m0, s4, 0x4000
wl 5
mf v[124:127],a[248:251],v[220:223],v[124:127]
tr a[242:243],v248,51200
v_accvgpr_read_b32 v26, a4
mf v[128:131],a[248:251],v[224:227],v[128:131]
ex v203
mf v[132:135],a[248:251],v[228:231],v[132:135]
tr a[244:245],v249,49152
s_add_u32 s32, s98, 0x18000
mf v[136:139],a[252:255],v[220:223],v[136:139]
tr a[246:247],v249,51200
cv v237,v202,v203
mf v[140:143],a[252:255],v[224:227],v[140:143]
ex v204
mf v[144:147],a[252:255],v[228:231],v[144:147]
tr a[248:249],v248,53248
s_and_b32 s32, s32, 0x1ffff
wl 5
mf v[148:151],a[232:235],v[220:223],v[148:151]
tr a[250:251],v248,55296
v_accvgpr_read_b32 v27, a5
mf v[152:155],a[232:235],v[224:227],v[152:155]
ex v205
mf v[156:159],a[232:235],v[228:231],v[156:159]
tr a[252:253],v249,53248
cv v240,v204,v205
mf v[160:163],a[236:239],v[220:223],v[160:163]
tr a[254:255],v249,55296
cv v26,v26,v27
mf v[164:167],a[236:239],v[224:227],v[164:167]
ex v206
mf v[168:171],a[236:239],v[228:231],v[168:171]
s_cmp_lg_u32 s100, 4
s_cbranch_scc1 L_hc8
s_mov_b32 s48, s70
s_and_b32 s49, s71, 0xffff
s_mov_b32 s50, 256
s_mov_b32 s51, 0x20000
s_lshl_b32 s36, s40, 3
v_mov_b32 v255, 0
s_nop 0
buffer_load_dword v255, v255, s[48:51], s36 offen sc1
L_hc8:
wl 4
mf a[24:27],a[240:243],a[96:99],0
tr a[232:233],v248,57344
v_accvgpr_write_b32 a74, v26
mf a[28:31],a[240:243],a[100:103],0
tr a[234:235],v248,59392
v_accvgpr_read_b32 v1, a6
mf a[32:35],a[240:243],a[104:107],0
tr a[236:237],v249,57344
v_accvgpr_read_b32 v3, a7
mf a[36:39],a[244:247],a[96:99],0
tr a[238:239],v249,59392
cv v1,v1,v3
mf a[40:43],a[244:247],a[100:103],0
ex v207
mf a[44:47],a[244:247],a[104:107],0
tr a[240:241],v248,61440
dn v16,s[8:11],s32,0
wl 5
mf a[24:27],a[248:251],a[108:111],a[24:27]
tr a[242:243],v248,63488
cv v241,v206,v207
mf a[28:31],a[248:251],a[112:115],a[28:31]
ex v208
mf a[32:35],a[248:251],a[116:119],a[32:35]
tr a[244:245],v249,61440
v_accvgpr_write_b32 a75, v1
mf a[36:39],a[252:255],a[108:111],a[36:39]
tr a[246:247],v249,63488
dn v16,s[8:11],s32,1024
mf a[40:43],a[252:255],a[112:115],a[40:43]
s_waitcnt vmcnt(22)
s_barrier
mf a[44:47],a[252:255],a[116:119],a[44:47]
rq a[248:251],v4,32768
v_accvgpr_read_b32 v26, a8
wl 5
mf a[24:27],a[232:235],a[120:123],a[24:27]
ex v209
mf a[28:31],a[232:235],a[124:127],a[28:31]
ex v210
mf a[32:35],a[232:235],a[128:131],a[32:35]
rq a[252:255],v5,32768
dn v17,s[8:11],s32,2048
mf a[36:39],a[236:239],a[120:123],a[36:39]
ex v211
mf a[40:43],a[236:239],a[124:127],a[40:43]
ex v212
mf a[44:47],a[236:239],a[128:131],a[44:47]
rq a[232:235],v6,32768
dn v17,s[8:11],s32,3072
wl 3
mf a[24:27],a[240:243],a[132:135],a[24:27]
ex v213
mf a[28:31],a[240:243],a[136:139],a[28:31]
ex v214
mf a[32:35],a[240:243],a[140:143],a[32:35]
rq a[236:239],v7,32768
s_add_u32 m0, s4, 0xc000
mf a[36:39],a[244:247],a[132:135],a[36:39]
ex v215
mf a[40:43],a[244:247],a[136:139],a[40:43]
ex v216
mf a[44:47],a[244:247],a[140:143],a[44:47]
rq a[240:243],v4,33792
s_add_u32 s32, s98, 0x16000
wl 3
mf v[172:175],a[248:251],v[28:31],v[244:247]
ex v217
mf v[176:179],a[248:251],v[32:35],v[244:247]
ex v218
mf v[180:183],a[248:251],v[36:39],v[244:247]
rq a[244:247],v5,33792
s_and_b32 s32, s32, 0x1ffff
mf v[172:175],a[252:255],v[40:43],v[172:175]
ex v219
mf v[176:179],a[252:255],v[44:47],v[176:179]
dn v18,s[12:15],s32,0
mf v[180:183],a[252:255],v[48:51],v[180:183]
rq a[248:251],v6,33792
cv v234,v208,v209
wl 3
mf v[172:175],a[232:235],v[52:55],v[172:175]
dn v18,s[12:15],s32,1024
mf v[176:179],a[232:235],v[56:59],v[176:179]
dn v19,s[12:15],s32,2048
mf v[180:183],a[232:235],v[60:63],v[180:183]
rq a[252:255],v7,33792
cv v235,v210,v211
mf v[172:175],a[236:239],v[64:67],v[172:175]
dn v19,s[12:15],s32,3072
mf v[176:179],a[236:239],v[68:71],v[176:179]
cv v238,v212,v213
cv v239,v214,v215
mf v[180:183],a[236:239],v[72:75],v[180:183]
cv v242,v216,v217
cv v243,v218,v219
wl 2
mf v[184:187],a[240:243],v[28:31],v[244:247]
v_accvgpr_read_b32 v27, a9
cv v26,v26,v27
mf v[188:191],a[240:243],v[32:35],v[244:247]
s_waitcnt vmcnt(24)
s_barrier
mf v[192:195],a[240:243],v[36:39],v[244:247]
tr a[232:233],v8,16384
s_add_u32 m0, s4, 0x1c000
mf v[184:187],a[244:247],v[40:43],v[184:187]
tr a[234:235],v8,17408
v_accvgpr_write_b32 a76, v26
mf v[188:191],a[244:247],v[44:47],v[188:191]
ex v172
mf v[192:195],a[244:247],v[48:51],v[192:195]
tr a[236:237],v9,16384
s_add_u32 s32, s56, 0x24000
wl 3
mf v[184:187],a[248:251],v[52:55],v[184:187]
tr a[238:239],v9,17408
v_accvgpr_read_b32 v1, a10
mf v[188:191],a[248:251],v[56:59],v[188:191]
ex v173
mf v[192:195],a[248:251],v[60:63],v[192:195]
tr a[240:241],v10,16384
v_accvgpr_read_b32 v3, a11
mf v[184:187],a[252:255],v[64:67],v[184:187]
tr a[242:243],v10,17408
cv v1,v1,v3
mf v[188:191],a[252:255],v[68:71],v[188:191]
ex v174
mf v[192:195],a[252:255],v[72:75],v[192:195]
tr a[244:245],v11,16384
v_accvgpr_write_b32 a77, v1
mf a[216:219],a[228:231],v[232:235],a[216:219]
tr a[246:247],v11,17408
v_accvgpr_read_b32 v26, a12
mf a[220:223],a[228:231],v[236:239],a[220:223]
ex v175
mf a[224:227],a[228:231],v[240:243],a[224:227]
tr a[248:249],v12,16384
v_accvgpr_read_b32 v27, a13
wl 5
mf v[76:79],a[232:235],v[232:235],v[76:79]
tr a[250:251],v12,17408
cv v26,v26,v27
mf v[80:83],a[232:235],v[236:239],v[80:83]
ex v176
mf v[84:87],a[232:235],v[240:243],v[84:87]
tr a[252:253],v13,16384
dl v20,s[20:23],s32,0
mf v[88:91],a[236:239],v[232:235],v[88:91]
tr a[254:255],v13,17408
v_accvgpr_write_b32 a78, v26
mf v[92:95],a[236:239],v[236:239],v[92:95]
ex v177
mf v[96:99],a[236:239],v[240:243],v[96:99]
tr a[232:233],v14,16384
dl v21,s[20:23],s32,1024
wl 5
mf v[100:103],a[240:243],v[232:235],v[100:103]
tr a[234:235],v14,17408
v_accvgpr_read_b32 v1, a14
mf v[104:107],a[240:243],v[236:239],v[104:107]
ex v178
mf v[108:111],a[240:243],v[240:243],v[108:111]
tr a[236:237],v15,16384
v_accvgpr_read_b32 v3, a15
mf v[112:115],a[244:247],v[232:235],v[112:115]
tr a[238:239],v15,17408
dl v22,s[20:23],s32,2048
mf v[116:119],a[244:247],v[236:239],v[116:119]
s_waitcnt vmcnt(23)
s_barrier
mf v[120:123],a[244:247],v[240:243],v[120:123]
tr a[240:241],v248,32768
cv v1,v1,v3
wl 5
mf v[124:127],a[248:251],v[232:235],v[124:127]
tr a[242:243],v248,34816
dl v23,s[20:23],s32,3072
mf v[128:131],a[248:251],v[236:239],v[128:131]
ex v179
mf v[132:135],a[248:251],v[240:243],v[132:135]
tr a[244:245],v249,32768
s_add_u32 m0, s4, 0x8000
mf v[136:139],a[252:255],v[232:235],v[136:139]
tr a[246:247],v249,34816
s_add_u32 s32, s98, 0x1a000
mf v[140:143],a[252:255],v[236:239],v[140:143]
ex v180
mf v[144:147],a[252:255],v[240:243],v[144:147]
tr a[248:249],v248,36864
s_and_b32 s32, s32, 0x1ffff
wl 5
mf v[148:151],a[232:235],v[232:235],v[148:151]
tr a[250:251],v248,38912
v_accvgpr_write_b32 a79, v1
mf v[152:155],a[232:235],v[236:239],v[152:155]
ex v181
mf v[156:159],a[232:235],v[240:243],v[156:159]
tr a[252:253],v249,36864
cv v220,v172,v173
mf v[160:163],a[236:239],v[232:235],v[160:163]
tr a[254:255],v249,38912
cv v221,v174,v175
mf v[164:167],a[236:239],v[236:239],v[164:167]
ex v182
mf v[168:171],a[236:239],v[240:243],v[168:171]
s_cmp_lg_u32 s100, 5
s_cbranch_scc1 L_hc9
s_mov_b32 s48, s70
s_and_b32 s49, s71, 0xffff
s_mov_b32 s50, 256
s_mov_b32 s51, 0x20000
s_lshl_b32 s36, s40, 3
v_mov_b32 v255, 0
s_nop 0
buffer_load_dword v255, v255, s[48:51], s36 offen sc1
L_hc9:
wl 4
mf a[24:27],a[240:243],a[144:147],a[24:27]
tr a[232:233],v248,40960
v_accvgpr_read_b32 v26, a16
mf a[28:31],a[240:243],a[148:151],a[28:31]
tr a[234:235],v248,43008
cv v224,v176,v177
mf a[32:35],a[240:243],a[152:155],a[32:35]
tr a[236:237],v249,40960
cv v225,v178,v179
mf a[36:39],a[244:247],a[144:147],a[36:39]
tr a[238:239],v249,43008
cv v228,v180,v181
mf a[40:43],a[244:247],a[148:151],a[40:43]
ex v183
mf a[44:47],a[244:247],a[152:155],a[44:47]
tr a[240:241],v248,45056
dn v16,s[8:11],s32,0
wl 5
mf a[24:27],a[248:251],a[156:159],a[24:27]
tr a[242:243],v248,47104
cv v229,v182,v183
mf a[28:31],a[248:251],a[160:163],a[28:31]
ex v184
mf a[32:35],a[248:251],a[164:167],a[32:35]
tr a[244:245],v249,45056
v_accvgpr_read_b32 v27, a17
mf a[36:39],a[252:255],a[156:159],a[36:39]
tr a[246:247],v249,47104
dn v16,s[8:11],s32,1024
mf a[40:43],a[252:255],a[160:163],a[40:43]
s_waitcnt vmcnt(22)
s_barrier
mf a[44:47],a[252:255],a[164:167],a[44:47]
rq a[248:251],v4,0
cv v26,v26,v27
wl 5
mf a[24:27],a[232:235],a[192:195],a[24:27]
ex v185
mf a[28:31],a[232:235],a[196:199],a[28:31]
ex v186
mf a[32:35],a[232:235],a[200:203],a[32:35]
rq a[252:255],v5,0
dn v17,s[8:11],s32,2048
mf a[36:39],a[236:239],a[192:195],a[36:39]
ex v187
mf a[40:43],a[236:239],a[196:199],a[40:43]
ex v188
mf a[44:47],a[236:239],a[200:203],a[44:47]
rq a[232:235],v6,0
dn v17,s[8:11],s32,3072
wl 3
mf a[24:27],a[240:243],a[204:207],a[24:27]
ex v189
mf a[28:31],a[240:243],a[208:211],a[28:31]
ex v190
mf a[32:35],a[240:243],a[212:215],a[32:35]
rq a[236:239],v7,0
s_add_u32 m0, s4, 0x10000
mf a[36:39],a[244:247],a[204:207],a[36:39]
ex v191
mf a[40:43],a[244:247],a[208:211],a[40:43]
ex v192
mf a[44:47],a[244:247],a[212:215],a[44:47]
rq a[240:243],v4,1024
s_add_u32 s32, s98, 0x18000
wl 3
mf v[196:199],a[248:251],v[28:31],v[244:247]
ex v193
mf v[200:203],a[248:251],v[32:35],v[244:247]
ex v194
mf v[204:207],a[248:251],v[36:39],v[244:247]
v_accvgpr_write_b32 a80, v26
v_accvgpr_read_b32 v1, a18
v_accvgpr_read_b32 v3, a19
cv v1,v1,v3
v_accvgpr_write_b32 a81, v1
v_accvgpr_read_b32 v26, a20
v_accvgpr_read_b32 v27, a21
cv v26,v26,v27
v_accvgpr_write_b32 a82, v26
v_accvgpr_read_b32 v1, a22
v_accvgpr_read_b32 v3, a23
cv v1,v1,v3
v_accvgpr_write_b32 a83, v1
mf v[196:199],a[252:255],v[40:43],v[196:199]
rq a[244:247],v5,1024
s_and_b32 s32, s32, 0x1ffff
mf v[200:203],a[252:255],v[44:47],v[200:203]
ex v195
mf v[204:207],a[252:255],v[48:51],v[204:207]
rq a[248:251],v6,1024
cv v222,v184,v185
wl 3
mf v[196:199],a[232:235],v[52:55],v[196:199]
dn v18,s[12:15],s32,0
mf v[200:203],a[232:235],v[56:59],v[200:203]
dn v18,s[12:15],s32,1024
mf v[204:207],a[232:235],v[60:63],v[204:207]
rq a[252:255],v7,1024
cv v223,v186,v187
mf v[196:199],a[236:239],v[64:67],v[196:199]
dn v19,s[12:15],s32,2048
mf v[200:203],a[236:239],v[68:71],v[200:203]
dn v19,s[12:15],s32,3072
mf v[204:207],a[236:239],v[72:75],v[204:207]
cv v226,v188,v189
cv v227,v190,v191
wl 2
mf v[208:211],a[240:243],v[28:31],v[244:247]
cv v230,v192,v193
cv v231,v194,v195
mf v[212:215],a[240:243],v[32:35],v[244:247]
s_waitcnt vmcnt(24)
s_barrier
mf v[216:219],a[240:243],v[36:39],v[244:247]
tr a[232:233],v8,32768
s_add_u32 m0, s4, 0x24000
mf v[208:211],a[244:247],v[40:43],v[208:211]
tr a[234:235],v8,33792
v_accvgpr_read_b32 v26, a24
mf v[212:215],a[244:247],v[44:47],v[212:215]
ex v196
mf v[216:219],a[244:247],v[48:51],v[216:219]
tr a[236:237],v9,32768
v_accvgpr_read_b32 v27, a25
wl 3
mf v[208:211],a[248:251],v[52:55],v[208:211]
tr a[238:239],v9,33792
cv v26,v26,v27
mf v[212:215],a[248:251],v[56:59],v[212:215]
ex v197
mf v[216:219],a[248:251],v[60:63],v[216:219]
tr a[240:241],v10,32768
v_accvgpr_write_b32 a84, v26
mf v[208:211],a[252:255],v[64:67],v[208:211]
tr a[242:243],v10,33792
cv v232,v196,v197
mf v[212:215],a[252:255],v[68:71],v[212:215]
ex v198
mf v[216:219],a[252:255],v[72:75],v[216:219]
tr a[244:245],v11,32768
v_accvgpr_read_b32 v1, a26
mf a[216:219],a[228:231],v[220:223],a[216:219]
tr a[246:247],v11,33792
v_accvgpr_read_b32 v3, a27
mf a[220:223],a[228:231],v[224:227],a[220:223]
ex v199
mf a[224:227],a[228:231],v[228:231],a[224:227]
tr a[248:249],v12,32768
dl v20,s[20:23],s57,0
wl 5
mf v[76:79],a[232:235],v[220:223],v[76:79]
tr a[250:251],v12,33792
cv v233,v198,v199
mf v[80:83],a[232:235],v[224:227],v[80:83]
ex v200
mf v[84:87],a[232:235],v[228:231],v[84:87]
tr a[252:253],v13,32768
dl v21,s[20:23],s57,1024
mf v[88:91],a[236:239],v[220:223],v[88:91]
tr a[254:255],v13,33792
cv v1,v1,v3
mf v[92:95],a[236:239],v[224:227],v[92:95]
ex v201
mf v[96:99],a[236:239],v[228:231],v[96:99]
tr a[232:233],v14,32768
dl v22,s[20:23],s57,2048
wl 5
mf v[100:103],a[240:243],v[220:223],v[100:103]
tr a[234:235],v14,33792
cv v236,v200,v201
mf v[104:107],a[240:243],v[224:227],v[104:107]
ex v202
mf v[108:111],a[240:243],v[228:231],v[108:111]
tr a[236:237],v15,32768
v_accvgpr_write_b32 a85, v1
mf v[112:115],a[244:247],v[220:223],v[112:115]
tr a[238:239],v15,33792
dl v23,s[20:23],s57,3072
mf v[116:119],a[244:247],v[224:227],v[116:119]
s_waitcnt vmcnt(24)
s_barrier
mf v[120:123],a[244:247],v[228:231],v[120:123]
tr a[240:241],v248,0
s_add_u32 m0, s4, 0x0
wl 5
mf v[124:127],a[248:251],v[220:223],v[124:127]
tr a[242:243],v248,2048
v_accvgpr_read_b32 v26, a28
mf v[128:131],a[248:251],v[224:227],v[128:131]
ex v203
mf v[132:135],a[248:251],v[228:231],v[132:135]
tr a[244:245],v249,0
s_add_u32 s32, s98, 0x1c000
mf v[136:139],a[252:255],v[220:223],v[136:139]
tr a[246:247],v249,2048
cv v237,v202,v203
mf v[140:143],a[252:255],v[224:227],v[140:143]
ex v204
mf v[144:147],a[252:255],v[228:231],v[144:147]
tr a[248:249],v248,4096
s_and_b32 s32, s32, 0x1ffff
wl 5
mf v[148:151],a[232:235],v[220:223],v[148:151]
tr a[250:251],v248,6144
v_accvgpr_read_b32 v27, a29
mf v[152:155],a[232:235],v[224:227],v[152:155]
ex v205
mf v[156:159],a[232:235],v[228:231],v[156:159]
tr a[252:253],v249,4096
cv v240,v204,v205
mf v[160:163],a[236:239],v[220:223],v[160:163]
tr a[254:255],v249,6144
cv v26,v26,v27
mf v[164:167],a[236:239],v[224:227],v[164:167]
ex v206
mf v[168:171],a[236:239],v[228:231],v[168:171]
s_cmp_lg_u32 s100, 6
s_cbranch_scc1 L_hc10
s_mov_b32 s48, s70
s_and_b32 s49, s71, 0xffff
s_mov_b32 s50, 256
s_mov_b32 s51, 0x20000
s_lshl_b32 s36, s40, 3
v_mov_b32 v255, 0
s_nop 0
buffer_load_dword v255, v255, s[48:51], s36 offen sc1
L_hc10:
wl 4
mf a[0:3],a[240:243],a[96:99],0
tr a[232:233],v248,8192
v_accvgpr_write_b32 a86, v26
mf a[4:7],a[240:243],a[100:103],0
tr a[234:235],v248,10240
v_accvgpr_read_b32 v1, a30
mf a[8:11],a[240:243],a[104:107],0
tr a[236:237],v249,8192
v_accvgpr_read_b32 v3, a31
mf a[12:15],a[244:247],a[96:99],0
tr a[238:239],v249,10240
cv v1,v1,v3
mf a[16:19],a[244:247],a[100:103],0
ex v207
mf a[20:23],a[244:247],a[104:107],0
tr a[240:241],v248,12288
dn v16,s[8:11],s32,0
wl 5
mf a[0:3],a[248:251],a[108:111],a[0:3]
tr a[242:243],v248,14336
cv v241,v206,v207
mf a[4:7],a[248:251],a[112:115],a[4:7]
ex v208
mf a[8:11],a[248:251],a[116:119],a[8:11]
tr a[244:245],v249,12288
v_accvgpr_write_b32 a87, v1
mf a[12:15],a[252:255],a[108:111],a[12:15]
tr a[246:247],v249,14336
dn v16,s[8:11],s32,1024
mf a[16:19],a[252:255],a[112:115],a[16:19]
s_waitcnt vmcnt(22)
s_barrier
mf a[20:23],a[252:255],a[116:119],a[20:23]
rq a[248:251],v4,16384
v_accvgpr_read_b32 v26, a32
wl 5
mf a[0:3],a[232:235],a[120:123],a[0:3]
ex v209
mf a[4:7],a[232:235],a[124:127],a[4:7]
ex v210
mf a[8:11],a[232:235],a[128:131],a[8:11]
rq a[252:255],v5,16384
dn v17,s[8:11],s32,2048
mf a[12:15],a[236:239],a[120:123],a[12:15]
ex v211
mf a[16:19],a[236:239],a[124:127],a[16:19]
ex v212
mf a[20:23],a[236:239],a[128:131],a[20:23]
rq a[232:235],v6,16384
dn v17,s[8:11],s32,3072
wl 3
mf a[0:3],a[240:243],a[132:135],a[0:3]
ex v213
mf a[4:7],a[240:243],a[136:139],a[4:7]
ex v214
mf a[8:11],a[240:243],a[140:143],a[8:11]
rq a[236:239],v7,16384
s_add_u32 m0, s4, 0x14000
mf a[12:15],a[244:247],a[132:135],a[12:15]
ex v215
mf a[16:19],a[244:247],a[136:139],a[16:19]
ex v216
mf a[20:23],a[244:247],a[140:143],a[20:23]
rq a[240:243],v4,17408
s_add_u32 s32, s98, 0x1a000
wl 3
mf v[172:175],a[248:251],v[28:31],v[244:247]
ex v217
mf v[176:179],a[248:251],v[32:35],v[244:247]
ex v218
mf v[180:183],a[248:251],v[36:39],v[244:247]
rq a[244:247],v5,17408
s_and_b32 s32, s32, 0x1ffff
mf v[172:175],a[252:255],v[40:43],v[172:175]
ex v219
mf v[176:179],a[252:255],v[44:47],v[176:179]
dn v18,s[12:15],s32,0
mf v[180:183],a[252:255],v[48:51],v[180:183]
rq a[248:251],v6,17408
cv v234,v208,v209
wl 3
mf v[172:175],a[232:235],v[52:55],v[172:175]
dn v18,s[12:15],s32,1024
mf v[176:179],a[232:235],v[56:59],v[176:179]
dn v19,s[12:15],s32,2048
mf v[180:183],a[232:235],v[60:63],v[180:183]
rq a[252:255],v7,17408
cv v235,v210,v211
mf v[172:175],a[236:239],v[64:67],v[172:175]
dn v19,s[12:15],s32,3072
mf v[176:179],a[236:239],v[68:71],v[176:179]
cv v238,v212,v213
cv v239,v214,v215
mf v[180:183],a[236:239],v[72:75],v[180:183]
cv v242,v216,v217
cv v243,v218,v219
wl 2
mf v[184:187],a[240:243],v[28:31],v[244:247]
v_accvgpr_read_b32 v27, a33
cv v26,v26,v27
mf v[188:191],a[240:243],v[32:35],v[244:247]
s_waitcnt vmcnt(24)
s_barrier
mf v[192:195],a[240:243],v[36:39],v[244:247]
tr a[232:233],v8,0
s_add_u32 m0, s4, 0x20000
mf v[184:187],a[244:247],v[40:43],v[184:187]
tr a[234:235],v8,1024
v_accvgpr_write_b32 a88, v26
mf v[188:191],a[244:247],v[44:47],v[188:191]
ex v172
mf v[192:195],a[244:247],v[48:51],v[192:195]
tr a[236:237],v9,0
s_add_u32 s32, s57, 0x24000
wl 3
mf v[184:187],a[248:251],v[52:55],v[184:187]
tr a[238:239],v9,1024
v_accvgpr_read_b32 v1, a34
mf v[188:191],a[248:251],v[56:59],v[188:191]
ex v173
mf v[192:195],a[248:251],v[60:63],v[192:195]
tr a[240:241],v10,0
v_accvgpr_read_b32 v3, a35
mf v[184:187],a[252:255],v[64:67],v[184:187]
tr a[242:243],v10,1024
cv v1,v1,v3
mf v[188:191],a[252:255],v[68:71],v[188:191]
ex v174
mf v[192:195],a[252:255],v[72:75],v[192:195]
tr a[244:245],v11,0
v_accvgpr_write_b32 a89, v1
mf a[216:219],a[228:231],v[232:235],a[216:219]
tr a[246:247],v11,1024
v_accvgpr_read_b32 v26, a36
mf a[220:223],a[228:231],v[236:239],a[220:223]
ex v175
mf a[224:227],a[228:231],v[240:243],a[224:227]
tr a[248:249],v12,0
v_accvgpr_read_b32 v27, a37
wl 5
mf v[76:79],a[232:235],v[232:235],v[76:79]
tr a[250:251],v12,1024
cv v26,v26,v27
mf v[80:83],a[232:235],v[236:239],v[80:83]
ex v176
mf v[84:87],a[232:235],v[240:243],v[84:87]
tr a[252:253],v13,0
dl v20,s[20:23],s32,0
mf v[88:91],a[236:239],v[232:235],v[88:91]
tr a[254:255],v13,1024
v_accvgpr_write_b32 a90, v26
mf v[92:95],a[236:239],v[236:239],v[92:95]
ex v177
mf v[96:99],a[236:239],v[240:243],v[96:99]
tr a[232:233],v14,0
dl v21,s[20:23],s32,1024
wl 5
mf v[100:103],a[240:243],v[232:235],v[100:103]
tr a[234:235],v14,1024
v_accvgpr_read_b32 v1, a38
mf v[104:107],a[240:243],v[236:239],v[104:107]
ex v178
mf v[108:111],a[240:243],v[240:243],v[108:111]
tr a[236:237],v15,0
v_accvgpr_read_b32 v3, a39
mf v[112:115],a[244:247],v[232:235],v[112:115]
tr a[238:239],v15,1024
dl v22,s[20:23],s32,2048
mf v[116:119],a[244:247],v[236:239],v[116:119]
s_waitcnt vmcnt(23)
s_barrier
mf v[120:123],a[244:247],v[240:243],v[120:123]
tr a[240:241],v248,16384
cv v1,v1,v3
wl 5
mf v[124:127],a[248:251],v[232:235],v[124:127]
tr a[242:243],v248,18432
dl v23,s[20:23],s32,3072
mf v[128:131],a[248:251],v[236:239],v[128:131]
ex v179
mf v[132:135],a[248:251],v[240:243],v[132:135]
tr a[244:245],v249,16384
s_add_u32 m0, s4, 0x4000
mf v[136:139],a[252:255],v[232:235],v[136:139]
tr a[246:247],v249,18432
s_add_u32 s32, s98, 0x1e000
mf v[140:143],a[252:255],v[236:239],v[140:143]
ex v180
mf v[144:147],a[252:255],v[240:243],v[144:147]
tr a[248:249],v248,20480
s_and_b32 s32, s32, 0x1ffff
wl 5
mf v[148:151],a[232:235],v[232:235],v[148:151]
tr a[250:251],v248,22528
v_accvgpr_write_b32 a91, v1
mf v[152:155],a[232:235],v[236:239],v[152:155]
ex v181
mf v[156:159],a[232:235],v[240:243],v[156:159]
tr a[252:253],v249,20480
cv v220,v172,v173
mf v[160:163],a[236:239],v[232:235],v[160:163]
tr a[254:255],v249,22528
cv v221,v174,v175
mf v[164:167],a[236:239],v[236:239],v[164:167]
ex v182
mf v[168:171],a[236:239],v[240:243],v[168:171]
s_cmp_lg_u32 s100, 7
s_cbranch_scc1 L_hc11
s_mov_b32 s48, s70
s_and_b32 s49, s71, 0xffff
s_mov_b32 s50, 256
s_mov_b32 s51, 0x20000
s_lshl_b32 s36, s40, 3
v_mov_b32 v255, 0
s_nop 0
buffer_load_dword v255, v255, s[48:51], s36 offen sc1
L_hc11:
wl 4
mf a[0:3],a[240:243],a[144:147],a[0:3]
tr a[232:233],v248,24576
v_accvgpr_read_b32 v26, a40
mf a[4:7],a[240:243],a[148:151],a[4:7]
tr a[234:235],v248,26624
cv v224,v176,v177
mf a[8:11],a[240:243],a[152:155],a[8:11]
tr a[236:237],v249,24576
cv v225,v178,v179
mf a[12:15],a[244:247],a[144:147],a[12:15]
tr a[238:239],v249,26624
cv v228,v180,v181
mf a[16:19],a[244:247],a[148:151],a[16:19]
ex v183
mf a[20:23],a[244:247],a[152:155],a[20:23]
tr a[240:241],v248,28672
dn v16,s[8:11],s32,0
wl 5
mf a[0:3],a[248:251],a[156:159],a[0:3]
tr a[242:243],v248,30720
cv v229,v182,v183
mf a[4:7],a[248:251],a[160:163],a[4:7]
ex v184
mf a[8:11],a[248:251],a[164:167],a[8:11]
tr a[244:245],v249,28672
v_accvgpr_read_b32 v27, a41
mf a[12:15],a[252:255],a[156:159],a[12:15]
tr a[246:247],v249,30720
dn v16,s[8:11],s32,1024
mf a[16:19],a[252:255],a[160:163],a[16:19]
s_waitcnt vmcnt(22)
s_barrier
mf a[20:23],a[252:255],a[164:167],a[20:23]
rq a[248:251],v4,32768
cv v26,v26,v27
wl 5
mf a[0:3],a[232:235],a[192:195],a[0:3]
ex v185
mf a[4:7],a[232:235],a[196:199],a[4:7]
ex v186
mf a[8:11],a[232:235],a[200:203],a[8:11]
rq a[252:255],v5,32768
dn v17,s[8:11],s32,2048
mf a[12:15],a[236:239],a[192:195],a[12:15]
ex v187
mf a[16:19],a[236:239],a[196:199],a[16:19]
ex v188
mf a[20:23],a[236:239],a[200:203],a[20:23]
rq a[232:235],v6,32768
dn v17,s[8:11],s32,3072
wl 3
mf a[0:3],a[240:243],a[204:207],a[0:3]
ex v189
mf a[4:7],a[240:243],a[208:211],a[4:7]
ex v190
mf a[8:11],a[240:243],a[212:215],a[8:11]
rq a[236:239],v7,32768
s_add_u32 m0, s4, 0xc000
mf a[12:15],a[244:247],a[204:207],a[12:15]
ex v191
mf a[16:19],a[244:247],a[208:211],a[16:19]
ex v192
mf a[20:23],a[244:247],a[212:215],a[20:23]
rq a[240:243],v4,33792
s_add_u32 s32, s98, 0x1c000
wl 3
mf v[196:199],a[248:251],v[28:31],v[244:247]
ex v193
mf v[200:203],a[248:251],v[32:35],v[244:247]
ex v194
mf v[204:207],a[248:251],v[36:39],v[244:247]
v_accvgpr_write_b32 a92, v26
v_accvgpr_read_b32 v1, a42
v_accvgpr_read_b32 v3, a43
cv v1,v1,v3
v_accvgpr_write_b32 a93, v1
v_accvgpr_read_b32 v26, a44
v_accvgpr_read_b32 v27, a45
cv v26,v26,v27
v_accvgpr_write_b32 a94, v26
v_accvgpr_read_b32 v1, a46
v_accvgpr_read_b32 v3, a47
cv v1,v1,v3
v_accvgpr_write_b32 a95, v1
mf v[196:199],a[252:255],v[40:43],v[196:199]
rq a[244:247],v5,33792
s_and_b32 s32, s32, 0x1ffff
mf v[200:203],a[252:255],v[44:47],v[200:203]
ex v195
mf v[204:207],a[252:255],v[48:51],v[204:207]
rq a[248:251],v6,33792
cv v222,v184,v185
wl 3
mf v[196:199],a[232:235],v[52:55],v[196:199]
dn v18,s[12:15],s32,0
mf v[200:203],a[232:235],v[56:59],v[200:203]
dn v18,s[12:15],s32,1024
mf v[204:207],a[232:235],v[60:63],v[204:207]
rq a[252:255],v7,33792
cv v223,v186,v187
mf v[196:199],a[236:239],v[64:67],v[196:199]
dn v19,s[12:15],s32,2048
mf v[200:203],a[236:239],v[68:71],v[200:203]
dn v19,s[12:15],s32,3072
mf v[204:207],a[236:239],v[72:75],v[204:207]
cv v226,v188,v189
cv v227,v190,v191
wl 2
mf v[208:211],a[240:243],v[28:31],v[244:247]
cv v230,v192,v193
cv v231,v194,v195
mf v[212:215],a[240:243],v[32:35],v[244:247]
s_waitcnt vmcnt(24)
s_barrier
mf v[216:219],a[240:243],v[36:39],v[244:247]
tr a[232:233],v8,16384
s_add_u32 m0, s4, 0x18000
mf v[208:211],a[244:247],v[40:43],v[208:211]
tr a[234:235],v8,17408
v_accvgpr_read_b32 v26, a0
mf v[212:215],a[244:247],v[44:47],v[212:215]
ex v196
mf v[216:219],a[244:247],v[48:51],v[216:219]
tr a[236:237],v9,16384
v_accvgpr_read_b32 v27, a1
wl 3
mf v[208:211],a[248:251],v[52:55],v[208:211]
tr a[238:239],v9,17408
cv v26,v26,v27
mf v[212:215],a[248:251],v[56:59],v[212:215]
ex v197
mf v[216:219],a[248:251],v[60:63],v[216:219]
tr a[240:241],v10,16384
v_accvgpr_write_b32 a168, v26
mf v[208:211],a[252:255],v[64:67],v[208:211]
tr a[242:243],v10,17408
cv v232,v196,v197
mf v[212:215],a[252:255],v[68:71],v[212:215]
ex v198
mf v[216:219],a[252:255],v[72:75],v[216:219]
tr a[244:245],v11,16384
v_accvgpr_read_b32 v1, a2
mf a[216:219],a[228:231],v[220:223],a[216:219]
tr a[246:247],v11,17408
v_accvgpr_read_b32 v3, a3
mf a[220:223],a[228:231],v[224:227],a[220:223]
ex v199
mf a[224:227],a[228:231],v[228:231],a[224:227]
tr a[248:249],v12,16384
dl v20,s[20:23],s58,0
wl 5
mf v[76:79],a[232:235],v[220:223],v[76:79]
tr a[250:251],v12,17408
cv v233,v198,v199
mf v[80:83],a[232:235],v[224:227],v[80:83]
ex v200
mf v[84:87],a[232:235],v[228:231],v[84:87]
tr a[252:253],v13,16384
dl v21,s[20:23],s58,1024
mf v[88:91],a[236:239],v[220:223],v[88:91]
tr a[254:255],v13,17408
cv v1,v1,v3
mf v[92:95],a[236:239],v[224:227],v[92:95]
ex v201
mf v[96:99],a[236:239],v[228:231],v[96:99]
tr a[232:233],v14,16384
dl v22,s[20:23],s58,2048
wl 5
mf v[100:103],a[240:243],v[220:223],v[100:103]
tr a[234:235],v14,17408
cv v236,v200,v201
mf v[104:107],a[240:243],v[224:227],v[104:107]
ex v202
mf v[108:111],a[240:243],v[228:231],v[108:111]
tr a[236:237],v15,16384
v_accvgpr_write_b32 a169, v1
mf v[112:115],a[244:247],v[220:223],v[112:115]
tr a[238:239],v15,17408
dl v23,s[20:23],s58,3072
mf v[116:119],a[244:247],v[224:227],v[116:119]
s_waitcnt vmcnt(24)
s_barrier
mf v[120:123],a[244:247],v[228:231],v[120:123]
tr a[240:241],v248,49152
v_accvgpr_read_b32 v26, a4
wl 5
mf v[124:127],a[248:251],v[220:223],v[124:127]
tr a[242:243],v248,51200
v_accvgpr_read_b32 v27, a5
mf v[128:131],a[248:251],v[224:227],v[128:131]
ex v203
mf v[132:135],a[248:251],v[228:231],v[132:135]
tr a[244:245],v249,49152
cv v237,v202,v203
mf v[136:139],a[252:255],v[220:223],v[136:139]
tr a[246:247],v249,51200
cv v26,v26,v27
mf v[140:143],a[252:255],v[224:227],v[140:143]
ex v204
mf v[144:147],a[252:255],v[228:231],v[144:147]
tr a[248:249],v248,53248
v_accvgpr_write_b32 a170, v26
wl 5
mf v[148:151],a[232:235],v[220:223],v[148:151]
tr a[250:251],v248,55296
v_accvgpr_read_b32 v1, a6
mf v[152:155],a[232:235],v[224:227],v[152:155]
ex v205
mf v[156:159],a[232:235],v[228:231],v[156:159]
tr a[252:253],v249,53248
cv v240,v204,v205
mf v[160:163],a[236:239],v[220:223],v[160:163]
tr a[254:255],v249,55296
v_accvgpr_read_b32 v3, a7
mf v[164:167],a[236:239],v[224:227],v[164:167]
ex v206
mf v[168:171],a[236:239],v[228:231],v[168:171]
tr a[232:233],v248,57344
cv v1,v1,v3
wl 5
mf a[24:27],a[240:243],a[96:99],0
tr a[234:235],v248,59392
v_accvgpr_write_b32 a171, v1
mf a[28:31],a[240:243],a[100:103],0
ex v207
mf a[32:35],a[240:243],a[104:107],0
tr a[236:237],v249,57344
cv v241,v206,v207
mf a[36:39],a[244:247],a[96:99],0
tr a[238:239],v249,59392
v_accvgpr_read_b32 v26, a8
mf a[40:43],a[244:247],a[100:103],0
ex v208
mf a[44:47],a[244:247],a[104:107],0
tr a[240:241],v248,61440
v_accvgpr_read_b32 v27, a9
wl 5
mf a[24:27],a[248:251],a[108:111],a[24:27]
tr a[242:243],v248,63488
cv v26,v26,v27
mf a[28:31],a[248:251],a[112:115],a[28:31]
ex v209
mf a[32:35],a[248:251],a[116:119],a[32:35]
tr a[244:245],v249,61440
cv v234,v208,v209
mf a[36:39],a[252:255],a[108:111],a[36:39]
tr a[246:247],v249,63488
v_accvgpr_write_b32 a172, v26
mf a[40:43],a[252:255],a[112:115],a[40:43]
s_waitcnt vmcnt(20)
s_barrier
mf a[44:47],a[252:255],a[116:119],a[44:47]
rq a[248:251],v4,0
s_add_u32 m0, s4, 0x10000
wl 5
mf a[24:27],a[232:235],a[120:123],a[24:27]
ex v210
mf a[28:31],a[232:235],a[124:127],a[28:31]
ex v211
mf a[32:35],a[232:235],a[128:131],a[32:35]
rq a[252:255],v5,0
s_add_u32 s32, s98, 0x1e000
mf a[36:39],a[236:239],a[120:123],a[36:39]
ex v212
mf a[40:43],a[236:239],a[124:127],a[40:43]
ex v213
mf a[44:47],a[236:239],a[128:131],a[44:47]
rq a[232:235],v6,0
s_and_b32 s32, s32, 0x1ffff
wl 3
mf a[24:27],a[240:243],a[132:135],a[24:27]
ex v214
mf a[28:31],a[240:243],a[136:139],a[28:31]
ex v215
mf a[32:35],a[240:243],a[140:143],a[32:35]
rq a[236:239],v7,0
cv v235,v210,v211
mf a[36:39],a[244:247],a[132:135],a[36:39]
ex v216
mf a[40:43],a[244:247],a[136:139],a[40:43]
ex v217
mf a[44:47],a[244:247],a[140:143],a[44:47]
rq a[240:243],v4,1024
cv v238,v212,v213
wl 3
mf v[172:175],a[248:251],v[28:31],v[244:247]
ex v218
mf v[176:179],a[248:251],v[32:35],v[244:247]
ex v219
mf v[180:183],a[248:251],v[36:39],v[244:247]
rq a[244:247],v5,1024
dn v18,s[12:15],s32,0
mf v[172:175],a[252:255],v[40:43],v[172:175]
dn v18,s[12:15],s32,1024
mf v[176:179],a[252:255],v[44:47],v[176:179]
dn v19,s[12:15],s32,2048
mf v[180:183],a[252:255],v[48:51],v[180:183]
rq a[248:251],v6,1024
dn v19,s[12:15],s32,3072
wl 3
mf v[172:175],a[232:235],v[52:55],v[172:175]
rq a[252:255],v7,1024
s_add_u32 m0, s4, 0x1c000
mf v[176:179],a[232:235],v[56:59],v[176:179]
s_add_u32 s32, s58, 0x24000
cv v239,v214,v215
mf v[180:183],a[232:235],v[60:63],v[180:183]
dl v20,s[20:23],s32,0
mf v[172:175],a[236:239],v[64:67],v[172:175]
dl v21,s[20:23],s32,1024
mf v[176:179],a[236:239],v[68:71],v[176:179]
dl v22,s[20:23],s32,2048
mf v[180:183],a[236:239],v[72:75],v[180:183]
dl v23,s[20:23],s32,3072
wl 2
mf v[184:187],a[240:243],v[28:31],v[244:247]
cv v242,v216,v217
cv v243,v218,v219
mf v[188:191],a[240:243],v[32:35],v[244:247]
s_waitcnt vmcnt(24)
s_barrier
mf v[192:195],a[240:243],v[36:39],v[244:247]
tr a[232:233],v8,32768
s_add_u32 m0, s4, 0x24000
mf v[184:187],a[244:247],v[40:43],v[184:187]
tr a[234:235],v8,33792
v_accvgpr_read_b32 v1, a10
mf v[188:191],a[244:247],v[44:47],v[188:191]
ex v172
mf v[192:195],a[244:247],v[48:51],v[192:195]
tr a[236:237],v9,32768
v_accvgpr_read_b32 v3, a11
wl 3
mf v[184:187],a[248:251],v[52:55],v[184:187]
tr a[238:239],v9,33792
cv v1,v1,v3
mf v[188:191],a[248:251],v[56:59],v[188:191]
ex v173
mf v[192:195],a[248:251],v[60:63],v[192:195]
tr a[240:241],v10,32768
v_accvgpr_write_b32 a173, v1
mf v[184:187],a[252:255],v[64:67],v[184:187]
tr a[242:243],v10,33792
v_accvgpr_read_b32 v26, a12
mf v[188:191],a[252:255],v[68:71],v[188:191]
ex v174
mf v[192:195],a[252:255],v[72:75],v[192:195]
tr a[244:245],v11,32768
v_accvgpr_read_b32 v27, a13
mf a[216:219],a[228:231],v[232:235],a[216:219]
tr a[246:247],v11,33792
cv v26,v26,v27
mf a[220:223],a[228:231],v[236:239],a[220:223]
ex v175
mf a[224:227],a[228:231],v[240:243],a[224:227]
tr a[248:249],v12,32768
dl v20,s[20:23],s59,0
wl 5
mf v[76:79],a[232:235],v[232:235],v[76:79]
tr a[250:251],v12,33792
v_accvgpr_write_b32 a174, v26
mf v[80:83],a[232:235],v[236:239],v[80:83]
ex v176
mf v[84:87],a[232:235],v[240:243],v[84:87]
tr a[252:253],v13,32768
dl v21,s[20:23],s59,1024
mf v[88:91],a[236:239],v[232:235],v[88:91]
tr a[254:255],v13,33792
v_accvgpr_read_b32 v1, a14
mf v[92:95],a[236:239],v[236:239],v[92:95]
ex v177
mf v[96:99],a[236:239],v[240:243],v[96:99]
tr a[232:233],v14,32768
dl v22,s[20:23],s59,2048
wl 5
mf v[100:103],a[240:243],v[232:235],v[100:103]
tr a[234:235],v14,33792
v_accvgpr_read_b32 v3, a15
mf v[104:107],a[240:243],v[236:239],v[104:107]
ex v178
mf v[108:111],a[240:243],v[240:243],v[108:111]
tr a[236:237],v15,32768
cv v1,v1,v3
mf v[112:115],a[244:247],v[232:235],v[112:115]
tr a[238:239],v15,33792
dl v23,s[20:23],s59,3072
mf v[116:119],a[244:247],v[236:239],v[116:119]
s_waitcnt vmcnt(24)
s_barrier
mf v[120:123],a[244:247],v[240:243],v[120:123]
tr a[240:241],v248,32768
v_accvgpr_write_b32 a175, v1
wl 5
mf v[124:127],a[248:251],v[232:235],v[124:127]
tr a[242:243],v248,34816
cv v220,v172,v173
mf v[128:131],a[248:251],v[236:239],v[128:131]
ex v179
mf v[132:135],a[248:251],v[240:243],v[132:135]
tr a[244:245],v249,32768
cv v221,v174,v175
mf v[136:139],a[252:255],v[232:235],v[136:139]
tr a[246:247],v249,34816
v_accvgpr_read_b32 v26, a16
mf v[140:143],a[252:255],v[236:239],v[140:143]
ex v180
mf v[144:147],a[252:255],v[240:243],v[144:147]
tr a[248:249],v248,36864
cv v224,v176,v177
wl 5
mf v[148:151],a[232:235],v[232:235],v[148:151]
tr a[250:251],v248,38912
cv v225,v178,v179
mf v[152:155],a[232:235],v[236:239],v[152:155]
ex v181
mf v[156:159],a[232:235],v[240:243],v[156:159]
tr a[252:253],v249,36864
cv v228,v180,v181
mf v[160:163],a[236:239],v[232:235],v[160:163]
tr a[254:255],v249,38912
v_accvgpr_read_b32 v27, a17
mf v[164:167],a[236:239],v[236:239],v[164:167]
ex v182
mf v[168:171],a[236:239],v[240:243],v[168:171]
tr a[232:233],v248,40960
cv v26,v26,v27
wl 5
mf a[24:27],a[240:243],a[144:147],a[24:27]
tr a[234:235],v248,43008
v_accvgpr_write_b32 a176, v26
mf a[28:31],a[240:243],a[148:151],a[28:31]
ex v183
mf a[32:35],a[240:243],a[152:155],a[32:35]
tr a[236:237],v249,40960
cv v229,v182,v183
mf a[36:39],a[244:247],a[144:147],a[36:39]
tr a[238:239],v249,43008
v_accvgpr_read_b32 v1, a18
mf a[40:43],a[244:247],a[148:151],a[40:43]
ex v184
mf a[44:47],a[244:247],a[152:155],a[44:47]
tr a[240:241],v248,45056
v_accvgpr_read_b32 v3, a19
wl 5
mf a[24:27],a[248:251],a[156:159],a[24:27]
tr a[242:243],v248,47104
cv v1,v1,v3
mf a[28:31],a[248:251],a[160:163],a[28:31]
ex v185
mf a[32:35],a[248:251],a[164:167],a[32:35]
tr a[244:245],v249,45056
cv v222,v184,v185
mf a[36:39],a[252:255],a[156:159],a[36:39]
tr a[246:247],v249,47104
v_accvgpr_write_b32 a177, v1
mf a[40:43],a[252:255],a[160:163],a[40:43]
s_waitcnt vmcnt(20)
s_barrier
mf a[44:47],a[252:255],a[164:167],a[44:47]
rq a[248:251],v4,16384
s_add_u32 m0, s4, 0x14000
wl 5
mf a[24:27],a[232:235],a[192:195],a[24:27]
ex v186
mf a[28:31],a[232:235],a[196:199],a[28:31]
ex v187
mf a[32:35],a[232:235],a[200:203],a[32:35]
rq a[252:255],v5,16384
s_add_u32 s32, s59, 0x24000
mf a[36:39],a[236:239],a[192:195],a[36:39]
ex v188
mf a[40:43],a[236:239],a[196:199],a[40:43]
ex v189
mf a[44:47],a[236:239],a[200:203],a[44:47]
rq a[232:235],v6,16384
cv v223,v186,v187
wl 3
mf a[24:27],a[240:243],a[204:207],a[24:27]
ex v190
mf a[28:31],a[240:243],a[208:211],a[28:31]
ex v191
mf a[32:35],a[240:243],a[212:215],a[32:35]
rq a[236:239],v7,16384
cv v226,v188,v189
mf a[36:39],a[244:247],a[204:207],a[36:39]
ex v192
mf a[40:43],a[244:247],a[208:211],a[40:43]
ex v193
mf a[44:47],a[244:247],a[212:215],a[44:47]
rq a[240:243],v4,17408
cv v227,v190,v191
wl 3
mf v[196:199],a[248:251],v[28:31],v[244:247]
ex v194
mf v[200:203],a[248:251],v[32:35],v[244:247]
ex v195
mf v[204:207],a[248:251],v[36:39],v[244:247]
v_accvgpr_read_b32 v26, a20
v_accvgpr_read_b32 v27, a21
cv v26,v26,v27
v_accvgpr_write_b32 a178, v26
v_accvgpr_read_b32 v1, a22
v_accvgpr_read_b32 v3, a23
cv v1,v1,v3
v_accvgpr_write_b32 a179, v1
mf v[196:199],a[252:255],v[40:43],v[196:199]
rq a[244:247],v5,17408
dl v20,s[20:23],s32,0
mf v[200:203],a[252:255],v[44:47],v[200:203]
dl v21,s[20:23],s32,1024
mf v[204:207],a[252:255],v[48:51],v[204:207]
rq a[248:251],v6,17408
cv v230,v192,v193
wl 3
mf v[196:199],a[232:235],v[52:55],v[196:199]
dl v22,s[20:23],s32,2048
mf v[200:203],a[232:235],v[56:59],v[200:203]
dl v23,s[20:23],s32,3072
mf v[204:207],a[232:235],v[60:63],v[204:207]
rq a[252:255],v7,17408
cv v231,v194,v195
mf v[196:199],a[236:239],v[64:67],v[196:199]
wl 3
mf v[200:203],a[236:239],v[68:71],v[200:203]
mf v[204:207],a[236:239],v[72:75],v[204:207]
wl 2
mf v[208:211],a[240:243],v[28:31],v[244:247]
mf v[212:215],a[240:243],v[32:35],v[244:247]
s_waitcnt vmcnt(20)
s_barrier
mf v[216:219],a[240:243],v[36:39],v[244:247]
tr a[232:233],v8,0
s_add_u32 m0, s4, 0x20000
mf v[208:211],a[244:247],v[40:43],v[208:211]
tr a[234:235],v8,1024
wl 2
mf v[212:215],a[244:247],v[44:47],v[212:215]
ex v196
mf v[216:219],a[244:247],v[48:51],v[216:219]
tr a[236:237],v9,0
mf v[208:211],a[248:251],v[52:55],v[208:211]
tr a[238:239],v9,1024
mf v[212:215],a[248:251],v[56:59],v[212:215]
ex v197
mf v[216:219],a[248:251],v[60:63],v[216:219]
tr a[240:241],v10,0
cv v232,v196,v197
mf v[208:211],a[252:255],v[64:67],v[208:211]
tr a[242:243],v10,1024
mf v[212:215],a[252:255],v[68:71],v[212:215]
ex v198
mf v[216:219],a[252:255],v[72:75],v[216:219]
tr a[244:245],v11,0
wl 5
mf a[216:219],a[228:231],v[220:223],a[216:219]
tr a[246:247],v11,1024
mf a[220:223],a[228:231],v[224:227],a[220:223]
ex v199
mf a[224:227],a[228:231],v[228:231],a[224:227]
tr a[248:249],v12,0
dl v20,s[20:23],s60,0
mf v[76:79],a[232:235],v[220:223],v[76:79]
tr a[250:251],v12,1024
cv v233,v198,v199
mf v[80:83],a[232:235],v[224:227],v[80:83]
ex v200
mf v[84:87],a[232:235],v[228:231],v[84:87]
tr a[252:253],v13,0
dl v21,s[20:23],s60,1024
wl 5
mf v[88:91],a[236:239],v[220:223],v[88:91]
tr a[254:255],v13,1024
mf v[92:95],a[236:239],v[224:227],v[92:95]
ex v201
mf v[96:99],a[236:239],v[228:231],v[96:99]
tr a[232:233],v14,0
dl v22,s[20:23],s60,2048
mf v[100:103],a[240:243],v[220:223],v[100:103]
tr a[234:235],v14,1024
cv v236,v200,v201
mf v[104:107],a[240:243],v[224:227],v[104:107]
ex v202
mf v[108:111],a[240:243],v[228:231],v[108:111]
tr a[236:237],v15,0
wl 5
mf v[112:115],a[244:247],v[220:223],v[112:115]
tr a[238:239],v15,1024
dl v23,s[20:23],s60,3072
mf v[116:119],a[244:247],v[224:227],v[116:119]
s_waitcnt vmcnt(20)
s_barrier
mf v[120:123],a[244:247],v[228:231],v[120:123]
tr a[240:241],v248,0
wl 5
mf v[124:127],a[248:251],v[220:223],v[124:127]
tr a[242:243],v248,2048
mf v[128:131],a[248:251],v[224:227],v[128:131]
ex v203
mf v[132:135],a[248:251],v[228:231],v[132:135]
tr a[244:245],v249,0
cv v237,v202,v203
mf v[136:139],a[252:255],v[220:223],v[136:139]
tr a[246:247],v249,2048
wl 5
mf v[140:143],a[252:255],v[224:227],v[140:143]
ex v204
mf v[144:147],a[252:255],v[228:231],v[144:147]
tr a[248:249],v248,4096
wl 5
mf v[148:151],a[232:235],v[220:223],v[148:151]
tr a[250:251],v248,6144
mf v[152:155],a[232:235],v[224:227],v[152:155]
ex v205
mf v[156:159],a[232:235],v[228:231],v[156:159]
tr a[252:253],v249,4096
cv v240,v204,v205
mf v[160:163],a[236:239],v[220:223],v[160:163]
tr a[254:255],v249,6144
wl 5
mf v[164:167],a[236:239],v[224:227],v[164:167]
ex v206
mf v[168:171],a[236:239],v[228:231],v[168:171]
L_tailcode:
mf a[0:3],a[240:243],a[96:99],0
tr a[232:233],v248,8192
wl 4
mf a[4:7],a[240:243],a[100:103],0
tr a[234:235],v248,10240
mf a[8:11],a[240:243],a[104:107],0
tr a[236:237],v249,8192
wl 5
mf a[12:15],a[244:247],a[96:99],0
tr a[238:239],v249,10240
mf a[16:19],a[244:247],a[100:103],0
ex v207
mf a[20:23],a[244:247],a[104:107],0
tr a[240:241],v248,12288
cv v241,v206,v207
mf a[0:3],a[248:251],a[108:111],a[0:3]
tr a[242:243],v248,14336
wl 6
mf a[4:7],a[248:251],a[112:115],a[4:7]
ex v208
mf a[8:11],a[248:251],a[116:119],a[8:11]
tr a[244:245],v249,12288
wl 5
mf a[12:15],a[252:255],a[108:111],a[12:15]
tr a[246:247],v249,14336
mf a[16:19],a[252:255],a[112:115],a[16:19]
s_waitcnt vmcnt(16)
s_barrier
mf a[20:23],a[252:255],a[116:119],a[20:23]
ex v209
mf a[0:3],a[232:235],a[120:123],a[0:3]
ex v210
mf a[4:7],a[232:235],a[124:127],a[4:7]
ex v211
mf a[8:11],a[232:235],a[128:131],a[8:11]
tr a[248:249],v8,16384
s_add_u32 m0, s4, 0xc000
wl 3
mf a[12:15],a[236:239],a[120:123],a[12:15]
tr a[250:251],v8,17408
s_add_u32 s32, s60, 0x24000
mf a[16:19],a[236:239],a[124:127],a[16:19]
ex v212
mf a[20:23],a[236:239],a[128:131],a[20:23]
tr a[252:253],v9,16384
cv v234,v208,v209
mf a[0:3],a[240:243],a[132:135],a[0:3]
tr a[254:255],v9,17408
cv v235,v210,v211
mf a[4:7],a[240:243],a[136:139],a[4:7]
ex v213
mf a[8:11],a[240:243],a[140:143],a[8:11]
tr a[232:233],v10,16384
cv v238,v212,v213
wl 5
mf a[12:15],a[244:247],a[132:135],a[12:15]
tr a[234:235],v10,17408
mf a[16:19],a[244:247],a[136:139],a[16:19]
ex v214
ex v215
ex v216
ex v217
ex v218
ex v219
mf a[20:23],a[244:247],a[140:143],a[20:23]
cv v239,v214,v215
cv v242,v216,v217
cv v243,v218,v219
mf a[216:219],a[228:231],v[232:235],a[216:219]
tr a[236:237],v11,16384
v_add_u32 v250, 0xc000, v2
mf a[220:223],a[228:231],v[236:239],a[220:223]
tr a[238:239],v11,17408
v_xor_b32 v251, 32, v250
mf a[224:227],a[228:231],v[240:243],a[224:227]
tr a[240:241],v12,16384
v_add_u32 v252, 0x0, v2
wl 5
mf v[76:79],a[248:251],v[232:235],v[76:79]
tr a[242:243],v12,17408
dl v20,s[20:23],s32,0
mf v[80:83],a[248:251],v[236:239],v[80:83]
dl v21,s[20:23],s32,1024
mf v[84:87],a[248:251],v[240:243],v[84:87]
v_accvgpr_read_b32 v244, a216
v_accvgpr_read_b32 v246, a220
v_accvgpr_read_b32 v254, a224
v_add_f32 v245, v244, v246
v_min3_f32 v247, v244, v246, v254
v_add_f32 v245, v245, v254
s_mov_b32 s48, 0x5d800000
s_mov_b32 s49, 0x21800000
v_cmp_nge_f32 vcc, s48, v245
v_cmp_nle_f32 s[50:51], s49, v247
s_nop 1
s_or_b64 vcc, vcc, s[50:51]
s_cbranch_vccz L_ok1
s_mov_b32 s48, 0x40000
s_getpc_b64 s[6:7]
s_add_u32 s6, s6, 12
s_addc_u32 s7, s7, 0
s_branch L_slow
L_ok1:
mf v[88:91],a[252:255],v[232:235],v[88:91]
tr a[244:245],v13,16384
v_xor_b32 v253, 32, v252
mf v[92:95],a[252:255],v[236:239],v[92:95]
tr a[246:247],v13,17408
v_lshlrev_b32 v25, 4, v0
mf v[96:99],a[252:255],v[240:243],v[96:99]
tr a[248:249],v14,16384
s_mul_i32 s37, s3, 12288
wl 5
mf v[100:103],a[232:235],v[232:235],v[100:103]
v_rcp_f32 v244, v244
v_rcp_f32 v246, v246
v_rcp_f32 v254, v254
mf v[104:107],a[232:235],v[236:239],v[104:107]
tr a[250:251],v14,17408
v_add_u32 v26, s37, v25
mf v[108:111],a[232:235],v[240:243],v[108:111]
tr a[252:253],v15,16384
dl v22,s[20:23],s32,2048
mf v[112:115],a[236:239],v[232:235],v[112:115]
tr a[254:255],v15,17408
s_xor_b32 s37, s3, 2
mf v[116:119],a[236:239],v[236:239],v[116:119]
s_waitcnt vmcnt(15)
s_barrier
mf v[120:123],a[236:239],v[240:243],v[120:123]
s_mul_i32 s37, s37, 12288
v_add_u32 v27, s37, v25
wl 4
mf v[124:127],a[240:243],v[232:235],v[124:127]
tr a[232:233],v248,16384
dl v23,s[20:23],s32,3072
mf v[128:131],a[240:243],v[236:239],v[128:131]
tr a[234:235],v248,18432
s_add_u32 m0, s4, 0x18000
mf v[132:135],a[240:243],v[240:243],v[132:135]
tr a[236:237],v249,16384
s_add_u32 s32, s59, 0x48000
mf v[136:139],a[244:247],v[232:235],v[136:139]
tr a[238:239],v249,18432
v_mul_f32 v76, v244, v76
mf v[140:143],a[244:247],v[236:239],v[140:143]
dl v20,s[20:23],s32,0
mf v[144:147],a[244:247],v[240:243],v[144:147]
tr a[240:241],v248,20480
v_mul_f32 v80, v246, v80
wl 5
mf v[148:151],a[248:251],v[232:235],v[148:151]
tr a[242:243],v248,22528
v_mul_f32 v84, v254, v84
mf v[152:155],a[248:251],v[236:239],v[152:155]
dl v21,s[20:23],s32,1024
mf v[156:159],a[248:251],v[240:243],v[156:159]
tr a[244:245],v249,20480
v_mul_f32 v77, v244, v77
mf v[160:163],a[252:255],v[232:235],v[160:163]
tr a[246:247],v249,22528
v_mul_f32 v81, v246, v81
mf v[164:167],a[252:255],v[236:239],v[164:167]
dl v22,s[20:23],s32,2048
mf v[168:171],a[252:255],v[240:243],v[168:171]
tr a[248:249],v248,24576
s_lshl_b32 s36, s38, 14
wl 5
mf a[0:3],a[232:235],a[144:147],a[0:3]
tr a[250:251],v248,26624
v_mul_f32 v85, v254, v85
mf a[4:7],a[232:235],a[148:151],a[4:7]
dl v23,s[20:23],s32,3072
mf a[8:11],a[232:235],a[152:155],a[8:11]
tr a[252:253],v249,24576
v_mul_f32 v78, v244, v78
mf a[12:15],a[236:239],a[144:147],a[12:15]
tr a[254:255],v249,26624
v_mul_f32 v82, v246, v82
mf a[16:19],a[236:239],a[148:151],a[16:19]
tr a[232:233],v248,28672
v_mul_f32 v86, v254, v86
mf a[20:23],a[236:239],a[152:155],a[20:23]
tr a[234:235],v248,30720
v_mul_f32 v79, v244, v79
wl 6
mf a[0:3],a[240:243],a[156:159],a[0:3]
tr a[236:237],v249,28672
v_mul_f32 v83, v246, v83
mf a[4:7],a[240:243],a[160:163],a[4:7]
tr a[238:239],v249,30720
v_mul_f32 v87, v254, v87
mf a[8:11],a[240:243],a[164:167],a[8:11]
v_mul_f32 v88, v244, v88
v_mul_f32 v92, v246, v92
mf a[12:15],a[244:247],a[156:159],a[12:15]
v_mul_f32 v96, v254, v96
v_mul_f32 v89, v244, v89
mf a[16:19],a[244:247],a[160:163],a[16:19]
s_waitcnt vmcnt(16)
s_barrier
mf a[20:23],a[244:247],a[164:167],a[20:23]
tr a[240:241],v248,49152
s_add_u32 m0, s4, 0x10000
wl 4
mf a[0:3],a[248:251],a[192:195],a[0:3]
tr a[242:243],v248,51200
v_mul_f32 v93, v246, v93
mf a[4:7],a[248:251],a[196:199],a[4:7]
tr a[244:245],v249,49152
v_mul_f32 v97, v254, v97
mf a[8:11],a[248:251],a[200:203],a[8:11]
tr a[246:247],v249,51200
s_add_u32 s32, s60, 0x48000
mf a[12:15],a[252:255],a[192:195],a[12:15]
dl v20,s[20:23],s32,0
mf a[16:19],a[252:255],a[196:199],a[16:19]
dl v21,s[20:23],s32,1024
mf a[20:23],a[252:255],a[200:203],a[20:23]
tr a[248:249],v248,53248
v_mul_f32 v90, v244, v90
wl 5
mf a[0:3],a[232:235],a[204:207],a[0:3]
tr a[250:251],v248,55296
v_mul_f32 v94, v246, v94
mf a[4:7],a[232:235],a[208:211],a[4:7]
tr a[252:253],v249,53248
v_mul_f32 v98, v254, v98
mf a[8:11],a[232:235],a[212:215],a[8:11]
dl v22,s[20:23],s32,2048
mf a[12:15],a[236:239],a[204:207],a[12:15]
tr a[254:255],v249,55296
v_mul_f32 v91, v244, v91
mf a[16:19],a[236:239],a[208:211],a[16:19]
tr a[232:233],v248,57344
v_mul_f32 v95, v246, v95
mf a[20:23],a[236:239],a[212:215],a[20:23]
dl v23,s[20:23],s32,3072
wl 5
mf v[172:175],a[240:243],a[96:99],0
tr a[234:235],v248,59392
v_mul_f32 v99, v254, v99
mf v[176:179],a[240:243],a[100:103],0
tr a[236:237],v249,57344
cv v76,v76,v77
mf v[180:183],a[240:243],a[104:107],0
tr a[238:239],v249,59392
cv v80,v80,v81
mf v[184:187],a[244:247],a[96:99],0
tr a[240:241],v248,61440
cv v84,v84,v85
mf v[188:191],a[244:247],a[100:103],0
tr a[242:243],v248,63488
cv v77,v78,v79
mf v[192:195],a[244:247],a[104:107],0
tr a[244:245],v249,61440
cv v81,v82,v83
wl 6
mf v[172:175],a[248:251],a[108:111],v[172:175]
tr a[246:247],v249,63488
cv v85,v86,v87
mf v[176:179],a[248:251],a[112:115],v[176:179]
cv v78,v88,v89
cv v82,v92,v93
mf v[180:183],a[248:251],a[116:119],v[180:183]
cv v86,v96,v97
cv v79,v90,v91
mf v[184:187],a[252:255],a[108:111],v[184:187]
ds_write_b128 v26, v[76:79] offset:0
cv v83,v94,v95
mf v[188:191],a[252:255],a[112:115],v[188:191]
s_waitcnt vmcnt(16)
wl 0
s_barrier
mf v[192:195],a[252:255],a[116:119],v[192:195]
ds_write_b128 v26, v[80:83] offset:1024
s_add_u32 m0, s4, 0x1c000
mf v[172:175],a[232:235],a[120:123],v[172:175]
tr a[248:249],v250,32768
cv v87,v98,v99
mf v[176:179],a[232:235],a[124:127],v[176:179]
ds_write_b128 v26, v[84:87] offset:2048
v_mul_f32 v100, v244, v100
mf v[180:183],a[232:235],a[128:131],v[180:183]
tr a[250:251],v250,34816
s_add_u32 s32, s59, 0x6c000
mf v[184:187],a[236:239],a[120:123],v[184:187]
tr a[252:253],v251,32768
v_mul_f32 v104, v246, v104
mf v[188:191],a[236:239],a[124:127],v[188:191]
tr a[254:255],v251,34816
v_mul_f32 v108, v254, v108
mf v[192:195],a[236:239],a[128:131],v[192:195]
tr a[232:233],v250,36864
v_mul_f32 v101, v244, v101
mf v[172:175],a[240:243],a[132:135],v[172:175]
tr a[234:235],v250,38912
v_mul_f32 v105, v246, v105
mf v[176:179],a[240:243],a[136:139],v[176:179]
dl v20,s[20:23],s32,0
mf v[180:183],a[240:243],a[140:143],v[180:183]
tr a[236:237],v251,36864
v_mul_f32 v109, v254, v109
mf v[184:187],a[244:247],a[132:135],v[184:187]
tr a[238:239],v251,38912
v_mul_f32 v102, v244, v102
mf v[188:191],a[244:247],a[136:139],v[188:191]
dl v21,s[20:23],s32,1024
mf v[192:195],a[244:247],a[140:143],v[192:195]
tr a[240:241],v250,40960
v_mul_f32 v106, v246, v106
wl 5
mf v[172:175],a[248:251],a[144:147],v[172:175]
tr a[242:243],v250,43008
v_mul_f32 v110, v254, v110
mf v[176:179],a[248:251],a[148:151],v[176:179]
dl v22,s[20:23],s32,2048
mf v[180:183],a[248:251],a[152:155],v[180:183]
tr a[244:245],v251,40960
v_mul_f32 v103, v244, v103
mf v[184:187],a[252:255],a[144:147],v[184:187]
tr a[246:247],v251,43008
v_mul_f32 v107, v246, v107
mf v[188:191],a[252:255],a[148:151],v[188:191]
dl v23,s[20:23],s32,3072
mf v[192:195],a[252:255],a[152:155],v[192:195]
tr a[248:249],v250,45056
v_mul_f32 v111, v254, v111
wl 5
mf v[172:175],a[232:235],a[156:159],v[172:175]
tr a[250:251],v250,47104
v_mul_f32 v112, v244, v112
mf v[176:179],a[232:235],a[160:163],v[176:179]
tr a[252:253],v251,45056
v_mul_f32 v116, v246, v116
mf v[180:183],a[232:235],a[164:167],v[180:183]
tr a[254:255],v251,47104
v_mul_f32 v120, v254, v120
mf v[184:187],a[236:239],a[156:159],v[184:187]
v_mul_f32 v113, v244, v113
v_mul_f32 v117, v246, v117
mf v[188:191],a[236:239],a[160:163],v[188:191]
s_waitcnt vmcnt(16)
s_barrier
mf v[192:195],a[236:239],a[164:167],v[192:195]
v_add_u32 v4, s36, v2
v_xor_b32 v5, 32, v4
v_xor_b32 v6, 0x4000, v4
v_xor_b32 v7, 0x4020, v4
v_add_u32 v12, 0x18000, v4
v_add_u32 v13, 0x18000, v5
v_add_u32 v14, 0x18000, v6
v_add_u32 v15, 0x18000, v7
v_add_u32 v8, 0xc000, v4
v_add_u32 v9, 0xc000, v5
v_add_u32 v10, 0xc000, v6
v_add_u32 v11, 0xc000, v7
wl 4
mf v[172:175],a[240:243],a[192:195],v[172:175]
tr a[232:233],v248,32768
s_add_u32 m0, s4, 0x24000
mf v[176:179],a[240:243],a[196:199],v[176:179]
tr a[234:235],v248,34816
v_mul_f32 v121, v254, v121
mf v[180:183],a[240:243],a[200:203],v[180:183]
tr a[236:237],v249,32768
s_add_u32 s32, s57, 0x6c000
mf v[184:187],a[244:247],a[192:195],v[184:187]
tr a[238:239],v249,34816
v_mul_f32 v114, v244, v114
mf v[188:191],a[244:247],a[196:199],v[188:191]
dl v20,s[20:23],s32,0
mf v[192:195],a[244:247],a[200:203],v[192:195]
tr a[240:241],v248,36864
v_mul_f32 v118, v246, v118
wl 5
mf v[172:175],a[248:251],a[204:207],v[172:175]
tr a[242:243],v248,38912
v_mul_f32 v122, v254, v122
mf v[176:179],a[248:251],a[208:211],v[176:179]
dl v21,s[20:23],s32,1024
mf v[180:183],a[248:251],a[212:215],v[180:183]
tr a[244:245],v249,36864
v_mul_f32 v115, v244, v115
mf v[184:187],a[252:255],a[204:207],v[184:187]
tr a[246:247],v249,38912
v_mul_f32 v119, v246, v119
mf v[188:191],a[252:255],a[208:211],v[188:191]
dl v22,s[20:23],s32,2048
mf v[192:195],a[252:255],a[212:215],v[192:195]
tr a[248:249],v248,40960
v_mul_f32 v123, v254, v123
wl 5
mf v[196:199],a[232:235],a[96:99],0
tr a[250:251],v248,43008
cv v100,v100,v101
mf v[200:203],a[232:235],a[100:103],0
dl v23,s[20:23],s32,3072
mf v[204:207],a[232:235],a[104:107],0
tr a[252:253],v249,40960
cv v104,v104,v105
mf v[208:211],a[236:239],a[96:99],0
tr a[254:255],v249,43008
cv v108,v108,v109
mf v[212:215],a[236:239],a[100:103],0
tr a[232:233],v248,45056
cv v101,v102,v103
mf v[216:219],a[236:239],a[104:107],0
tr a[234:235],v248,47104
cv v105,v106,v107
wl 6
mf v[196:199],a[240:243],a[108:111],v[196:199]
tr a[236:237],v249,45056
cv v109,v110,v111
mf v[200:203],a[240:243],a[112:115],v[200:203]
tr a[238:239],v249,47104
cv v102,v112,v113
mf v[204:207],a[240:243],a[116:119],v[204:207]
cv v106,v116,v117
cv v110,v120,v121
mf v[208:211],a[244:247],a[108:111],v[208:211]
cv v103,v114,v115
cv v107,v118,v119
mf v[212:215],a[244:247],a[112:115],v[212:215]
s_waitcnt vmcnt(16)
s_barrier
mf v[216:219],a[244:247],a[116:119],v[216:219]
ds_write_b128 v26, v[100:103] offset:3072
ds_write_b128 v26, v[104:107] offset:4096
wl 5
mf v[196:199],a[248:251],a[120:123],v[196:199]
tr a[240:241],v250,0
s_add_u32 m0, s4, 0x14000
mf v[200:203],a[248:251],a[124:127],v[200:203]
tr a[242:243],v250,2048
cv v111,v122,v123
mf v[204:207],a[248:251],a[128:131],v[204:207]
ds_write_b128 v26, v[108:111] offset:5120
s_add_u32 s32, s60, 0x6c000
mf v[208:211],a[252:255],a[120:123],v[208:211]
tr a[244:245],v251,0
v_mul_f32 v124, v244, v124
mf v[212:215],a[252:255],a[124:127],v[212:215]
tr a[246:247],v251,2048
v_mul_f32 v128, v246, v128
mf v[216:219],a[252:255],a[128:131],v[216:219]
tr a[248:249],v250,4096
v_mul_f32 v132, v254, v132
wl 8
mf v[196:199],a[232:235],a[132:135],v[196:199]
tr a[250:251],v250,6144
v_mul_f32 v125, v244, v125
mf v[200:203],a[232:235],a[136:139],v[200:203]
dl v20,s[20:23],s32,0
mf v[204:207],a[232:235],a[140:143],v[204:207]
tr a[252:253],v251,4096
v_mul_f32 v129, v246, v129
mf v[208:211],a[236:239],a[132:135],v[208:211]
tr a[254:255],v251,6144
v_mul_f32 v133, v254, v133
mf v[212:215],a[236:239],a[136:139],v[212:215]
dl v21,s[20:23],s32,1024
mf v[216:219],a[236:239],a[140:143],v[216:219]
tr a[232:233],v250,8192
v_mul_f32 v126, v244, v126
wl 5
mf v[196:199],a[240:243],a[144:147],v[196:199]
tr a[234:235],v250,10240
v_mul_f32 v130, v246, v130
mf v[200:203],a[240:243],a[148:151],v[200:203]
dl v22,s[20:23],s32,2048
mf v[204:207],a[240:243],a[152:155],v[204:207]
tr a[236:237],v251,8192
v_mul_f32 v134, v254, v134
mf v[208:211],a[244:247],a[144:147],v[208:211]
tr a[238:239],v251,10240
v_mul_f32 v127, v244, v127
mf v[212:215],a[244:247],a[148:151],v[212:215]
dl v23,s[20:23],s32,3072
mf v[216:219],a[244:247],a[152:155],v[216:219]
tr a[240:241],v250,12288
v_mul_f32 v131, v246, v131
wl 5
mf v[196:199],a[248:251],a[156:159],v[196:199]
tr a[242:243],v250,14336
v_mul_f32 v135, v254, v135
mf v[200:203],a[248:251],a[160:163],v[200:203]
tr a[244:245],v251,12288
v_mul_f32 v136, v244, v136
mf v[204:207],a[248:251],a[164:167],v[204:207]
tr a[246:247],v251,14336
v_mul_f32 v140, v246, v140
mf v[208:211],a[252:255],a[156:159],v[208:211]
v_mul_f32 v144, v254, v144
v_mul_f32 v137, v244, v137
mf v[212:215],a[252:255],a[160:163],v[212:215]
s_waitcnt vmcnt(8)
s_barrier
mf v[216:219],a[252:255],a[164:167],v[216:219]
rq v[88:91],v27,0
s_add_u32 m0, s4, 0x20000
wl 5
mf v[196:199],a[232:235],a[192:195],v[196:199]
tr a[248:249],v12,0
v_mul_f32 v141, v246, v141
mf v[200:203],a[232:235],a[196:199],v[200:203]
tr a[250:251],v12,2048
v_mul_f32 v145, v254, v145
mf v[204:207],a[232:235],a[200:203],v[204:207]
rq v[92:95],v27,1024
v_mul_f32 v138, v244, v138
mf v[208:211],a[236:239],a[192:195],v[208:211]
tr a[252:253],v13,0
s_add_u32 s32, s57, 0x48000
mf v[212:215],a[236:239],a[196:199],v[212:215]
rq v[96:99],v27,2048
v_mul_f32 v142, v246, v142
mf v[216:219],a[236:239],a[200:203],v[216:219]
tr a[254:255],v13,2048
v_mul_f32 v146, v254, v146
wl 7
mf v[196:199],a[240:243],a[204:207],v[196:199]
rq v[112:115],v27,3072
v_mul_f32 v139, v244, v139
mf v[200:203],a[240:243],a[208:211],v[200:203]
tr a[232:233],v12,4096
v_mul_f32 v143, v246, v143
mf v[204:207],a[240:243],a[212:215],v[204:207]
tr a[234:235],v12,6144
v_mul_f32 v147, v254, v147
mf v[208:211],a[244:247],a[204:207],v[208:211]
rq v[116:119],v27,4096
cv v124,v124,v125
mf v[212:215],a[244:247],a[208:211],v[212:215]
tr a[236:237],v13,4096
cv v128,v128,v129
mf v[216:219],a[244:247],a[212:215],v[216:219]
rq v[120:123],v27,5120
cv v132,v132,v133
wl 7
mf v[172:175],a[248:251],v[76:79],v[172:175]
tr a[238:239],v13,6144
cv v125,v126,v127
mf v[176:179],a[248:251],v[80:83],v[176:179]
tr a[240:241],v12,8192
cv v129,v130,v131
mf v[180:183],a[248:251],v[84:87],v[180:183]
tr a[242:243],v12,10240
cv v133,v134,v135
wl 7
mf v[184:187],a[252:255],v[76:79],v[184:187]
tr a[244:245],v13,8192
cv v126,v136,v137
mf v[188:191],a[252:255],v[80:83],v[188:191]
tr a[246:247],v13,10240
cv v130,v140,v141
mf v[192:195],a[252:255],v[84:87],v[192:195]
tr a[248:249],v12,12288
dl v20,s[20:23],s32,0
wl 7
mf v[172:175],a[232:235],v[100:103],v[172:175]
tr a[250:251],v12,14336
cv v134,v144,v145
mf v[176:179],a[232:235],v[104:107],v[176:179]
dl v21,s[20:23],s32,1024
mf v[180:183],a[232:235],v[108:111],v[180:183]
tr a[252:253],v13,12288
cv v127,v138,v139
wl 6
mf v[184:187],a[236:239],v[100:103],v[184:187]
cv v131,v142,v143
cv v135,v146,v147
mf v[188:191],a[236:239],v[104:107],v[188:191]
ds_write_b128 v26, v[124:127] offset:6144
ds_write_b128 v26, v[128:131] offset:7168
mf v[192:195],a[236:239],v[108:111],v[192:195]
ds_write_b128 v26, v[132:135] offset:8192
v_mul_f32 v148, v244, v148
wl 6
mf v[172:175],a[240:243],v[124:127],v[172:175]
tr a[254:255],v13,14336
v_mul_f32 v152, v246, v152
mf v[176:179],a[240:243],v[128:131],v[176:179]
tr a[232:233],v14,0
v_mul_f32 v156, v254, v156
mf v[180:183],a[240:243],v[132:135],v[180:183]
tr a[234:235],v14,2048
v_mul_f32 v149, v244, v149
mf v[184:187],a[244:247],v[124:127],v[184:187]
v_mul_f32 v153, v246, v153
v_mul_f32 v157, v254, v157
v_mul_f32 v150, v244, v150
v_mul_f32 v154, v246, v154
v_mul_f32 v158, v254, v158
v_mul_f32 v151, v244, v151
v_mul_f32 v155, v246, v155
v_mul_f32 v159, v254, v159
v_mul_f32 v160, v244, v160
v_mul_f32 v164, v246, v164
v_mul_f32 v168, v254, v168
v_mul_f32 v161, v244, v161
v_mul_f32 v165, v246, v165
v_mul_f32 v169, v254, v169
v_mul_f32 v162, v244, v162
v_mul_f32 v166, v246, v166
v_mul_f32 v170, v254, v170
v_mul_f32 v163, v244, v163
v_mul_f32 v167, v246, v167
v_mul_f32 v171, v254, v171
cv v148,v148,v149
cv v152,v152,v153
cv v156,v156,v157
cv v149,v150,v151
cv v153,v154,v155
cv v157,v158,v159
cv v150,v160,v161
cv v154,v164,v165
cv v158,v168,v169
cv v151,v162,v163
cv v155,v166,v167
cv v159,v170,v171
mf v[188:191],a[244:247],v[128:131],v[188:191]
ds_write_b128 v26, v[148:151] offset:9216
dl v22,s[20:23],s32,2048
mf v[192:195],a[244:247],v[132:135],v[192:195]
ds_write_b128 v26, v[152:155] offset:10240
ds_write_b128 v26, v[156:159] offset:11264
wl 7
mf v[172:175],a[248:251],v[148:151],v[172:175]
tr a[236:237],v15,0
tr a[238:239],v15,2048
mf v[176:179],a[248:251],v[152:155],v[176:179]
wl 2
s_barrier
mf v[180:183],a[248:251],v[156:159],v[180:183]
tr a[240:241],v14,4096
dl v23,s[20:23],s32,3072
mf v[184:187],a[252:255],v[148:151],v[184:187]
tr a[242:243],v14,6144
s_add_u32 m0, s4, 0xc000
mf v[188:191],a[252:255],v[152:155],v[188:191]
tr a[244:245],v15,4096
s_add_u32 s32, s58, 0x6c000
mf v[192:195],a[252:255],v[156:159],v[192:195]
rq v[136:139],v27,6144
mf v[172:175],a[232:235],v[88:91],v[172:175]
tr a[246:247],v15,6144
mf v[176:179],a[232:235],v[92:95],v[176:179]
rq v[140:143],v27,7168
wl 6
mf v[180:183],a[232:235],v[96:99],v[180:183]
rq v[144:147],v27,8192
tr a[248:249],v14,8192
mf v[184:187],a[236:239],v[88:91],v[184:187]
rq v[160:163],v27,9216
tr a[250:251],v14,10240
mf v[188:191],a[236:239],v[92:95],v[188:191]
rq v[164:167],v27,10240
wl 9
mf v[192:195],a[236:239],v[96:99],v[192:195]
rq v[168:171],v27,11264
tr a[252:253],v15,8192
mf v[172:175],a[240:243],v[112:115],v[172:175]
tr a[254:255],v15,10240
mf v[176:179],a[240:243],v[116:119],v[176:179]
tr a[232:233],v14,12288
wl 10
mf v[180:183],a[240:243],v[120:123],v[180:183]
tr a[234:235],v14,14336
dl v20,s[20:23],s32,0
mf v[184:187],a[244:247],v[112:115],v[184:187]
tr a[236:237],v15,12288
mf v[188:191],a[244:247],v[116:119],v[188:191]
s_waitcnt vmcnt(5)
wl 5
s_barrier
mf v[192:195],a[244:247],v[120:123],v[192:195]
tr a[238:239],v15,14336
dl v21,s[20:23],s32,1024
mf v[172:175],a[248:251],v[136:139],v[172:175]
tr a[240:241],v8,16384
dl v22,s[20:23],s32,2048
mf v[176:179],a[248:251],v[140:143],v[176:179]
tr a[242:243],v8,18432
wl 6
mf v[180:183],a[248:251],v[144:147],v[180:183]
tr a[244:245],v9,16384
dl v23,s[20:23],s32,3072
mf v[184:187],a[252:255],v[136:139],v[184:187]
tr a[246:247],v9,18432
s_add_u32 m0, s4, 0x8000
mf v[188:191],a[252:255],v[140:143],v[188:191]
tr a[248:249],v8,20480
s_add_u32 s32, s58, 0x48000
mf v[192:195],a[252:255],v[144:147],v[192:195]
dl v20,s[20:23],s32,0
wl 6
mf v[172:175],a[232:235],v[160:163],v[172:175]
tr a[250:251],v8,22528
wl 6
mf v[176:179],a[232:235],v[164:167],v[176:179]
dl v21,s[20:23],s32,1024
mf v[180:183],a[232:235],v[168:171],v[180:183]
tr a[252:253],v9,20480
wl 5
mf v[184:187],a[236:239],v[160:163],v[184:187]
tr a[254:255],v9,22528
mf v[188:191],a[236:239],v[164:167],v[188:191]
dl v22,s[20:23],s32,2048
mf v[192:195],a[236:239],v[168:171],v[192:195]
tr a[232:233],v8,24576
wl 4
mf v[196:199],a[240:243],v[76:79],v[196:199]
tr a[234:235],v8,26624
mf v[200:203],a[240:243],v[80:83],v[200:203]
dl v23,s[20:23],s32,3072
mf v[204:207],a[240:243],v[84:87],v[204:207]
tr a[236:237],v9,24576
s_add_u32 m0, s4, 0x0
mf v[208:211],a[244:247],v[76:79],v[208:211]
tr a[238:239],v9,26624
cv v172,v172,v173
mf v[212:215],a[244:247],v[80:83],v[212:215]
tr a[240:241],v8,28672
s_add_u32 s32, s52, 0x48000
mf v[216:219],a[244:247],v[84:87],v[216:219]
dl v20,s[20:23],s32,0
wl 5
mf v[196:199],a[248:251],v[100:103],v[196:199]
tr a[242:243],v8,30720
cv v173,v174,v175
mf v[200:203],a[248:251],v[104:107],v[200:203]
dl v21,s[20:23],s32,1024
mf v[204:207],a[248:251],v[108:111],v[204:207]
tr a[244:245],v9,28672
cv v174,v184,v185
mf v[208:211],a[252:255],v[100:103],v[208:211]
tr a[246:247],v9,30720
cv v175,v186,v187
mf v[212:215],a[252:255],v[104:107],v[212:215]
dl v22,s[20:23],s32,2048
mf v[216:219],a[252:255],v[108:111],v[216:219]
tr a[248:249],v10,16384
s_add_u32 s33, s47, 0x0
wl 4
mf v[196:199],a[232:235],v[124:127],v[196:199]
tr a[250:251],v10,18432
mf v[200:203],a[232:235],v[128:131],v[200:203]
buffer_store_dwordx4 v[172:175], v25, s[28:31], s33 offen offset:0 sc1
mf v[204:207],a[232:235],v[132:135],v[204:207]
tr a[252:253],v11,16384
cv v176,v176,v177
mf v[208:211],a[236:239],v[124:127],v[208:211]
tr a[254:255],v11,18432
cv v177,v178,v179
mf v[212:215],a[236:239],v[128:131],v[212:215]
dl v23,s[20:23],s32,3072
mf v[216:219],a[236:239],v[132:135],v[216:219]
tr a[232:233],v10,20480
s_add_u32 m0, s4, 0x4000
wl 5
mf v[196:199],a[240:243],v[148:151],v[196:199]
tr a[234:235],v10,22528
s_add_u32 s32, s52, 0x6c000
mf v[200:203],a[240:243],v[152:155],v[200:203]
dl v20,s[20:23],s32,0
mf v[204:207],a[240:243],v[156:159],v[204:207]
tr a[236:237],v11,20480
cv v178,v188,v189
mf v[208:211],a[244:247],v[148:151],v[208:211]
tr a[238:239],v11,22528
cv v179,v190,v191
mf v[212:215],a[244:247],v[152:155],v[212:215]
buffer_store_dwordx4 v[176:179], v25, s[28:31], s33 offen offset:1024 sc1
mf v[216:219],a[244:247],v[156:159],v[216:219]
tr a[240:241],v10,24576
cv v180,v180,v181
wl 5
mf v[196:199],a[248:251],v[88:91],v[196:199]
tr a[242:243],v10,26624
cv v181,v182,v183
mf v[200:203],a[248:251],v[92:95],v[200:203]
dl v21,s[20:23],s32,1024
mf v[204:207],a[248:251],v[96:99],v[204:207]
tr a[244:245],v11,24576
cv v182,v192,v193
mf v[208:211],a[252:255],v[88:91],v[208:211]
tr a[246:247],v11,26624
cv v183,v194,v195
mf v[212:215],a[252:255],v[92:95],v[212:215]
buffer_store_dwordx4 v[180:183], v25, s[28:31], s33 offen offset:2048 sc1
mf v[216:219],a[252:255],v[96:99],v[216:219]
tr a[248:249],v10,28672
wl 5
mf v[196:199],a[232:235],v[112:115],v[196:199]
tr a[250:251],v10,30720
mf v[200:203],a[232:235],v[116:119],v[200:203]
dl v22,s[20:23],s32,2048
mf v[204:207],a[232:235],v[120:123],v[204:207]
tr a[252:253],v11,28672
wl 5
mf v[208:211],a[236:239],v[112:115],v[208:211]
tr a[254:255],v11,30720
mf v[212:215],a[236:239],v[116:119],v[212:215]
s_waitcnt vmcnt(18)
s_barrier
mf v[216:219],a[236:239],v[120:123],v[216:219]
tr a[232:233],v12,32768
wl 5
mf v[196:199],a[240:243],v[136:139],v[196:199]
tr a[234:235],v12,34816
mf v[200:203],a[240:243],v[140:143],v[200:203]
dl v23,s[20:23],s32,3072
mf v[204:207],a[240:243],v[144:147],v[204:207]
tr a[236:237],v13,32768
s_add_u32 m0, s4, 0x18000
mf v[208:211],a[244:247],v[136:139],v[208:211]
tr a[238:239],v13,34816
s_add_u32 s32, s53, 0x48000
mf v[212:215],a[244:247],v[140:143],v[212:215]
dl v20,s[20:23],s32,0
mf v[216:219],a[244:247],v[144:147],v[216:219]
tr a[240:241],v12,36864
wl 5
mf v[196:199],a[248:251],v[160:163],v[196:199]
tr a[242:243],v12,38912
mf v[200:203],a[248:251],v[164:167],v[200:203]
dl v21,s[20:23],s32,1024
mf v[204:207],a[248:251],v[168:171],v[204:207]
tr a[244:245],v13,36864
wl 5
mf v[208:211],a[252:255],v[160:163],v[208:211]
tr a[246:247],v13,38912
mf v[212:215],a[252:255],v[164:167],v[212:215]
dl v22,s[20:23],s32,2048
mf v[216:219],a[252:255],v[168:171],v[216:219]
tr a[248:249],v12,40960
wl 5
mf a[24:27],a[232:235],v[76:79],a[24:27]
tr a[250:251],v12,43008
mf a[28:31],a[232:235],v[80:83],a[28:31]
dl v23,s[20:23],s32,3072
mf a[32:35],a[232:235],v[84:87],a[32:35]
tr a[252:253],v13,40960
wl 5
mf a[36:39],a[236:239],v[76:79],a[36:39]
tr a[254:255],v13,43008
cv v196,v196,v197
mf a[40:43],a[236:239],v[80:83],a[40:43]
tr a[232:233],v12,45056
cv v197,v198,v199
mf a[44:47],a[236:239],v[84:87],a[44:47]
tr a[234:235],v12,47104
cv v198,v208,v209
mf a[24:27],a[240:243],v[100:103],a[24:27]
tr a[236:237],v13,45056
cv v199,v210,v211
mf a[28:31],a[240:243],v[104:107],a[28:31]
tr a[238:239],v13,47104
s_add_u32 s33, s47, 0x3000
mf a[32:35],a[240:243],v[108:111],a[32:35]
buffer_store_dwordx4 v[196:199], v25, s[28:31], s33 offen offset:0 sc1
wl 6
mf a[36:39],a[244:247],v[100:103],a[36:39]
tr a[240:241],v14,32768
s_add_u32 m0, s4, 0x1c000
mf a[40:43],a[244:247],v[104:107],a[40:43]
tr a[242:243],v14,34816
cv v200,v200,v201
mf a[44:47],a[244:247],v[108:111],a[44:47]
tr a[244:245],v15,32768
cv v201,v202,v203
mf a[24:27],a[248:251],v[124:127],a[24:27]
tr a[246:247],v15,34816
s_add_u32 s32, s53, 0x6c000
mf a[28:31],a[248:251],v[128:131],a[28:31]
dl v20,s[20:23],s32,0
mf a[32:35],a[248:251],v[132:135],a[32:35]
tr a[248:249],v14,36864
cv v202,v212,v213
wl 5
mf a[36:39],a[252:255],v[124:127],a[36:39]
dl v21,s[20:23],s32,1024
mf a[40:43],a[252:255],v[128:131],a[40:43]
tr a[250:251],v14,38912
cv v203,v214,v215
mf a[44:47],a[252:255],v[132:135],a[44:47]
buffer_store_dwordx4 v[200:203], v25, s[28:31], s33 offen offset:1024 sc1
mf a[24:27],a[232:235],v[148:151],a[24:27]
tr a[252:253],v15,36864
cv v204,v204,v205
mf a[28:31],a[232:235],v[152:155],a[28:31]
dl v22,s[20:23],s32,2048
mf a[32:35],a[232:235],v[156:159],a[32:35]
tr a[254:255],v15,38912
cv v205,v206,v207
mf a[36:39],a[236:239],v[148:151],a[36:39]
tr a[232:233],v14,40960
cv v206,v216,v217
mf a[40:43],a[236:239],v[152:155],a[40:43]
tr a[234:235],v14,43008
cv v207,v218,v219
mf a[44:47],a[236:239],v[156:159],a[44:47]
buffer_store_dwordx4 v[204:207], v25, s[28:31], s33 offen offset:2048 sc1
wl 4
mf a[24:27],a[240:243],v[88:91],a[24:27]
dl v23,s[20:23],s32,3072
mf a[28:31],a[240:243],v[92:95],a[28:31]
tr a[236:237],v15,40960
mf a[32:35],a[240:243],v[96:99],a[32:35]
tr a[238:239],v15,43008
mf a[36:39],a[244:247],v[88:91],a[36:39]
tr a[240:241],v14,45056
mf a[40:43],a[244:247],v[92:95],a[40:43]
tr a[242:243],v14,47104
mf a[44:47],a[244:247],v[96:99],a[44:47]
tr a[244:245],v15,45056
wl 5
mf a[24:27],a[248:251],v[112:115],a[24:27]
tr a[246:247],v15,47104
mf a[28:31],a[248:251],v[116:119],a[28:31]
mf a[32:35],a[248:251],v[120:123],a[32:35]
mf a[36:39],a[252:255],v[112:115],a[36:39]
mf a[40:43],a[252:255],v[116:119],a[40:43]
s_waitcnt vmcnt(22)
s_barrier
mf a[44:47],a[252:255],v[120:123],a[44:47]
tr a[248:249],v4,32768
s_add_u32 m0, s4, 0x10000
mf a[24:27],a[232:235],v[136:139],a[24:27]
tr a[250:251],v4,34816
v_accvgpr_read_b32 v29, a48
mf a[28:31],a[232:235],v[140:143],a[28:31]
tr a[252:253],v5,32768
v_lshlrev_b32 v28, 16, v29
mf a[32:35],a[232:235],v[144:147],a[32:35]
tr a[254:255],v5,34816
s_add_u32 s32, s54, 0x48000
wl 4
mf a[36:39],a[236:239],v[136:139],a[36:39]
dl v20,s[20:23],s32,0
mf a[40:43],a[236:239],v[140:143],a[40:43]
tr a[232:233],v4,36864
v_and_b32 v29, 0xffff0000, v29
mf a[44:47],a[236:239],v[144:147],a[44:47]
dl v21,s[20:23],s32,1024
mf a[24:27],a[240:243],v[160:163],a[24:27]
tr a[234:235],v4,38912
v_accvgpr_read_b32 v31, a49
mf a[28:31],a[240:243],v[164:167],a[28:31]
tr a[236:237],v5,36864
v_lshlrev_b32 v30, 16, v31
mf a[32:35],a[240:243],v[168:171],a[32:35]
tr a[238:239],v5,38912
v_and_b32 v31, 0xffff0000, v31
mf a[36:39],a[244:247],v[160:163],a[36:39]
dl v22,s[20:23],s32,2048
mf a[40:43],a[244:247],v[164:167],a[40:43]
tr a[240:241],v4,40960
v_accvgpr_read_b32 v33, a50
mf a[44:47],a[244:247],v[168:171],a[44:47]
tr a[242:243],v4,43008
v_lshlrev_b32 v32, 16, v33
wl 5
mf a[0:3],a[248:251],v[76:79],a[0:3]
tr a[244:245],v5,40960
v_and_b32 v33, 0xffff0000, v33
mf a[4:7],a[248:251],v[80:83],a[4:7]
dl v23,s[20:23],s32,3072
mf a[8:11],a[248:251],v[84:87],a[8:11]
tr a[246:247],v5,43008
v_accvgpr_read_b32 v35, a51
mf a[12:15],a[252:255],v[76:79],a[12:15]
tr a[248:249],v4,45056
v_lshlrev_b32 v34, 16, v35
mf a[16:19],a[252:255],v[80:83],a[16:19]
tr a[250:251],v4,47104
v_and_b32 v35, 0xffff0000, v35
mf a[20:23],a[252:255],v[84:87],a[20:23]
tr a[252:253],v5,45056
v_accvgpr_read_b32 v37, a52
wl 6
mf a[0:3],a[232:235],v[100:103],a[0:3]
tr a[254:255],v5,47104
v_lshlrev_b32 v36, 16, v37
mf a[4:7],a[232:235],v[104:107],a[4:7]
v_and_b32 v37, 0xffff0000, v37
v_accvgpr_read_b32 v39, a53
mf a[8:11],a[232:235],v[108:111],a[8:11]
tr a[232:233],v6,32768
s_add_u32 m0, s4, 0x14000
mf a[12:15],a[236:239],v[100:103],a[12:15]
tr a[234:235],v6,34816
v_accvgpr_read_b32 v220, a24
mf a[16:19],a[236:239],v[104:107],a[16:19]
v_lshlrev_b32 v38, 16, v39
v_accvgpr_read_b32 v221, a25
mf a[20:23],a[236:239],v[108:111],a[20:23]
tr a[236:237],v7,32768
v_and_b32 v39, 0xffff0000, v39
wl 5
mf a[0:3],a[240:243],v[124:127],a[0:3]
tr a[238:239],v7,34816
s_add_u32 s32, s54, 0x6c000
mf a[4:7],a[240:243],v[128:131],a[4:7]
dl v20,s[20:23],s32,0
mf a[8:11],a[240:243],v[132:135],a[8:11]
tr a[240:241],v6,36864
v_accvgpr_read_b32 v222, a26
mf a[12:15],a[244:247],v[124:127],a[12:15]
dl v21,s[20:23],s32,1024
mf a[16:19],a[244:247],v[128:131],a[16:19]
tr a[242:243],v6,38912
v_accvgpr_read_b32 v41, a54
mf a[20:23],a[244:247],v[132:135],a[20:23]
tr a[244:245],v7,36864
v_accvgpr_read_b32 v223, a27
mf a[0:3],a[248:251],v[148:151],a[0:3]
tr a[246:247],v7,38912
v_lshlrev_b32 v40, 16, v41
mf a[4:7],a[248:251],v[152:155],a[4:7]
dl v22,s[20:23],s32,2048
mf a[8:11],a[248:251],v[156:159],a[8:11]
tr a[248:249],v6,40960
v_accvgpr_read_b32 v224, a36
wl 5
mf a[12:15],a[252:255],v[148:151],a[12:15]
tr a[250:251],v6,43008
v_and_b32 v41, 0xffff0000, v41
mf a[16:19],a[252:255],v[152:155],a[16:19]
v_accvgpr_read_b32 v225, a37
v_accvgpr_read_b32 v43, a55
mf a[20:23],a[252:255],v[156:159],a[20:23]
dl v23,s[20:23],s32,3072
mf a[0:3],a[232:235],v[88:91],a[0:3]
tr a[252:253],v7,40960
v_accvgpr_read_b32 v226, a38
mf a[4:7],a[232:235],v[92:95],a[4:7]
tr a[254:255],v7,43008
v_lshlrev_b32 v42, 16, v43
mf a[8:11],a[232:235],v[96:99],a[8:11]
tr a[232:233],v6,45056
v_accvgpr_read_b32 v227, a39
mf a[12:15],a[236:239],v[88:91],a[12:15]
tr a[234:235],v6,47104
v_and_b32 v43, 0xffff0000, v43
mf a[16:19],a[236:239],v[92:95],a[16:19]
cv v220,v220,v221
v_accvgpr_read_b32 v45, a56
mf a[20:23],a[236:239],v[96:99],a[20:23]
tr a[236:237],v7,45056
cv v221,v222,v223
wl 5
mf a[0:3],a[240:243],v[112:115],a[0:3]
tr a[238:239],v7,47104
v_lshlrev_b32 v44, 16, v45
mf a[4:7],a[240:243],v[116:119],a[4:7]
cv v222,v224,v225
v_and_b32 v45, 0xffff0000, v45
mf a[8:11],a[240:243],v[120:123],a[8:11]
cv v223,v226,v227
s_add_u32 s33, s47, 0x6000
mf a[12:15],a[244:247],v[112:115],a[12:15]
buffer_store_dwordx4 v[220:223], v25, s[28:31], s33 offen offset:0 sc1
mf a[16:19],a[244:247],v[116:119],a[16:19]
s_waitcnt vmcnt(20)
s_barrier
mf a[20:23],a[244:247],v[120:123],a[20:23]
tr a[240:241],v4,0
s_add_u32 m0, s4, 0x20000
mf a[0:3],a[248:251],v[136:139],a[0:3]
tr a[242:243],v4,2048
v_accvgpr_read_b32 v228, a28
mf a[4:7],a[248:251],v[140:143],a[4:7]
tr a[244:245],v5,0
v_accvgpr_read_b32 v229, a29
mf a[8:11],a[248:251],v[144:147],a[8:11]
tr a[246:247],v5,2048
s_add_u32 s32, s55, 0x48000
wl 4
mf a[12:15],a[252:255],v[136:139],a[12:15]
dl v20,s[20:23],s32,0
mf a[16:19],a[252:255],v[140:143],a[16:19]
tr a[248:249],v4,4096
v_accvgpr_read_b32 v230, a30
mf a[20:23],a[252:255],v[144:147],a[20:23]
dl v21,s[20:23],s32,1024
mf a[0:3],a[232:235],v[160:163],a[0:3]
tr a[250:251],v4,6144
v_accvgpr_read_b32 v231, a31
mf a[4:7],a[232:235],v[164:167],a[4:7]
tr a[252:253],v5,4096
v_accvgpr_read_b32 v232, a40
mf a[8:11],a[232:235],v[168:171],a[8:11]
tr a[254:255],v5,6144
v_accvgpr_read_b32 v233, a41
mf a[12:15],a[236:239],v[160:163],a[12:15]
v_accvgpr_read_b32 v234, a42
v_accvgpr_read_b32 v235, a43
cv v228,v228,v229
cv v229,v230,v231
cv v230,v232,v233
cv v231,v234,v235
buffer_store_dwordx4 v[228:231], v25, s[28:31], s33 offen offset:1024 sc1
v_accvgpr_read_b32 v236, a32
v_accvgpr_read_b32 v237, a33
v_accvgpr_read_b32 v238, a34
v_accvgpr_read_b32 v239, a35
v_accvgpr_read_b32 v240, a44
v_accvgpr_read_b32 v241, a45
v_accvgpr_read_b32 v242, a46
v_accvgpr_read_b32 v243, a47
cv v236,v236,v237
cv v237,v238,v239
cv v238,v240,v241
cv v239,v242,v243
buffer_store_dwordx4 v[236:239], v25, s[28:31], s33 offen offset:2048 sc1
mf a[16:19],a[236:239],v[164:167],a[16:19]
v_accvgpr_read_b32 v47, a57
v_lshlrev_b32 v46, 16, v47
v_and_b32 v47, 0xffff0000, v47
v_accvgpr_read_b32 v49, a58
v_lshlrev_b32 v48, 16, v49
v_and_b32 v49, 0xffff0000, v49
v_accvgpr_read_b32 v51, a59
v_lshlrev_b32 v50, 16, v51
v_and_b32 v51, 0xffff0000, v51
mf a[20:23],a[236:239],v[168:171],a[20:23]
tr a[232:233],v4,8192
v_accvgpr_read_b32 v53, a60
wl 4
mf v[28:31],a[240:243],v[76:79],v[28:31]
tr a[234:235],v4,10240
v_lshlrev_b32 v52, 16, v53
mf v[32:35],a[240:243],v[80:83],v[32:35]
dl v22,s[20:23],s32,2048
mf v[36:39],a[240:243],v[84:87],v[36:39]
tr a[236:237],v5,8192
v_and_b32 v53, 0xffff0000, v53
mf v[40:43],a[244:247],v[76:79],v[40:43]
tr a[238:239],v5,10240
v_accvgpr_read_b32 v55, a61
mf v[44:47],a[244:247],v[80:83],v[44:47]
dl v23,s[20:23],s32,3072
mf v[48:51],a[244:247],v[84:87],v[48:51]
tr a[240:241],v4,12288
v_lshlrev_b32 v54, 16, v55
wl 5
mf v[28:31],a[248:251],v[100:103],v[28:31]
tr a[242:243],v4,14336
v_and_b32 v55, 0xffff0000, v55
mf v[32:35],a[248:251],v[104:107],v[32:35]
tr a[244:245],v5,12288
v_accvgpr_read_b32 v57, a62
mf v[36:39],a[248:251],v[108:111],v[36:39]
tr a[246:247],v5,14336
s_add_u32 m0, s4, 0x24000
mf v[40:43],a[252:255],v[100:103],v[40:43]
tr a[248:249],v6,0
v_lshlrev_b32 v56, 16, v57
mf v[44:47],a[252:255],v[104:107],v[44:47]
tr a[250:251],v6,2048
v_and_b32 v57, 0xffff0000, v57
mf v[48:51],a[252:255],v[108:111],v[48:51]
tr a[252:253],v7,0
v_accvgpr_read_b32 v59, a63
wl 7
mf v[28:31],a[232:235],v[124:127],v[28:31]
tr a[254:255],v7,2048
s_add_u32 s32, s55, 0x6c000
mf v[32:35],a[232:235],v[128:131],v[32:35]
dl v20,s[20:23],s32,0
mf v[36:39],a[232:235],v[132:135],v[36:39]
tr a[232:233],v6,4096
v_lshlrev_b32 v58, 16, v59
mf v[40:43],a[236:239],v[124:127],v[40:43]
dl v21,s[20:23],s32,1024
mf v[44:47],a[236:239],v[128:131],v[44:47]
tr a[234:235],v6,6144
v_and_b32 v59, 0xffff0000, v59
mf v[48:51],a[236:239],v[132:135],v[48:51]
tr a[236:237],v7,4096
v_accvgpr_read_b32 v61, a64
wl 5
mf v[28:31],a[240:243],v[148:151],v[28:31]
tr a[238:239],v7,6144
v_lshlrev_b32 v60, 16, v61
mf v[32:35],a[240:243],v[152:155],v[32:35]
dl v22,s[20:23],s32,2048
mf v[36:39],a[240:243],v[156:159],v[36:39]
tr a[240:241],v6,8192
v_and_b32 v61, 0xffff0000, v61
mf v[40:43],a[244:247],v[148:151],v[40:43]
tr a[242:243],v6,10240
v_accvgpr_read_b32 v63, a65
mf v[44:47],a[244:247],v[152:155],v[44:47]
v_accvgpr_read_b32 v220, a0
v_lshlrev_b32 v62, 16, v63
mf v[48:51],a[244:247],v[156:159],v[48:51]
dl v23,s[20:23],s32,3072
mf v[28:31],a[248:251],v[88:91],v[28:31]
tr a[244:245],v7,8192
v_accvgpr_read_b32 v221, a1
mf v[32:35],a[248:251],v[92:95],v[32:35]
tr a[246:247],v7,10240
v_and_b32 v63, 0xffff0000, v63
mf v[36:39],a[248:251],v[96:99],v[36:39]
tr a[248:249],v6,12288
v_accvgpr_read_b32 v222, a2
wl 5
mf v[40:43],a[252:255],v[88:91],v[40:43]
tr a[250:251],v6,14336
v_accvgpr_read_b32 v65, a66
mf v[44:47],a[252:255],v[92:95],v[44:47]
v_accvgpr_read_b32 v223, a3
v_lshlrev_b32 v64, 16, v65
mf v[48:51],a[252:255],v[96:99],v[48:51]
tr a[252:253],v7,12288
v_accvgpr_read_b32 v224, a12
mf v[28:31],a[232:235],v[112:115],v[28:31]
tr a[254:255],v7,14336
v_and_b32 v65, 0xffff0000, v65
mf v[32:35],a[232:235],v[116:119],v[32:35]
v_accvgpr_read_b32 v225, a13
v_accvgpr_read_b32 v67, a67
mf v[36:39],a[232:235],v[120:123],v[36:39]
v_accvgpr_read_b32 v226, a14
v_lshlrev_b32 v66, 16, v67
mf v[40:43],a[236:239],v[112:115],v[40:43]
v_accvgpr_read_b32 v227, a15
v_and_b32 v67, 0xffff0000, v67
mf v[44:47],a[236:239],v[116:119],v[44:47]
s_waitcnt vmcnt(19)
s_barrier
mf v[48:51],a[236:239],v[120:123],v[48:51]
tr a[232:233],v12,0
s_add_u32 m0, s4, 0x8000
wl 3
mf v[28:31],a[240:243],v[136:139],v[28:31]
tr a[234:235],v12,2048
cv v220,v220,v221
mf v[32:35],a[240:243],v[140:143],v[32:35]
tr a[236:237],v13,0
v_accvgpr_read_b32 v69, a68
mf v[36:39],a[240:243],v[144:147],v[36:39]
tr a[238:239],v13,2048
s_add_u32 s32, s56, 0x48000
mf v[40:43],a[244:247],v[136:139],v[40:43]
dl v20,s[20:23],s32,0
mf v[44:47],a[244:247],v[140:143],v[44:47]
tr a[240:241],v12,4096
cv v221,v222,v223
mf v[48:51],a[244:247],v[144:147],v[48:51]
dl v21,s[20:23],s32,1024
mf v[28:31],a[248:251],v[160:163],v[28:31]
tr a[242:243],v12,6144
v_lshlrev_b32 v68, 16, v69
mf v[32:35],a[248:251],v[164:167],v[32:35]
tr a[244:245],v13,4096
cv v222,v224,v225
mf v[36:39],a[248:251],v[168:171],v[36:39]
tr a[246:247],v13,6144
v_and_b32 v69, 0xffff0000, v69
wl 5
mf v[40:43],a[252:255],v[160:163],v[40:43]
cv v223,v226,v227
s_add_u32 s33, s47, 0x9000
buffer_store_dwordx4 v[220:223], v25, s[28:31], s33 offen offset:0 sc1
v_accvgpr_read_b32 v228, a4
v_accvgpr_read_b32 v229, a5
v_accvgpr_read_b32 v230, a6
v_accvgpr_read_b32 v231, a7
v_accvgpr_read_b32 v232, a16
v_accvgpr_read_b32 v233, a17
v_accvgpr_read_b32 v234, a18
v_accvgpr_read_b32 v235, a19
cv v228,v228,v229
cv v229,v230,v231
cv v230,v232,v233
cv v231,v234,v235
buffer_store_dwordx4 v[228:231], v25, s[28:31], s33 offen offset:1024 sc1
v_accvgpr_read_b32 v236, a8
v_accvgpr_read_b32 v237, a9
v_accvgpr_read_b32 v238, a10
v_accvgpr_read_b32 v239, a11
v_accvgpr_read_b32 v240, a20
v_accvgpr_read_b32 v241, a21
v_accvgpr_read_b32 v242, a22
v_accvgpr_read_b32 v243, a23
cv v236,v236,v237
cv v237,v238,v239
cv v238,v240,v241
cv v239,v242,v243
buffer_store_dwordx4 v[236:239], v25, s[28:31], s33 offen offset:2048 sc1
mf v[44:47],a[252:255],v[164:167],v[44:47]
v_accvgpr_read_b32 v71, a69
v_lshlrev_b32 v70, 16, v71
v_and_b32 v71, 0xffff0000, v71
v_accvgpr_read_b32 v73, a70
v_lshlrev_b32 v72, 16, v73
v_and_b32 v73, 0xffff0000, v73
v_accvgpr_read_b32 v75, a71
v_lshlrev_b32 v74, 16, v75
v_and_b32 v75, 0xffff0000, v75
mf v[48:51],a[252:255],v[168:171],v[48:51]
tr a[248:249],v12,8192
v_accvgpr_read_b32 v173, a72
mf v[52:55],a[232:235],v[76:79],v[52:55]
tr a[250:251],v12,10240
v_lshlrev_b32 v172, 16, v173
mf v[56:59],a[232:235],v[80:83],v[56:59]
dl v22,s[20:23],s32,2048
mf v[60:63],a[232:235],v[84:87],v[60:63]
tr a[252:253],v13,8192
v_and_b32 v173, 0xffff0000, v173
wl 4
mf v[64:67],a[236:239],v[76:79],v[64:67]
tr a[254:255],v13,10240
v_accvgpr_read_b32 v175, a73
mf v[68:71],a[236:239],v[80:83],v[68:71]
dl v23,s[20:23],s32,3072
mf v[72:75],a[236:239],v[84:87],v[72:75]
tr a[232:233],v12,12288
v_lshlrev_b32 v174, 16, v175
mf v[52:55],a[240:243],v[100:103],v[52:55]
tr a[234:235],v12,14336
v_and_b32 v175, 0xffff0000, v175
mf v[56:59],a[240:243],v[104:107],v[56:59]
tr a[236:237],v13,12288
v_accvgpr_read_b32 v177, a74
mf v[60:63],a[240:243],v[108:111],v[60:63]
tr a[238:239],v13,14336
s_add_u32 m0, s4, 0xc000
wl 6
mf v[64:67],a[244:247],v[100:103],v[64:67]
tr a[240:241],v14,0
v_lshlrev_b32 v176, 16, v177
mf v[68:71],a[244:247],v[104:107],v[68:71]
tr a[242:243],v14,2048
v_and_b32 v177, 0xffff0000, v177
mf v[72:75],a[244:247],v[108:111],v[72:75]
tr a[244:245],v15,0
v_accvgpr_read_b32 v179, a75
mf v[52:55],a[248:251],v[124:127],v[52:55]
tr a[246:247],v15,2048
s_add_u32 s32, s56, 0x6c000
mf v[56:59],a[248:251],v[128:131],v[56:59]
dl v20,s[20:23],s32,0
mf v[60:63],a[248:251],v[132:135],v[60:63]
tr a[248:249],v14,4096
v_lshlrev_b32 v178, 16, v179
wl 6
mf v[64:67],a[252:255],v[124:127],v[64:67]
dl v21,s[20:23],s32,1024
mf v[68:71],a[252:255],v[128:131],v[68:71]
tr a[250:251],v14,6144
v_and_b32 v179, 0xffff0000, v179
mf v[72:75],a[252:255],v[132:135],v[72:75]
tr a[252:253],v15,4096
v_accvgpr_read_b32 v181, a76
mf v[52:55],a[232:235],v[148:151],v[52:55]
tr a[254:255],v15,6144
v_lshlrev_b32 v180, 16, v181
mf v[56:59],a[232:235],v[152:155],v[56:59]
dl v22,s[20:23],s32,2048
mf v[60:63],a[232:235],v[156:159],v[60:63]
tr a[232:233],v14,8192
v_and_b32 v181, 0xffff0000, v181
wl 5
mf v[64:67],a[236:239],v[148:151],v[64:67]
tr a[234:235],v14,10240
v_accvgpr_read_b32 v183, a77
mf v[68:71],a[236:239],v[152:155],v[68:71]
cv v28,v28,v29
v_lshlrev_b32 v182, 16, v183
mf v[72:75],a[236:239],v[156:159],v[72:75]
dl v23,s[20:23],s32,3072
mf v[52:55],a[240:243],v[88:91],v[52:55]
tr a[236:237],v15,8192
cv v29,v30,v31
mf v[56:59],a[240:243],v[92:95],v[56:59]
tr a[238:239],v15,10240
v_and_b32 v183, 0xffff0000, v183
mf v[60:63],a[240:243],v[96:99],v[60:63]
tr a[240:241],v14,12288
cv v30,v40,v41
mf v[64:67],a[244:247],v[88:91],v[64:67]
tr a[242:243],v14,14336
v_accvgpr_read_b32 v185, a78
mf v[68:71],a[244:247],v[92:95],v[68:71]
cv v31,v42,v43
s_add_u32 s33, s47, 0xc000
mf v[72:75],a[244:247],v[96:99],v[72:75]
buffer_store_dwordx4 v[28:31], v25, s[28:31], s33 offen offset:0 sc1
wl 4
mf v[52:55],a[248:251],v[112:115],v[52:55]
tr a[244:245],v15,12288
cv v32,v32,v33
mf v[56:59],a[248:251],v[116:119],v[56:59]
tr a[246:247],v15,14336
cv v33,v34,v35
mf v[60:63],a[248:251],v[120:123],v[60:63]
cv v34,v44,v45
cv v35,v46,v47
mf v[64:67],a[252:255],v[112:115],v[64:67]
buffer_store_dwordx4 v[32:35], v25, s[28:31], s33 offen offset:1024 sc1
mf v[68:71],a[252:255],v[116:119],v[68:71]
s_waitcnt vmcnt(24)
s_barrier
mf v[72:75],a[252:255],v[120:123],v[72:75]
tr a[248:249],v8,16384
cv v36,v36,v37
mf v[52:55],a[232:235],v[136:139],v[52:55]
tr a[250:251],v8,18432
cv v37,v38,v39
mf v[56:59],a[232:235],v[140:143],v[56:59]
tr a[252:253],v9,16384
cv v38,v48,v49
mf v[60:63],a[232:235],v[144:147],v[60:63]
tr a[254:255],v9,18432
cv v39,v50,v51
wl 4
mf v[64:67],a[236:239],v[136:139],v[64:67]
buffer_store_dwordx4 v[36:39], v25, s[28:31], s33 offen offset:2048 sc1
mf v[68:71],a[236:239],v[140:143],v[68:71]
tr a[232:233],v8,20480
v_lshlrev_b32 v184, 16, v185
mf v[72:75],a[236:239],v[144:147],v[72:75]
tr a[234:235],v8,22528
v_and_b32 v185, 0xffff0000, v185
mf v[52:55],a[240:243],v[160:163],v[52:55]
tr a[236:237],v9,20480
v_accvgpr_read_b32 v187, a79
mf v[56:59],a[240:243],v[164:167],v[56:59]
tr a[238:239],v9,22528
v_lshlrev_b32 v186, 16, v187
mf v[60:63],a[240:243],v[168:171],v[60:63]
tr a[240:241],v8,24576
v_and_b32 v187, 0xffff0000, v187
mf v[64:67],a[244:247],v[160:163],v[64:67]
tr a[242:243],v8,26624
v_accvgpr_read_b32 v189, a80
mf v[68:71],a[244:247],v[164:167],v[68:71]
v_lshlrev_b32 v188, 16, v189
v_and_b32 v189, 0xffff0000, v189
v_accvgpr_read_b32 v191, a81
v_lshlrev_b32 v190, 16, v191
v_and_b32 v191, 0xffff0000, v191
v_accvgpr_read_b32 v193, a82
v_lshlrev_b32 v192, 16, v193
v_and_b32 v193, 0xffff0000, v193
v_accvgpr_read_b32 v195, a83
v_lshlrev_b32 v194, 16, v195
v_and_b32 v195, 0xffff0000, v195
mf v[72:75],a[244:247],v[168:171],v[72:75]
tr a[244:245],v9,24576
v_accvgpr_read_b32 v197, a84
wl 6
mf v[172:175],a[248:251],v[76:79],v[172:175]
tr a[246:247],v9,26624
v_lshlrev_b32 v196, 16, v197
mf v[176:179],a[248:251],v[80:83],v[176:179]
v_and_b32 v197, 0xffff0000, v197
v_accvgpr_read_b32 v199, a85
mf v[180:183],a[248:251],v[84:87],v[180:183]
tr a[248:249],v8,28672
v_lshlrev_b32 v198, 16, v199
mf v[184:187],a[252:255],v[76:79],v[184:187]
tr a[250:251],v8,30720
v_and_b32 v199, 0xffff0000, v199
mf v[188:191],a[252:255],v[80:83],v[188:191]
v_accvgpr_read_b32 v201, a86
v_lshlrev_b32 v200, 16, v201
mf v[192:195],a[252:255],v[84:87],v[192:195]
tr a[252:253],v9,28672
v_and_b32 v201, 0xffff0000, v201
wl 5
mf v[172:175],a[232:235],v[100:103],v[172:175]
tr a[254:255],v9,30720
v_accvgpr_read_b32 v203, a87
mf v[176:179],a[232:235],v[104:107],v[176:179]
v_lshlrev_b32 v202, 16, v203
v_and_b32 v203, 0xffff0000, v203
mf v[180:183],a[232:235],v[108:111],v[180:183]
tr a[232:233],v10,16384
v_accvgpr_read_b32 v205, a88
mf v[184:187],a[236:239],v[100:103],v[184:187]
tr a[234:235],v10,18432
v_lshlrev_b32 v204, 16, v205
mf v[188:191],a[236:239],v[104:107],v[188:191]
v_and_b32 v205, 0xffff0000, v205
v_accvgpr_read_b32 v207, a89
mf v[192:195],a[236:239],v[108:111],v[192:195]
tr a[236:237],v11,16384
cv v52,v52,v53
mf v[172:175],a[240:243],v[124:127],v[172:175]
tr a[238:239],v11,18432
v_lshlrev_b32 v206, 16, v207
mf v[176:179],a[240:243],v[128:131],v[176:179]
cv v53,v54,v55
v_and_b32 v207, 0xffff0000, v207
mf v[180:183],a[240:243],v[132:135],v[180:183]
tr a[240:241],v10,20480
cv v54,v64,v65
wl 5
mf v[184:187],a[244:247],v[124:127],v[184:187]
tr a[242:243],v10,22528
v_accvgpr_read_b32 v209, a90
mf v[188:191],a[244:247],v[128:131],v[188:191]
cv v55,v66,v67
s_add_u32 s33, s47, 0xf000
mf v[192:195],a[244:247],v[132:135],v[192:195]
buffer_store_dwordx4 v[52:55], v25, s[28:31], s33 offen offset:0 sc1
mf v[172:175],a[248:251],v[148:151],v[172:175]
tr a[244:245],v11,20480
cv v56,v56,v57
mf v[176:179],a[248:251],v[152:155],v[176:179]
tr a[246:247],v11,22528
cv v57,v58,v59
mf v[180:183],a[248:251],v[156:159],v[180:183]
tr a[248:249],v10,24576
cv v58,v68,v69
mf v[184:187],a[252:255],v[148:151],v[184:187]
tr a[250:251],v10,26624
cv v59,v70,v71
mf v[188:191],a[252:255],v[152:155],v[188:191]
buffer_store_dwordx4 v[56:59], v25, s[28:31], s33 offen offset:1024 sc1
mf v[192:195],a[252:255],v[156:159],v[192:195]
tr a[252:253],v11,24576
cv v60,v60,v61
wl 5
mf v[172:175],a[232:235],v[88:91],v[172:175]
tr a[254:255],v11,26624
cv v61,v62,v63
mf v[176:179],a[232:235],v[92:95],v[176:179]
cv v62,v72,v73
cv v63,v74,v75
mf v[180:183],a[232:235],v[96:99],v[180:183]
buffer_store_dwordx4 v[60:63], v25, s[28:31], s33 offen offset:2048 sc1
mf v[184:187],a[236:239],v[88:91],v[184:187]
tr a[232:233],v10,28672
v_lshlrev_b32 v208, 16, v209
mf v[188:191],a[236:239],v[92:95],v[188:191]
tr a[234:235],v10,30720
v_and_b32 v209, 0xffff0000, v209
mf v[192:195],a[236:239],v[96:99],v[192:195]
tr a[236:237],v11,28672
v_accvgpr_read_b32 v211, a91
mf v[172:175],a[240:243],v[112:115],v[172:175]
tr a[238:239],v11,30720
v_lshlrev_b32 v210, 16, v211
mf v[176:179],a[240:243],v[116:119],v[176:179]
v_and_b32 v211, 0xffff0000, v211
v_accvgpr_read_b32 v213, a92
mf v[180:183],a[240:243],v[120:123],v[180:183]
v_lshlrev_b32 v212, 16, v213
v_and_b32 v213, 0xffff0000, v213
wl 4
mf v[184:187],a[244:247],v[112:115],v[184:187]
v_accvgpr_read_b32 v215, a93
v_lshlrev_b32 v214, 16, v215
mf v[188:191],a[244:247],v[116:119],v[188:191]
s_waitcnt vmcnt(17)
s_barrier
mf v[192:195],a[244:247],v[120:123],v[192:195]
tr a[240:241],v12,32768
v_and_b32 v215, 0xffff0000, v215
mf v[172:175],a[248:251],v[136:139],v[172:175]
tr a[242:243],v12,34816
v_accvgpr_read_b32 v217, a94
mf v[176:179],a[248:251],v[140:143],v[176:179]
tr a[244:245],v13,32768
v_lshlrev_b32 v216, 16, v217
mf v[180:183],a[248:251],v[144:147],v[180:183]
tr a[246:247],v13,34816
v_and_b32 v217, 0xffff0000, v217
mf v[184:187],a[252:255],v[136:139],v[184:187]
tr a[248:249],v12,36864
v_accvgpr_read_b32 v219, a95
mf v[188:191],a[252:255],v[140:143],v[188:191]
tr a[250:251],v12,38912
v_lshlrev_b32 v218, 16, v219
mf v[192:195],a[252:255],v[144:147],v[192:195]
tr a[252:253],v13,36864
v_and_b32 v219, 0xffff0000, v219
wl 7
mf v[172:175],a[232:235],v[160:163],v[172:175]
tr a[254:255],v13,38912
v_accvgpr_read_b32 v29, a168
mf v[176:179],a[232:235],v[164:167],v[176:179]
v_lshlrev_b32 v28, 16, v29
v_and_b32 v29, 0xffff0000, v29
mf v[180:183],a[232:235],v[168:171],v[180:183]
tr a[232:233],v12,40960
v_accvgpr_read_b32 v31, a169
mf v[184:187],a[236:239],v[160:163],v[184:187]
tr a[234:235],v12,43008
v_lshlrev_b32 v30, 16, v31
mf v[188:191],a[236:239],v[164:167],v[188:191]
v_and_b32 v31, 0xffff0000, v31
v_accvgpr_read_b32 v33, a170
mf v[192:195],a[236:239],v[168:171],v[192:195]
tr a[236:237],v13,40960
v_lshlrev_b32 v32, 16, v33
wl 5
mf v[196:199],a[240:243],v[76:79],v[196:199]
tr a[238:239],v13,43008
v_and_b32 v33, 0xffff0000, v33
mf v[200:203],a[240:243],v[80:83],v[200:203]
v_accvgpr_read_b32 v35, a171
v_lshlrev_b32 v34, 16, v35
mf v[204:207],a[240:243],v[84:87],v[204:207]
tr a[240:241],v12,45056
v_and_b32 v35, 0xffff0000, v35
mf v[208:211],a[244:247],v[76:79],v[208:211]
tr a[242:243],v12,47104
v_accvgpr_read_b32 v37, a172
mf v[212:215],a[244:247],v[80:83],v[212:215]
v_lshlrev_b32 v36, 16, v37
v_and_b32 v37, 0xffff0000, v37
mf v[216:219],a[244:247],v[84:87],v[216:219]
tr a[244:245],v13,45056
v_accvgpr_read_b32 v39, a173
mf v[196:199],a[248:251],v[100:103],v[196:199]
tr a[246:247],v13,47104
cv v172,v172,v173
mf v[200:203],a[248:251],v[104:107],v[200:203]
v_lshlrev_b32 v38, 16, v39
cv v173,v174,v175
mf v[204:207],a[248:251],v[108:111],v[204:207]
tr a[248:249],v14,32768
v_and_b32 v39, 0xffff0000, v39
wl 5
mf v[208:211],a[252:255],v[100:103],v[208:211]
tr a[250:251],v14,34816
cv v174,v184,v185
mf v[212:215],a[252:255],v[104:107],v[212:215]
v_accvgpr_read_b32 v41, a174
cv v175,v186,v187
mf v[216:219],a[252:255],v[108:111],v[216:219]
tr a[252:253],v15,32768
s_add_u32 s33, s47, 0x12000
mf v[196:199],a[232:235],v[124:127],v[196:199]
buffer_store_dwordx4 v[172:175], v25, s[28:31], s33 offen offset:0 sc1
mf v[200:203],a[232:235],v[128:131],v[200:203]
tr a[254:255],v15,34816
cv v176,v176,v177
mf v[204:207],a[232:235],v[132:135],v[204:207]
tr a[232:233],v14,36864
cv v177,v178,v179
mf v[208:211],a[236:239],v[124:127],v[208:211]
tr a[234:235],v14,38912
cv v178,v188,v189
mf v[212:215],a[236:239],v[128:131],v[212:215]
cv v179,v190,v191
v_lshlrev_b32 v40, 16, v41
mf v[216:219],a[236:239],v[132:135],v[216:219]
buffer_store_dwordx4 v[176:179], v25, s[28:31], s33 offen offset:1024 sc1
wl 4
mf v[196:199],a[240:243],v[148:151],v[196:199]
tr a[236:237],v15,36864
cv v180,v180,v181
mf v[200:203],a[240:243],v[152:155],v[200:203]
tr a[238:239],v15,38912
cv v181,v182,v183
mf v[204:207],a[240:243],v[156:159],v[204:207]
tr a[240:241],v14,40960
cv v182,v192,v193
mf v[208:211],a[244:247],v[148:151],v[208:211]
tr a[242:243],v14,43008
cv v183,v194,v195
mf v[212:215],a[244:247],v[152:155],v[212:215]
buffer_store_dwordx4 v[180:183], v25, s[28:31], s33 offen offset:2048 sc1
mf v[216:219],a[244:247],v[156:159],v[216:219]
tr a[244:245],v15,40960
v_and_b32 v41, 0xffff0000, v41
mf v[196:199],a[248:251],v[88:91],v[196:199]
tr a[246:247],v15,43008
v_accvgpr_read_b32 v43, a175
mf v[200:203],a[248:251],v[92:95],v[200:203]
v_lshlrev_b32 v42, 16, v43
v_and_b32 v43, 0xffff0000, v43
mf v[204:207],a[248:251],v[96:99],v[204:207]
tr a[248:249],v14,45056
v_accvgpr_read_b32 v45, a176
wl 5
mf v[208:211],a[252:255],v[88:91],v[208:211]
tr a[250:251],v14,47104
v_lshlrev_b32 v44, 16, v45
mf v[212:215],a[252:255],v[92:95],v[212:215]
v_and_b32 v45, 0xffff0000, v45
v_accvgpr_read_b32 v47, a177
mf v[216:219],a[252:255],v[96:99],v[216:219]
tr a[252:253],v15,45056
v_lshlrev_b32 v46, 16, v47
mf v[196:199],a[232:235],v[112:115],v[196:199]
tr a[254:255],v15,47104
v_and_b32 v47, 0xffff0000, v47
mf v[200:203],a[232:235],v[116:119],v[200:203]
v_accvgpr_read_b32 v49, a178
v_lshlrev_b32 v48, 16, v49
mf v[204:207],a[232:235],v[120:123],v[204:207]
v_and_b32 v49, 0xffff0000, v49
v_accvgpr_read_b32 v51, a179
mf v[208:211],a[236:239],v[112:115],v[208:211]
v_lshlrev_b32 v50, 16, v51
v_and_b32 v51, 0xffff0000, v51
mf v[212:215],a[236:239],v[116:119],v[212:215]
s_waitcnt vmcnt(9)
s_waitcnt vmcnt(3)
s_cmp_lg_u32 s3, 0
s_cbranch_scc1 L_hok
s_mov_b32 s48, s70
s_and_b32 s49, s71, 0xffff
s_mov_b32 s50, 256
s_mov_b32 s51, 0x20000
s_lshl_b32 s36, s40, 3
s_mov_b32 s37, 0
v_mov_b32 v3, 0
L_hp:
v_readfirstlane_b32 s100, v255
s_add_u32 s37, s37, 1
s_nop 1
s_cmp_ge_u32 s100, 8
s_cbranch_scc1 L_hok
s_sleep 16
buffer_load_dword v255, v3, s[48:51], s36 offen sc1
s_waitcnt vmcnt(0)
s_cmp_lt_u32 s37, 0x400000
s_cbranch_scc1 L_hp
L_hok:
s_barrier
v_mov_b32 v1, 1
v_mov_b32 v3, 0
s_cmp_lg_u32 s3, 0
s_cbranch_scc1 L_npa
s_mov_b64 exec, 1
buffer_store_dword v1, v3, s[28:31], s101 offen sc1
s_mov_b64 exec, -1
L_npa:
v_min_u32 v246, 7, v0
v_lshlrev_b32 v246, 3, v246
s_mov_b32 s99, 0xd8000
mf v[216:219],a[236:239],v[120:123],v[216:219]
tr a[232:233],v4,32768
wl 3
mf v[196:199],a[240:243],v[136:139],v[196:199]
tr a[234:235],v4,34816
mf v[200:203],a[240:243],v[140:143],v[200:203]
tr a[236:237],v5,32768
mf v[204:207],a[240:243],v[144:147],v[204:207]
tr a[238:239],v5,34816
mf v[208:211],a[244:247],v[136:139],v[208:211]
tr a[240:241],v4,36864
mf v[212:215],a[244:247],v[140:143],v[212:215]
tr a[242:243],v4,38912
mf v[216:219],a[244:247],v[144:147],v[216:219]
tr a[244:245],v5,36864
wl 7
mf v[196:199],a[248:251],v[160:163],v[196:199]
tr a[246:247],v5,38912
mf v[200:203],a[248:251],v[164:167],v[200:203]
mf v[204:207],a[248:251],v[168:171],v[204:207]
tr a[248:249],v4,40960
wl 6
mf v[208:211],a[252:255],v[160:163],v[208:211]
tr a[250:251],v4,43008
mf v[212:215],a[252:255],v[164:167],v[212:215]
mf v[216:219],a[252:255],v[168:171],v[216:219]
tr a[252:253],v5,40960
wl 5
mf v[28:31],a[232:235],v[76:79],v[28:31]
tr a[254:255],v5,43008
mf v[32:35],a[232:235],v[80:83],v[32:35]
mf v[36:39],a[232:235],v[84:87],v[36:39]
tr a[232:233],v4,45056
mf v[40:43],a[236:239],v[76:79],v[40:43]
tr a[234:235],v4,47104
cv v196,v196,v197
mf v[44:47],a[236:239],v[80:83],v[44:47]
cv v197,v198,v199
cv v198,v208,v209
mf v[48:51],a[236:239],v[84:87],v[48:51]
tr a[236:237],v5,45056
cv v199,v210,v211
mf v[28:31],a[240:243],v[100:103],v[28:31]
tr a[238:239],v5,47104
s_add_u32 s33, s47, 0x15000
mf v[32:35],a[240:243],v[104:107],v[32:35]
buffer_store_dwordx4 v[196:199], v25, s[28:31], s33 offen offset:0 sc1
mf v[36:39],a[240:243],v[108:111],v[36:39]
tr a[240:241],v6,32768
cv v200,v200,v201
wl 5
mf v[40:43],a[244:247],v[100:103],v[40:43]
tr a[242:243],v6,34816
cv v201,v202,v203
mf v[44:47],a[244:247],v[104:107],v[44:47]
cv v202,v212,v213
cv v203,v214,v215
mf v[48:51],a[244:247],v[108:111],v[48:51]
buffer_store_dwordx4 v[200:203], v25, s[28:31], s33 offen offset:1024 sc1
mf v[28:31],a[248:251],v[124:127],v[28:31]
tr a[244:245],v7,32768
cv v204,v204,v205
mf v[32:35],a[248:251],v[128:131],v[32:35]
tr a[246:247],v7,34816
cv v205,v206,v207
mf v[36:39],a[248:251],v[132:135],v[36:39]
tr a[248:249],v6,36864
cv v206,v216,v217
mf v[40:43],a[252:255],v[124:127],v[40:43]
tr a[250:251],v6,38912
cv v207,v218,v219
mf v[44:47],a[252:255],v[128:131],v[44:47]
buffer_store_dwordx4 v[204:207], v25, s[28:31], s33 offen offset:2048 sc1
mf v[48:51],a[252:255],v[132:135],v[48:51]
tr a[252:253],v7,36864
wl 5
mf v[28:31],a[232:235],v[148:151],v[28:31]
buffer_load_dwordx2 v[244:245], v246, s[28:31], s99 offen sc1
mf v[32:35],a[232:235],v[152:155],v[32:35]
tr a[254:255],v7,38912
mf v[36:39],a[232:235],v[156:159],v[36:39]
tr a[232:233],v6,40960
mf v[40:43],a[236:239],v[148:151],v[40:43]
tr a[234:235],v6,43008
mf v[44:47],a[236:239],v[152:155],v[44:47]
mf v[48:51],a[236:239],v[156:159],v[48:51]
tr a[236:237],v7,40960
wl 5
mf v[28:31],a[240:243],v[88:91],v[28:31]
tr a[238:239],v7,43008
mf v[32:35],a[240:243],v[92:95],v[32:35]
mf v[36:39],a[240:243],v[96:99],v[36:39]
tr a[240:241],v6,45056
mf v[40:43],a[244:247],v[88:91],v[40:43]
tr a[242:243],v6,47104
mf v[44:47],a[244:247],v[92:95],v[44:47]
mf v[48:51],a[244:247],v[96:99],v[48:51]
tr a[244:245],v7,45056
wl 5
mf v[28:31],a[248:251],v[112:115],v[28:31]
tr a[246:247],v7,47104
mf v[32:35],a[248:251],v[116:119],v[32:35]
mf v[36:39],a[248:251],v[120:123],v[36:39]
mf v[40:43],a[252:255],v[112:115],v[40:43]
mf v[44:47],a[252:255],v[116:119],v[44:47]
mf v[48:51],a[252:255],v[120:123],v[48:51]
wl 2
mf v[28:31],a[232:235],v[136:139],v[28:31]
mf v[32:35],a[232:235],v[140:143],v[32:35]
mf v[36:39],a[232:235],v[144:147],v[36:39]
mf v[40:43],a[236:239],v[136:139],v[40:43]
mf v[44:47],a[236:239],v[140:143],v[44:47]
mf v[48:51],a[236:239],v[144:147],v[48:51]
wl 0
mf v[28:31],a[240:243],v[160:163],v[28:31]
mf v[32:35],a[240:243],v[164:167],v[32:35]
mf v[36:39],a[240:243],v[168:171],v[36:39]
mf v[40:43],a[244:247],v[160:163],v[40:43]
mf v[44:47],a[244:247],v[164:167],v[44:47]
mf v[48:51],a[244:247],v[168:171],v[48:51]
s_nop 2
cv v28,v28,v29
cv v29,v30,v31
s_nop 0
cv v30,v40,v41
cv v31,v42,v43
s_add_u32 s33, s47, 0x18000
buffer_store_dwordx4 v[28:31], v25, s[28:31], s33 offen offset:0 sc1
cv v32,v32,v33
cv v33,v34,v35
cv v34,v44,v45
cv v35,v46,v47
buffer_store_dwordx4 v[32:35], v25, s[28:31], s33 offen offset:1024 sc1
cv v36,v36,v37
cv v37,v38,v39
cv v38,v48,v49
cv v39,v50,v51
buffer_store_dwordx4 v[36:39], v25, s[28:31], s33 offen offset:2048 sc1
L_final:
v_min_u32 v26, 7, v0
v_lshlrev_b32 v26, 3, v26
s_mov_b32 s61, 0xd8000
s_mov_b32 s99, 0xd8000
v_lshlrev_b32 v2, 4, v0
s_lshl_b32 s52, s46, 2
s_add_u32 s52, s52, s3
s_mov_b32 s64, s68
s_and_b32 s65, s69, 0xffff
s_mov_b32 s66, 0x360000
s_mov_b32 s67, 0x20000
v_and_b32 v6, 15, v0
v_mul_u32_u24 v6, 2304, v6
v_lshrrev_b32 v7, 4, v0
v_lshl_add_u32 v6, v7, 3, v6
v_mov_b32 v24, 0x3f80
v_mov_b32 v25, 0x3f800000
s_mov_b32 s62, 0x32106587
s_mov_b32 s63, 0x4
s_mul_i32 s60, s44, 221184
s_mul_i32 s61, s42, 1152
s_add_u32 s60, s60, s61
s_add_u32 s53, s52, 0
s_mul_hi_u32 s54, s53, 357913942
s_mul_i32 s55, s54, 12
s_sub_u32 s55, s53, s55
s_lshl_b32 s54, s54, 2
s_lshr_b64 s[36:37], s[62:63], s54
s_and_b32 s36, s36, 15
s_lshl_b32 s36, s36, 7
s_add_u32 s36, s36, s41
s_sub_u32 s37, s36, 1152
s_min_u32 s36, s36, s37
s_cmp_ge_u32 s55, 6
s_cselect_b32 s37, 64, 0
s_cselect_b32 s54, 6, 0
s_sub_u32 s55, s55, s54
s_mul_i32 s55, s55, 36864
s_add_u32 s55, s55, s36
s_add_u32 s55, s55, s37
s_add_u32 s56, s55, s60
s_add_u32 s53, s52, 32
s_mul_hi_u32 s54, s53, 357913942
s_mul_i32 s55, s54, 12
s_sub_u32 s55, s53, s55
s_lshl_b32 s54, s54, 2
s_lshr_b64 s[36:37], s[62:63], s54
s_and_b32 s36, s36, 15
s_lshl_b32 s36, s36, 7
s_add_u32 s36, s36, s41
s_sub_u32 s37, s36, 1152
s_min_u32 s36, s36, s37
s_cmp_ge_u32 s55, 6
s_cselect_b32 s37, 64, 0
s_cselect_b32 s54, 6, 0
s_sub_u32 s55, s55, s54
s_mul_i32 s55, s55, 36864
s_add_u32 s55, s55, s36
s_add_u32 s55, s55, s37
s_add_u32 s57, s55, s60
s_add_u32 s53, s52, 64
s_mul_hi_u32 s54, s53, 357913942
s_mul_i32 s55, s54, 12
s_sub_u32 s55, s53, s55
s_lshl_b32 s54, s54, 2
s_lshr_b64 s[36:37], s[62:63], s54
s_and_b32 s36, s36, 15
s_lshl_b32 s36, s36, 7
s_add_u32 s36, s36, s41
s_sub_u32 s37, s36, 1152
s_min_u32 s36, s36, s37
s_cmp_ge_u32 s55, 6
s_cselect_b32 s37, 64, 0
s_cselect_b32 s54, 6, 0
s_sub_u32 s55, s55, s54
s_mul_i32 s55, s55, 36864
s_add_u32 s55, s55, s36
s_add_u32 s55, s55, s37
s_add_u32 s58, s55, s60
s_add_u32 s53, s52, 96
s_mul_hi_u32 s54, s53, 357913942
s_mul_i32 s55, s54, 12
s_sub_u32 s55, s53, s55
s_lshl_b32 s54, s54, 2
s_lshr_b64 s[36:37], s[62:63], s54
s_and_b32 s36, s36, 15
s_lshl_b32 s36, s36, 7
s_add_u32 s36, s36, s41
s_sub_u32 s37, s36, 1152
s_min_u32 s36, s36, s37
s_cmp_ge_u32 s55, 6
s_cselect_b32 s37, 64, 0
s_cselect_b32 s54, 6, 0
s_sub_u32 s55, s55, s54
s_mul_i32 s55, s55, 36864
s_add_u32 s55, s55, s36
s_add_u32 s55, s55, s37
s_add_u32 s59, s55, s60
s_cmp_lt_u32 s52, 12
s_cselect_b32 s59, s59, 0x70000000
s_waitcnt vmcnt(0) lgkmcnt(0)
v_mov_b32 v4, v244
v_mov_b32 v5, v245
s_lshl_b32 s53, s46, 3
v_cmp_eq_u32 s[48:49], s53, v26
s_barrier
s_cmp_lg_u32 s3, 0
s_cbranch_scc1 L_npb
s_mov_b64 exec, 1
buffer_store_dword v1, v3, s[28:31], s101 offen offset:4 sc1
s_mov_b64 exec, -1
L_npb:
s_mov_b32 s53, 0
L_pollA:
v_cmp_eq_u32 vcc, 1, v4
s_add_u32 s53, s53, 1
s_nop 1
s_or_b64 vcc, vcc, s[48:49]
s_cmp_eq_u64 vcc, -1
s_cbranch_scc1 L_pdA
s_sleep 8
L_plA:
buffer_load_dwordx2 v[4:5], v26, s[28:31], s99 offen sc1
s_waitcnt vmcnt(0)
s_cmp_lt_u32 s53, 0x400000
s_cbranch_scc1 L_pollA
L_pdA:
v_cmp_eq_u32 vcc, 1, v5
s_nop 1
s_or_b64 vcc, vcc, s[48:49]
s_cmp_eq_u64 vcc, -1
s_cbranch_scc0 L_two
s_add_u32 s53, s52, 0
s_lshl_b32 s53, s53, 10
buffer_load_dwordx4 v[32:35], v2, s[28:31], s53 offen sc1
s_add_u32 s53, s53, 110592
buffer_load_dwordx4 v[36:39], v2, s[28:31], s53 offen sc1
s_add_u32 s53, s53, 110592
buffer_load_dwordx4 v[40:43], v2, s[28:31], s53 offen sc1
s_add_u32 s53, s53, 110592
buffer_load_dwordx4 v[44:47], v2, s[28:31], s53 offen sc1
s_add_u32 s53, s53, 110592
buffer_load_dwordx4 v[48:51], v2, s[28:31], s53 offen sc1
s_add_u32 s53, s53, 110592
buffer_load_dwordx4 v[52:55], v2, s[28:31], s53 offen sc1
s_add_u32 s53, s53, 110592
buffer_load_dwordx4 v[56:59], v2, s[28:31], s53 offen sc1
s_add_u32 s53, s53, 110592
buffer_load_dwordx4 v[60:63], v2, s[28:31], s53 offen sc1
s_add_u32 s53, s52, 32
s_lshl_b32 s53, s53, 10
buffer_load_dwordx4 v[64:67], v2, s[28:31], s53 offen sc1
s_add_u32 s53, s53, 110592
buffer_load_dwordx4 v[68:71], v2, s[28:31], s53 offen sc1
s_add_u32 s53, s53, 110592
buffer_load_dwordx4 v[72:75], v2, s[28:31], s53 offen sc1
s_add_u32 s53, s53, 110592
buffer_load_dwordx4 v[76:79], v2, s[28:31], s53 offen sc1
s_add_u32 s53, s53, 110592
buffer_load_dwordx4 v[80:83], v2, s[28:31], s53 offen sc1
s_add_u32 s53, s53, 110592
buffer_load_dwordx4 v[84:87], v2, s[28:31], s53 offen sc1
s_add_u32 s53, s53, 110592
buffer_load_dwordx4 v[88:91], v2, s[28:31], s53 offen sc1
s_add_u32 s53, s53, 110592
buffer_load_dwordx4 v[92:95], v2, s[28:31], s53 offen sc1
s_add_u32 s53, s52, 64
s_lshl_b32 s53, s53, 10
buffer_load_dwordx4 v[96:99], v2, s[28:31], s53 offen sc1
s_add_u32 s53, s53, 110592
buffer_load_dwordx4 v[100:103], v2, s[28:31], s53 offen sc1
s_add_u32 s53, s53, 110592
buffer_load_dwordx4 v[104:107], v2, s[28:31], s53 offen sc1
s_add_u32 s53, s53, 110592
buffer_load_dwordx4 v[108:111], v2, s[28:31], s53 offen sc1
s_add_u32 s53, s53, 110592
buffer_load_dwordx4 v[112:115], v2, s[28:31], s53 offen sc1
s_add_u32 s53, s53, 110592
buffer_load_dwordx4 v[116:119], v2, s[28:31], s53 offen sc1
s_add_u32 s53, s53, 110592
buffer_load_dwordx4 v[120:123], v2, s[28:31], s53 offen sc1
s_add_u32 s53, s53, 110592
buffer_load_dwordx4 v[124:127], v2, s[28:31], s53 offen sc1
s_add_u32 s53, s52, 96
s_lshl_b32 s53, s53, 10
s_cmp_lt_u32 s52, 12
s_cselect_b32 s53, s53, 0x70000000
buffer_load_dwordx4 v[128:131], v2, s[28:31], s53 offen sc1
s_add_u32 s53, s53, 110592
buffer_load_dwordx4 v[132:135], v2, s[28:31], s53 offen sc1
s_add_u32 s53, s53, 110592
buffer_load_dwordx4 v[136:139], v2, s[28:31], s53 offen sc1
s_add_u32 s53, s53, 110592
buffer_load_dwordx4 v[140:143], v2, s[28:31], s53 offen sc1
s_add_u32 s53, s53, 110592
buffer_load_dwordx4 v[144:147], v2, s[28:31], s53 offen sc1
s_add_u32 s53, s53, 110592
buffer_load_dwordx4 v[148:151], v2, s[28:31], s53 offen sc1
s_add_u32 s53, s53, 110592
buffer_load_dwordx4 v[152:155], v2, s[28:31], s53 offen sc1
s_add_u32 s53, s53, 110592
buffer_load_dwordx4 v[156:159], v2, s[28:31], s53 offen sc1
s_waitcnt vmcnt(31)
v_dot2_f32_bf16 v8, v32, v24, 0
v_dot2_f32_bf16 v9, v32, v25, 0
v_dot2_f32_bf16 v10, v33, v24, 0
v_dot2_f32_bf16 v11, v33, v25, 0
v_dot2_f32_bf16 v12, v34, v24, 0
v_dot2_f32_bf16 v13, v34, v25, 0
v_dot2_f32_bf16 v14, v35, v24, 0
v_dot2_f32_bf16 v15, v35, v25, 0
s_waitcnt vmcnt(30)
v_dot2_f32_bf16 v8, v36, v24, v8
v_dot2_f32_bf16 v9, v36, v25, v9
v_dot2_f32_bf16 v10, v37, v24, v10
v_dot2_f32_bf16 v11, v37, v25, v11
v_dot2_f32_bf16 v12, v38, v24, v12
v_dot2_f32_bf16 v13, v38, v25, v13
v_dot2_f32_bf16 v14, v39, v24, v14
v_dot2_f32_bf16 v15, v39, v25, v15
s_waitcnt vmcnt(29)
v_dot2_f32_bf16 v8, v40, v24, v8
v_dot2_f32_bf16 v9, v40, v25, v9
v_dot2_f32_bf16 v10, v41, v24, v10
v_dot2_f32_bf16 v11, v41, v25, v11
v_dot2_f32_bf16 v12, v42, v24, v12
v_dot2_f32_bf16 v13, v42, v25, v13
v_dot2_f32_bf16 v14, v43, v24, v14
v_dot2_f32_bf16 v15, v43, v25, v15
s_waitcnt vmcnt(28)
v_dot2_f32_bf16 v8, v44, v24, v8
v_dot2_f32_bf16 v9, v44, v25, v9
v_dot2_f32_bf16 v10, v45, v24, v10
v_dot2_f32_bf16 v11, v45, v25, v11
v_dot2_f32_bf16 v12, v46, v24, v12
v_dot2_f32_bf16 v13, v46, v25, v13
v_dot2_f32_bf16 v14, v47, v24, v14
v_dot2_f32_bf16 v15, v47, v25, v15
s_waitcnt vmcnt(27)
v_dot2_f32_bf16 v8, v48, v24, v8
v_dot2_f32_bf16 v9, v48, v25, v9
v_dot2_f32_bf16 v10, v49, v24, v10
v_dot2_f32_bf16 v11, v49, v25, v11
v_dot2_f32_bf16 v12, v50, v24, v12
v_dot2_f32_bf16 v13, v50, v25, v13
v_dot2_f32_bf16 v14, v51, v24, v14
v_dot2_f32_bf16 v15, v51, v25, v15
s_waitcnt vmcnt(26)
v_dot2_f32_bf16 v8, v52, v24, v8
v_dot2_f32_bf16 v9, v52, v25, v9
v_dot2_f32_bf16 v10, v53, v24, v10
v_dot2_f32_bf16 v11, v53, v25, v11
v_dot2_f32_bf16 v12, v54, v24, v12
v_dot2_f32_bf16 v13, v54, v25, v13
v_dot2_f32_bf16 v14, v55, v24, v14
v_dot2_f32_bf16 v15, v55, v25, v15
s_waitcnt vmcnt(25)
v_dot2_f32_bf16 v8, v56, v24, v8
v_dot2_f32_bf16 v9, v56, v25, v9
v_dot2_f32_bf16 v10, v57, v24, v10
v_dot2_f32_bf16 v11, v57, v25, v11
v_dot2_f32_bf16 v12, v58, v24, v12
v_dot2_f32_bf16 v13, v58, v25, v13
v_dot2_f32_bf16 v14, v59, v24, v14
v_dot2_f32_bf16 v15, v59, v25, v15
s_waitcnt vmcnt(24)
v_dot2_f32_bf16 v8, v60, v24, v8
v_dot2_f32_bf16 v9, v60, v25, v9
v_dot2_f32_bf16 v10, v61, v24, v10
v_dot2_f32_bf16 v11, v61, v25, v11
v_dot2_f32_bf16 v12, v62, v24, v12
v_dot2_f32_bf16 v13, v62, v25, v13
v_dot2_f32_bf16 v14, v63, v24, v14
v_dot2_f32_bf16 v15, v63, v25, v15
s_nop 2
cv v16,v8,v9
cv v17,v10,v11
cv v18,v12,v13
cv v19,v14,v15
buffer_store_dwordx2 v[16:17], v6, s[64:67], s56 offen
buffer_store_dwordx2 v[18:19], v6, s[64:67], s56 offen offset:32
s_nop 2
s_waitcnt vmcnt(25)
v_dot2_f32_bf16 v8, v64, v24, 0
v_dot2_f32_bf16 v9, v64, v25, 0
v_dot2_f32_bf16 v10, v65, v24, 0
v_dot2_f32_bf16 v11, v65, v25, 0
v_dot2_f32_bf16 v12, v66, v24, 0
v_dot2_f32_bf16 v13, v66, v25, 0
v_dot2_f32_bf16 v14, v67, v24, 0
v_dot2_f32_bf16 v15, v67, v25, 0
s_waitcnt vmcnt(24)
v_dot2_f32_bf16 v8, v68, v24, v8
v_dot2_f32_bf16 v9, v68, v25, v9
v_dot2_f32_bf16 v10, v69, v24, v10
v_dot2_f32_bf16 v11, v69, v25, v11
v_dot2_f32_bf16 v12, v70, v24, v12
v_dot2_f32_bf16 v13, v70, v25, v13
v_dot2_f32_bf16 v14, v71, v24, v14
v_dot2_f32_bf16 v15, v71, v25, v15
s_waitcnt vmcnt(23)
v_dot2_f32_bf16 v8, v72, v24, v8
v_dot2_f32_bf16 v9, v72, v25, v9
v_dot2_f32_bf16 v10, v73, v24, v10
v_dot2_f32_bf16 v11, v73, v25, v11
v_dot2_f32_bf16 v12, v74, v24, v12
v_dot2_f32_bf16 v13, v74, v25, v13
v_dot2_f32_bf16 v14, v75, v24, v14
v_dot2_f32_bf16 v15, v75, v25, v15
s_waitcnt vmcnt(22)
v_dot2_f32_bf16 v8, v76, v24, v8
v_dot2_f32_bf16 v9, v76, v25, v9
v_dot2_f32_bf16 v10, v77, v24, v10
v_dot2_f32_bf16 v11, v77, v25, v11
v_dot2_f32_bf16 v12, v78, v24, v12
v_dot2_f32_bf16 v13, v78, v25, v13
v_dot2_f32_bf16 v14, v79, v24, v14
v_dot2_f32_bf16 v15, v79, v25, v15
s_waitcnt vmcnt(21)
v_dot2_f32_bf16 v8, v80, v24, v8
v_dot2_f32_bf16 v9, v80, v25, v9
v_dot2_f32_bf16 v10, v81, v24, v10
v_dot2_f32_bf16 v11, v81, v25, v11
v_dot2_f32_bf16 v12, v82, v24, v12
v_dot2_f32_bf16 v13, v82, v25, v13
v_dot2_f32_bf16 v14, v83, v24, v14
v_dot2_f32_bf16 v15, v83, v25, v15
s_waitcnt vmcnt(20)
v_dot2_f32_bf16 v8, v84, v24, v8
v_dot2_f32_bf16 v9, v84, v25, v9
v_dot2_f32_bf16 v10, v85, v24, v10
v_dot2_f32_bf16 v11, v85, v25, v11
v_dot2_f32_bf16 v12, v86, v24, v12
v_dot2_f32_bf16 v13, v86, v25, v13
v_dot2_f32_bf16 v14, v87, v24, v14
v_dot2_f32_bf16 v15, v87, v25, v15
s_waitcnt vmcnt(19)
v_dot2_f32_bf16 v8, v88, v24, v8
v_dot2_f32_bf16 v9, v88, v25, v9
v_dot2_f32_bf16 v10, v89, v24, v10
v_dot2_f32_bf16 v11, v89, v25, v11
v_dot2_f32_bf16 v12, v90, v24, v12
v_dot2_f32_bf16 v13, v90, v25, v13
v_dot2_f32_bf16 v14, v91, v24, v14
v_dot2_f32_bf16 v15, v91, v25, v15
s_waitcnt vmcnt(18)
v_dot2_f32_bf16 v8, v92, v24, v8
v_dot2_f32_bf16 v9, v92, v25, v9
v_dot2_f32_bf16 v10, v93, v24, v10
v_dot2_f32_bf16 v11, v93, v25, v11
v_dot2_f32_bf16 v12, v94, v24, v12
v_dot2_f32_bf16 v13, v94, v25, v13
v_dot2_f32_bf16 v14, v95, v24, v14
v_dot2_f32_bf16 v15, v95, v25, v15
s_nop 2
cv v20,v8,v9
cv v21,v10,v11
cv v22,v12,v13
cv v23,v14,v15
buffer_store_dwordx2 v[20:21], v6, s[64:67], s57 offen
buffer_store_dwordx2 v[22:23], v6, s[64:67], s57 offen offset:32
s_nop 2
s_waitcnt vmcnt(19)
v_dot2_f32_bf16 v8, v96, v24, 0
v_dot2_f32_bf16 v9, v96, v25, 0
v_dot2_f32_bf16 v10, v97, v24, 0
v_dot2_f32_bf16 v11, v97, v25, 0
v_dot2_f32_bf16 v12, v98, v24, 0
v_dot2_f32_bf16 v13, v98, v25, 0
v_dot2_f32_bf16 v14, v99, v24, 0
v_dot2_f32_bf16 v15, v99, v25, 0
s_waitcnt vmcnt(18)
v_dot2_f32_bf16 v8, v100, v24, v8
v_dot2_f32_bf16 v9, v100, v25, v9
v_dot2_f32_bf16 v10, v101, v24, v10
v_dot2_f32_bf16 v11, v101, v25, v11
v_dot2_f32_bf16 v12, v102, v24, v12
v_dot2_f32_bf16 v13, v102, v25, v13
v_dot2_f32_bf16 v14, v103, v24, v14
v_dot2_f32_bf16 v15, v103, v25, v15
s_waitcnt vmcnt(17)
v_dot2_f32_bf16 v8, v104, v24, v8
v_dot2_f32_bf16 v9, v104, v25, v9
v_dot2_f32_bf16 v10, v105, v24, v10
v_dot2_f32_bf16 v11, v105, v25, v11
v_dot2_f32_bf16 v12, v106, v24, v12
v_dot2_f32_bf16 v13, v106, v25, v13
v_dot2_f32_bf16 v14, v107, v24, v14
v_dot2_f32_bf16 v15, v107, v25, v15
s_waitcnt vmcnt(16)
v_dot2_f32_bf16 v8, v108, v24, v8
v_dot2_f32_bf16 v9, v108, v25, v9
v_dot2_f32_bf16 v10, v109, v24, v10
v_dot2_f32_bf16 v11, v109, v25, v11
v_dot2_f32_bf16 v12, v110, v24, v12
v_dot2_f32_bf16 v13, v110, v25, v13
v_dot2_f32_bf16 v14, v111, v24, v14
v_dot2_f32_bf16 v15, v111, v25, v15
s_waitcnt vmcnt(15)
v_dot2_f32_bf16 v8, v112, v24, v8
v_dot2_f32_bf16 v9, v112, v25, v9
v_dot2_f32_bf16 v10, v113, v24, v10
v_dot2_f32_bf16 v11, v113, v25, v11
v_dot2_f32_bf16 v12, v114, v24, v12
v_dot2_f32_bf16 v13, v114, v25, v13
v_dot2_f32_bf16 v14, v115, v24, v14
v_dot2_f32_bf16 v15, v115, v25, v15
s_waitcnt vmcnt(14)
v_dot2_f32_bf16 v8, v116, v24, v8
v_dot2_f32_bf16 v9, v116, v25, v9
v_dot2_f32_bf16 v10, v117, v24, v10
v_dot2_f32_bf16 v11, v117, v25, v11
v_dot2_f32_bf16 v12, v118, v24, v12
v_dot2_f32_bf16 v13, v118, v25, v13
v_dot2_f32_bf16 v14, v119, v24, v14
v_dot2_f32_bf16 v15, v119, v25, v15
s_waitcnt vmcnt(13)
v_dot2_f32_bf16 v8, v120, v24, v8
v_dot2_f32_bf16 v9, v120, v25, v9
v_dot2_f32_bf16 v10, v121, v24, v10
v_dot2_f32_bf16 v11, v121, v25, v11
v_dot2_f32_bf16 v12, v122, v24, v12
v_dot2_f32_bf16 v13, v122, v25, v13
v_dot2_f32_bf16 v14, v123, v24, v14
v_dot2_f32_bf16 v15, v123, v25, v15
s_waitcnt vmcnt(12)
v_dot2_f32_bf16 v8, v124, v24, v8
v_dot2_f32_bf16 v9, v124, v25, v9
v_dot2_f32_bf16 v10, v125, v24, v10
v_dot2_f32_bf16 v11, v125, v25, v11
v_dot2_f32_bf16 v12, v126, v24, v12
v_dot2_f32_bf16 v13, v126, v25, v13
v_dot2_f32_bf16 v14, v127, v24, v14
v_dot2_f32_bf16 v15, v127, v25, v15
s_nop 2
cv v16,v8,v9
cv v17,v10,v11
cv v18,v12,v13
cv v19,v14,v15
buffer_store_dwordx2 v[16:17], v6, s[64:67], s58 offen
buffer_store_dwordx2 v[18:19], v6, s[64:67], s58 offen offset:32
s_nop 2
s_waitcnt vmcnt(13)
v_dot2_f32_bf16 v8, v128, v24, 0
v_dot2_f32_bf16 v9, v128, v25, 0
v_dot2_f32_bf16 v10, v129, v24, 0
v_dot2_f32_bf16 v11, v129, v25, 0
v_dot2_f32_bf16 v12, v130, v24, 0
v_dot2_f32_bf16 v13, v130, v25, 0
v_dot2_f32_bf16 v14, v131, v24, 0
v_dot2_f32_bf16 v15, v131, v25, 0
s_waitcnt vmcnt(12)
v_dot2_f32_bf16 v8, v132, v24, v8
v_dot2_f32_bf16 v9, v132, v25, v9
v_dot2_f32_bf16 v10, v133, v24, v10
v_dot2_f32_bf16 v11, v133, v25, v11
v_dot2_f32_bf16 v12, v134, v24, v12
v_dot2_f32_bf16 v13, v134, v25, v13
v_dot2_f32_bf16 v14, v135, v24, v14
v_dot2_f32_bf16 v15, v135, v25, v15
s_waitcnt vmcnt(11)
v_dot2_f32_bf16 v8, v136, v24, v8
v_dot2_f32_bf16 v9, v136, v25, v9
v_dot2_f32_bf16 v10, v137, v24, v10
v_dot2_f32_bf16 v11, v137, v25, v11
v_dot2_f32_bf16 v12, v138, v24, v12
v_dot2_f32_bf16 v13, v138, v25, v13
v_dot2_f32_bf16 v14, v139, v24, v14
v_dot2_f32_bf16 v15, v139, v25, v15
s_waitcnt vmcnt(10)
v_dot2_f32_bf16 v8, v140, v24, v8
v_dot2_f32_bf16 v9, v140, v25, v9
v_dot2_f32_bf16 v10, v141, v24, v10
v_dot2_f32_bf16 v11, v141, v25, v11
v_dot2_f32_bf16 v12, v142, v24, v12
v_dot2_f32_bf16 v13, v142, v25, v13
v_dot2_f32_bf16 v14, v143, v24, v14
v_dot2_f32_bf16 v15, v143, v25, v15
s_waitcnt vmcnt(9)
v_dot2_f32_bf16 v8, v144, v24, v8
v_dot2_f32_bf16 v9, v144, v25, v9
v_dot2_f32_bf16 v10, v145, v24, v10
v_dot2_f32_bf16 v11, v145, v25, v11
v_dot2_f32_bf16 v12, v146, v24, v12
v_dot2_f32_bf16 v13, v146, v25, v13
v_dot2_f32_bf16 v14, v147, v24, v14
v_dot2_f32_bf16 v15, v147, v25, v15
s_waitcnt vmcnt(8)
v_dot2_f32_bf16 v8, v148, v24, v8
v_dot2_f32_bf16 v9, v148, v25, v9
v_dot2_f32_bf16 v10, v149, v24, v10
v_dot2_f32_bf16 v11, v149, v25, v11
v_dot2_f32_bf16 v12, v150, v24, v12
v_dot2_f32_bf16 v13, v150, v25, v13
v_dot2_f32_bf16 v14, v151, v24, v14
v_dot2_f32_bf16 v15, v151, v25, v15
s_waitcnt vmcnt(7)
v_dot2_f32_bf16 v8, v152, v24, v8
v_dot2_f32_bf16 v9, v152, v25, v9
v_dot2_f32_bf16 v10, v153, v24, v10
v_dot2_f32_bf16 v11, v153, v25, v11
v_dot2_f32_bf16 v12, v154, v24, v12
v_dot2_f32_bf16 v13, v154, v25, v13
v_dot2_f32_bf16 v14, v155, v24, v14
v_dot2_f32_bf16 v15, v155, v25, v15
s_waitcnt vmcnt(6)
v_dot2_f32_bf16 v8, v156, v24, v8
v_dot2_f32_bf16 v9, v156, v25, v9
v_dot2_f32_bf16 v10, v157, v24, v10
v_dot2_f32_bf16 v11, v157, v25, v11
v_dot2_f32_bf16 v12, v158, v24, v12
v_dot2_f32_bf16 v13, v158, v25, v13
v_dot2_f32_bf16 v14, v159, v24, v14
v_dot2_f32_bf16 v15, v159, v25, v15
s_nop 2
cv v20,v8,v9
cv v21,v10,v11
cv v22,v12,v13
cv v23,v14,v15
buffer_store_dwordx2 v[20:21], v6, s[64:67], s59 offen
buffer_store_dwordx2 v[22:23], v6, s[64:67], s59 offen offset:32
s_nop 2
s_branch L_fin
L_two:
s_add_u32 s53, s52, 0
s_lshl_b32 s53, s53, 10
buffer_load_dwordx4 v[32:35], v2, s[28:31], s53 offen sc1
s_add_u32 s53, s53, 110592
buffer_load_dwordx4 v[36:39], v2, s[28:31], s53 offen sc1
s_add_u32 s53, s53, 110592
buffer_load_dwordx4 v[40:43], v2, s[28:31], s53 offen sc1
s_add_u32 s53, s53, 110592
buffer_load_dwordx4 v[44:47], v2, s[28:31], s53 offen sc1
s_add_u32 s53, s53, 110592
buffer_load_dwordx4 v[48:51], v2, s[28:31], s53 offen sc1
s_add_u32 s53, s53, 110592
buffer_load_dwordx4 v[52:55], v2, s[28:31], s53 offen sc1
s_add_u32 s53, s53, 110592
buffer_load_dwordx4 v[56:59], v2, s[28:31], s53 offen sc1
s_add_u32 s53, s53, 110592
buffer_load_dwordx4 v[60:63], v2, s[28:31], s53 offen sc1
s_add_u32 s53, s52, 32
s_lshl_b32 s53, s53, 10
buffer_load_dwordx4 v[64:67], v2, s[28:31], s53 offen sc1
s_add_u32 s53, s53, 110592
buffer_load_dwordx4 v[68:71], v2, s[28:31], s53 offen sc1
s_add_u32 s53, s53, 110592
buffer_load_dwordx4 v[72:75], v2, s[28:31], s53 offen sc1
s_add_u32 s53, s53, 110592
buffer_load_dwordx4 v[76:79], v2, s[28:31], s53 offen sc1
s_add_u32 s53, s53, 110592
buffer_load_dwordx4 v[80:83], v2, s[28:31], s53 offen sc1
s_add_u32 s53, s53, 110592
buffer_load_dwordx4 v[84:87], v2, s[28:31], s53 offen sc1
s_add_u32 s53, s53, 110592
buffer_load_dwordx4 v[88:91], v2, s[28:31], s53 offen sc1
s_add_u32 s53, s53, 110592
buffer_load_dwordx4 v[92:95], v2, s[28:31], s53 offen sc1
buffer_load_dwordx2 v[4:5], v26, s[28:31], s99 offen sc1
s_waitcnt vmcnt(16)
v_dot2_f32_bf16 v8, v32, v24, 0
v_dot2_f32_bf16 v9, v32, v25, 0
v_dot2_f32_bf16 v10, v33, v24, 0
v_dot2_f32_bf16 v11, v33, v25, 0
v_dot2_f32_bf16 v12, v34, v24, 0
v_dot2_f32_bf16 v13, v34, v25, 0
v_dot2_f32_bf16 v14, v35, v24, 0
v_dot2_f32_bf16 v15, v35, v25, 0
s_waitcnt vmcnt(15)
v_dot2_f32_bf16 v8, v36, v24, v8
v_dot2_f32_bf16 v9, v36, v25, v9
v_dot2_f32_bf16 v10, v37, v24, v10
v_dot2_f32_bf16 v11, v37, v25, v11
v_dot2_f32_bf16 v12, v38, v24, v12
v_dot2_f32_bf16 v13, v38, v25, v13
v_dot2_f32_bf16 v14, v39, v24, v14
v_dot2_f32_bf16 v15, v39, v25, v15
s_waitcnt vmcnt(14)
v_dot2_f32_bf16 v8, v40, v24, v8
v_dot2_f32_bf16 v9, v40, v25, v9
v_dot2_f32_bf16 v10, v41, v24, v10
v_dot2_f32_bf16 v11, v41, v25, v11
v_dot2_f32_bf16 v12, v42, v24, v12
v_dot2_f32_bf16 v13, v42, v25, v13
v_dot2_f32_bf16 v14, v43, v24, v14
v_dot2_f32_bf16 v15, v43, v25, v15
s_waitcnt vmcnt(13)
v_dot2_f32_bf16 v8, v44, v24, v8
v_dot2_f32_bf16 v9, v44, v25, v9
v_dot2_f32_bf16 v10, v45, v24, v10
v_dot2_f32_bf16 v11, v45, v25, v11
v_dot2_f32_bf16 v12, v46, v24, v12
v_dot2_f32_bf16 v13, v46, v25, v13
v_dot2_f32_bf16 v14, v47, v24, v14
v_dot2_f32_bf16 v15, v47, v25, v15
s_waitcnt vmcnt(12)
v_dot2_f32_bf16 v8, v48, v24, v8
v_dot2_f32_bf16 v9, v48, v25, v9
v_dot2_f32_bf16 v10, v49, v24, v10
v_dot2_f32_bf16 v11, v49, v25, v11
v_dot2_f32_bf16 v12, v50, v24, v12
v_dot2_f32_bf16 v13, v50, v25, v13
v_dot2_f32_bf16 v14, v51, v24, v14
v_dot2_f32_bf16 v15, v51, v25, v15
s_waitcnt vmcnt(11)
v_dot2_f32_bf16 v8, v52, v24, v8
v_dot2_f32_bf16 v9, v52, v25, v9
v_dot2_f32_bf16 v10, v53, v24, v10
v_dot2_f32_bf16 v11, v53, v25, v11
v_dot2_f32_bf16 v12, v54, v24, v12
v_dot2_f32_bf16 v13, v54, v25, v13
v_dot2_f32_bf16 v14, v55, v24, v14
v_dot2_f32_bf16 v15, v55, v25, v15
s_waitcnt vmcnt(10)
v_dot2_f32_bf16 v8, v56, v24, v8
v_dot2_f32_bf16 v9, v56, v25, v9
v_dot2_f32_bf16 v10, v57, v24, v10
v_dot2_f32_bf16 v11, v57, v25, v11
v_dot2_f32_bf16 v12, v58, v24, v12
v_dot2_f32_bf16 v13, v58, v25, v13
v_dot2_f32_bf16 v14, v59, v24, v14
v_dot2_f32_bf16 v15, v59, v25, v15
s_waitcnt vmcnt(9)
v_dot2_f32_bf16 v8, v60, v24, v8
v_dot2_f32_bf16 v9, v60, v25, v9
v_dot2_f32_bf16 v10, v61, v24, v10
v_dot2_f32_bf16 v11, v61, v25, v11
v_dot2_f32_bf16 v12, v62, v24, v12
v_dot2_f32_bf16 v13, v62, v25, v13
v_dot2_f32_bf16 v14, v63, v24, v14
v_dot2_f32_bf16 v15, v63, v25, v15
s_nop 2
cv v16,v8,v9
cv v17,v10,v11
cv v18,v12,v13
cv v19,v14,v15
buffer_store_dwordx2 v[16:17], v6, s[64:67], s56 offen
buffer_store_dwordx2 v[18:19], v6, s[64:67], s56 offen offset:32
s_nop 2
s_waitcnt vmcnt(10)
v_dot2_f32_bf16 v8, v64, v24, 0
v_dot2_f32_bf16 v9, v64, v25, 0
v_dot2_f32_bf16 v10, v65, v24, 0
v_dot2_f32_bf16 v11, v65, v25, 0
v_dot2_f32_bf16 v12, v66, v24, 0
v_dot2_f32_bf16 v13, v66, v25, 0
v_dot2_f32_bf16 v14, v67, v24, 0
v_dot2_f32_bf16 v15, v67, v25, 0
s_waitcnt vmcnt(9)
v_dot2_f32_bf16 v8, v68, v24, v8
v_dot2_f32_bf16 v9, v68, v25, v9
v_dot2_f32_bf16 v10, v69, v24, v10
v_dot2_f32_bf16 v11, v69, v25, v11
v_dot2_f32_bf16 v12, v70, v24, v12
v_dot2_f32_bf16 v13, v70, v25, v13
v_dot2_f32_bf16 v14, v71, v24, v14
v_dot2_f32_bf16 v15, v71, v25, v15
s_waitcnt vmcnt(8)
v_dot2_f32_bf16 v8, v72, v24, v8
v_dot2_f32_bf16 v9, v72, v25, v9
v_dot2_f32_bf16 v10, v73, v24, v10
v_dot2_f32_bf16 v11, v73, v25, v11
v_dot2_f32_bf16 v12, v74, v24, v12
v_dot2_f32_bf16 v13, v74, v25, v13
v_dot2_f32_bf16 v14, v75, v24, v14
v_dot2_f32_bf16 v15, v75, v25, v15
s_waitcnt vmcnt(7)
v_dot2_f32_bf16 v8, v76, v24, v8
v_dot2_f32_bf16 v9, v76, v25, v9
v_dot2_f32_bf16 v10, v77, v24, v10
v_dot2_f32_bf16 v11, v77, v25, v11
v_dot2_f32_bf16 v12, v78, v24, v12
v_dot2_f32_bf16 v13, v78, v25, v13
v_dot2_f32_bf16 v14, v79, v24, v14
v_dot2_f32_bf16 v15, v79, v25, v15
s_waitcnt vmcnt(6)
v_dot2_f32_bf16 v8, v80, v24, v8
v_dot2_f32_bf16 v9, v80, v25, v9
v_dot2_f32_bf16 v10, v81, v24, v10
v_dot2_f32_bf16 v11, v81, v25, v11
v_dot2_f32_bf16 v12, v82, v24, v12
v_dot2_f32_bf16 v13, v82, v25, v13
v_dot2_f32_bf16 v14, v83, v24, v14
v_dot2_f32_bf16 v15, v83, v25, v15
s_waitcnt vmcnt(5)
v_dot2_f32_bf16 v8, v84, v24, v8
v_dot2_f32_bf16 v9, v84, v25, v9
v_dot2_f32_bf16 v10, v85, v24, v10
v_dot2_f32_bf16 v11, v85, v25, v11
v_dot2_f32_bf16 v12, v86, v24, v12
v_dot2_f32_bf16 v13, v86, v25, v13
v_dot2_f32_bf16 v14, v87, v24, v14
v_dot2_f32_bf16 v15, v87, v25, v15
s_waitcnt vmcnt(4)
v_dot2_f32_bf16 v8, v88, v24, v8
v_dot2_f32_bf16 v9, v88, v25, v9
v_dot2_f32_bf16 v10, v89, v24, v10
v_dot2_f32_bf16 v11, v89, v25, v11
v_dot2_f32_bf16 v12, v90, v24, v12
v_dot2_f32_bf16 v13, v90, v25, v13
v_dot2_f32_bf16 v14, v91, v24, v14
v_dot2_f32_bf16 v15, v91, v25, v15
s_waitcnt vmcnt(3)
v_dot2_f32_bf16 v8, v92, v24, v8
v_dot2_f32_bf16 v9, v92, v25, v9
v_dot2_f32_bf16 v10, v93, v24, v10
v_dot2_f32_bf16 v11, v93, v25, v11
v_dot2_f32_bf16 v12, v94, v24, v12
v_dot2_f32_bf16 v13, v94, v25, v13
v_dot2_f32_bf16 v14, v95, v24, v14
v_dot2_f32_bf16 v15, v95, v25, v15
s_nop 2
cv v20,v8,v9
cv v21,v10,v11
cv v22,v12,v13
cv v23,v14,v15
buffer_store_dwordx2 v[20:21], v6, s[64:67], s57 offen
buffer_store_dwordx2 v[22:23], v6, s[64:67], s57 offen offset:32
s_nop 2
s_waitcnt vmcnt(4)
s_mov_b32 s53, 0
L_pollB:
v_cmp_eq_u32 vcc, 1, v5
s_add_u32 s53, s53, 1
s_nop 1
s_or_b64 vcc, vcc, s[48:49]
s_cmp_eq_u64 vcc, -1
s_cbranch_scc1 L_pdB
s_sleep 8
L_plB:
buffer_load_dwordx2 v[4:5], v26, s[28:31], s99 offen sc1
s_waitcnt vmcnt(0)
s_cmp_lt_u32 s53, 0x400000
s_cbranch_scc1 L_pollB
L_pdB:
s_add_u32 s53, s52, 64
s_lshl_b32 s53, s53, 10
buffer_load_dwordx4 v[96:99], v2, s[28:31], s53 offen sc1
s_add_u32 s53, s53, 110592
buffer_load_dwordx4 v[100:103], v2, s[28:31], s53 offen sc1
s_add_u32 s53, s53, 110592
buffer_load_dwordx4 v[104:107], v2, s[28:31], s53 offen sc1
s_add_u32 s53, s53, 110592
buffer_load_dwordx4 v[108:111], v2, s[28:31], s53 offen sc1
s_add_u32 s53, s53, 110592
buffer_load_dwordx4 v[112:115], v2, s[28:31], s53 offen sc1
s_add_u32 s53, s53, 110592
buffer_load_dwordx4 v[116:119], v2, s[28:31], s53 offen sc1
s_add_u32 s53, s53, 110592
buffer_load_dwordx4 v[120:123], v2, s[28:31], s53 offen sc1
s_add_u32 s53, s53, 110592
buffer_load_dwordx4 v[124:127], v2, s[28:31], s53 offen sc1
s_add_u32 s53, s52, 96
s_lshl_b32 s53, s53, 10
s_cmp_lt_u32 s52, 12
s_cselect_b32 s53, s53, 0x70000000
buffer_load_dwordx4 v[128:131], v2, s[28:31], s53 offen sc1
s_add_u32 s53, s53, 110592
buffer_load_dwordx4 v[132:135], v2, s[28:31], s53 offen sc1
s_add_u32 s53, s53, 110592
buffer_load_dwordx4 v[136:139], v2, s[28:31], s53 offen sc1
s_add_u32 s53, s53, 110592
buffer_load_dwordx4 v[140:143], v2, s[28:31], s53 offen sc1
s_add_u32 s53, s53, 110592
buffer_load_dwordx4 v[144:147], v2, s[28:31], s53 offen sc1
s_add_u32 s53, s53, 110592
buffer_load_dwordx4 v[148:151], v2, s[28:31], s53 offen sc1
s_add_u32 s53, s53, 110592
buffer_load_dwordx4 v[152:155], v2, s[28:31], s53 offen sc1
s_add_u32 s53, s53, 110592
buffer_load_dwordx4 v[156:159], v2, s[28:31], s53 offen sc1
s_waitcnt vmcnt(15)
v_dot2_f32_bf16 v8, v96, v24, 0
v_dot2_f32_bf16 v9, v96, v25, 0
v_dot2_f32_bf16 v10, v97, v24, 0
v_dot2_f32_bf16 v11, v97, v25, 0
v_dot2_f32_bf16 v12, v98, v24, 0
v_dot2_f32_bf16 v13, v98, v25, 0
v_dot2_f32_bf16 v14, v99, v24, 0
v_dot2_f32_bf16 v15, v99, v25, 0
s_waitcnt vmcnt(14)
v_dot2_f32_bf16 v8, v100, v24, v8
v_dot2_f32_bf16 v9, v100, v25, v9
v_dot2_f32_bf16 v10, v101, v24, v10
v_dot2_f32_bf16 v11, v101, v25, v11
v_dot2_f32_bf16 v12, v102, v24, v12
v_dot2_f32_bf16 v13, v102, v25, v13
v_dot2_f32_bf16 v14, v103, v24, v14
v_dot2_f32_bf16 v15, v103, v25, v15
s_waitcnt vmcnt(13)
v_dot2_f32_bf16 v8, v104, v24, v8
v_dot2_f32_bf16 v9, v104, v25, v9
v_dot2_f32_bf16 v10, v105, v24, v10
v_dot2_f32_bf16 v11, v105, v25, v11
v_dot2_f32_bf16 v12, v106, v24, v12
v_dot2_f32_bf16 v13, v106, v25, v13
v_dot2_f32_bf16 v14, v107, v24, v14
v_dot2_f32_bf16 v15, v107, v25, v15
s_waitcnt vmcnt(12)
v_dot2_f32_bf16 v8, v108, v24, v8
v_dot2_f32_bf16 v9, v108, v25, v9
v_dot2_f32_bf16 v10, v109, v24, v10
v_dot2_f32_bf16 v11, v109, v25, v11
v_dot2_f32_bf16 v12, v110, v24, v12
v_dot2_f32_bf16 v13, v110, v25, v13
v_dot2_f32_bf16 v14, v111, v24, v14
v_dot2_f32_bf16 v15, v111, v25, v15
s_waitcnt vmcnt(11)
v_dot2_f32_bf16 v8, v112, v24, v8
v_dot2_f32_bf16 v9, v112, v25, v9
v_dot2_f32_bf16 v10, v113, v24, v10
v_dot2_f32_bf16 v11, v113, v25, v11
v_dot2_f32_bf16 v12, v114, v24, v12
v_dot2_f32_bf16 v13, v114, v25, v13
v_dot2_f32_bf16 v14, v115, v24, v14
v_dot2_f32_bf16 v15, v115, v25, v15
s_waitcnt vmcnt(10)
v_dot2_f32_bf16 v8, v116, v24, v8
v_dot2_f32_bf16 v9, v116, v25, v9
v_dot2_f32_bf16 v10, v117, v24, v10
v_dot2_f32_bf16 v11, v117, v25, v11
v_dot2_f32_bf16 v12, v118, v24, v12
v_dot2_f32_bf16 v13, v118, v25, v13
v_dot2_f32_bf16 v14, v119, v24, v14
v_dot2_f32_bf16 v15, v119, v25, v15
s_waitcnt vmcnt(9)
v_dot2_f32_bf16 v8, v120, v24, v8
v_dot2_f32_bf16 v9, v120, v25, v9
v_dot2_f32_bf16 v10, v121, v24, v10
v_dot2_f32_bf16 v11, v121, v25, v11
v_dot2_f32_bf16 v12, v122, v24, v12
v_dot2_f32_bf16 v13, v122, v25, v13
v_dot2_f32_bf16 v14, v123, v24, v14
v_dot2_f32_bf16 v15, v123, v25, v15
s_waitcnt vmcnt(8)
v_dot2_f32_bf16 v8, v124, v24, v8
v_dot2_f32_bf16 v9, v124, v25, v9
v_dot2_f32_bf16 v10, v125, v24, v10
v_dot2_f32_bf16 v11, v125, v25, v11
v_dot2_f32_bf16 v12, v126, v24, v12
v_dot2_f32_bf16 v13, v126, v25, v13
v_dot2_f32_bf16 v14, v127, v24, v14
v_dot2_f32_bf16 v15, v127, v25, v15
s_nop 2
cv v16,v8,v9
cv v17,v10,v11
cv v18,v12,v13
cv v19,v14,v15
buffer_store_dwordx2 v[16:17], v6, s[64:67], s58 offen
buffer_store_dwordx2 v[18:19], v6, s[64:67], s58 offen offset:32
s_nop 2
s_waitcnt vmcnt(9)
v_dot2_f32_bf16 v8, v128, v24, 0
v_dot2_f32_bf16 v9, v128, v25, 0
v_dot2_f32_bf16 v10, v129, v24, 0
v_dot2_f32_bf16 v11, v129, v25, 0
v_dot2_f32_bf16 v12, v130, v24, 0
v_dot2_f32_bf16 v13, v130, v25, 0
v_dot2_f32_bf16 v14, v131, v24, 0
v_dot2_f32_bf16 v15, v131, v25, 0
s_waitcnt vmcnt(8)
v_dot2_f32_bf16 v8, v132, v24, v8
v_dot2_f32_bf16 v9, v132, v25, v9
v_dot2_f32_bf16 v10, v133, v24, v10
v_dot2_f32_bf16 v11, v133, v25, v11
v_dot2_f32_bf16 v12, v134, v24, v12
v_dot2_f32_bf16 v13, v134, v25, v13
v_dot2_f32_bf16 v14, v135, v24, v14
v_dot2_f32_bf16 v15, v135, v25, v15
s_waitcnt vmcnt(7)
v_dot2_f32_bf16 v8, v136, v24, v8
v_dot2_f32_bf16 v9, v136, v25, v9
v_dot2_f32_bf16 v10, v137, v24, v10
v_dot2_f32_bf16 v11, v137, v25, v11
v_dot2_f32_bf16 v12, v138, v24, v12
v_dot2_f32_bf16 v13, v138, v25, v13
v_dot2_f32_bf16 v14, v139, v24, v14
v_dot2_f32_bf16 v15, v139, v25, v15
s_waitcnt vmcnt(6)
v_dot2_f32_bf16 v8, v140, v24, v8
v_dot2_f32_bf16 v9, v140, v25, v9
v_dot2_f32_bf16 v10, v141, v24, v10
v_dot2_f32_bf16 v11, v141, v25, v11
v_dot2_f32_bf16 v12, v142, v24, v12
v_dot2_f32_bf16 v13, v142, v25, v13
v_dot2_f32_bf16 v14, v143, v24, v14
v_dot2_f32_bf16 v15, v143, v25, v15
s_waitcnt vmcnt(5)
v_dot2_f32_bf16 v8, v144, v24, v8
v_dot2_f32_bf16 v9, v144, v25, v9
v_dot2_f32_bf16 v10, v145, v24, v10
v_dot2_f32_bf16 v11, v145, v25, v11
v_dot2_f32_bf16 v12, v146, v24, v12
v_dot2_f32_bf16 v13, v146, v25, v13
v_dot2_f32_bf16 v14, v147, v24, v14
v_dot2_f32_bf16 v15, v147, v25, v15
s_waitcnt vmcnt(4)
v_dot2_f32_bf16 v8, v148, v24, v8
v_dot2_f32_bf16 v9, v148, v25, v9
v_dot2_f32_bf16 v10, v149, v24, v10
v_dot2_f32_bf16 v11, v149, v25, v11
v_dot2_f32_bf16 v12, v150, v24, v12
v_dot2_f32_bf16 v13, v150, v25, v13
v_dot2_f32_bf16 v14, v151, v24, v14
v_dot2_f32_bf16 v15, v151, v25, v15
s_waitcnt vmcnt(3)
v_dot2_f32_bf16 v8, v152, v24, v8
v_dot2_f32_bf16 v9, v152, v25, v9
v_dot2_f32_bf16 v10, v153, v24, v10
v_dot2_f32_bf16 v11, v153, v25, v11
v_dot2_f32_bf16 v12, v154, v24, v12
v_dot2_f32_bf16 v13, v154, v25, v13
v_dot2_f32_bf16 v14, v155, v24, v14
v_dot2_f32_bf16 v15, v155, v25, v15
s_waitcnt vmcnt(2)
v_dot2_f32_bf16 v8, v156, v24, v8
v_dot2_f32_bf16 v9, v156, v25, v9
v_dot2_f32_bf16 v10, v157, v24, v10
v_dot2_f32_bf16 v11, v157, v25, v11
v_dot2_f32_bf16 v12, v158, v24, v12
v_dot2_f32_bf16 v13, v158, v25, v13
v_dot2_f32_bf16 v14, v159, v24, v14
v_dot2_f32_bf16 v15, v159, v25, v15
s_nop 2
cv v20,v8,v9
cv v21,v10,v11
cv v22,v12,v13
cv v23,v14,v15
buffer_store_dwordx2 v[20:21], v6, s[64:67], s59 offen
buffer_store_dwordx2 v[22:23], v6, s[64:67], s59 offen offset:32
s_nop 2
L_fin:
s_endpgm
L_slow:
s_nop 15
s_waitcnt vmcnt(0) lgkmcnt(0)
s_lshl_b32 s50, s38, 17
s_add_u32 s48, s48, s50
v_and_b32 v213, 15, v0
v_lshlrev_b32 v212, 8, v213
v_lshrrev_b32 v184, 4, v0
v_lshl_add_u32 v212, v184, 4, v212
v_lshlrev_b32 v213, 1, v213
v_lshl_add_u32 v213, v184, 10, v213
v_mov_b32 v232, 0xff7fffff
v_mov_b32 v234, 0xff7fffff
v_mov_b32 v236, 0xff7fffff
s_mov_b32 s49, s48
s_mov_b32 s51, 0
L_sl1:
buffer_load_dwordx4 v[184:187], v212, s[8:11], s49 offen offset:0
buffer_load_dwordx4 v[188:191], v212, s[8:11], s49 offen offset:64
buffer_load_dwordx4 v[192:195], v212, s[8:11], s49 offen offset:128
buffer_load_dwordx4 v[196:199], v212, s[8:11], s49 offen offset:192
s_waitcnt vmcnt(3)
mf v[172:175],v[184:187],v[28:31],0
mf v[176:179],v[184:187],v[32:35],0
mf v[180:183],v[184:187],v[36:39],0
s_waitcnt vmcnt(2)
mf v[172:175],v[188:191],v[40:43],v[172:175]
mf v[176:179],v[188:191],v[44:47],v[176:179]
mf v[180:183],v[188:191],v[48:51],v[180:183]
s_waitcnt vmcnt(1)
mf v[172:175],v[192:195],v[52:55],v[172:175]
mf v[176:179],v[192:195],v[56:59],v[176:179]
mf v[180:183],v[192:195],v[60:63],v[180:183]
s_waitcnt vmcnt(0)
mf v[172:175],v[196:199],v[64:67],v[172:175]
mf v[176:179],v[196:199],v[68:71],v[176:179]
mf v[180:183],v[196:199],v[72:75],v[180:183]
s_nop 5
v_max3_f32 v232, v232, v172, v173
v_max3_f32 v232, v232, v174, v175
v_max3_f32 v234, v234, v176, v177
v_max3_f32 v234, v234, v178, v179
v_max3_f32 v236, v236, v180, v181
v_max3_f32 v236, v236, v182, v183
s_nop 15
s_waitcnt vmcnt(0) lgkmcnt(0)
s_add_u32 s49, s49, 4096
s_add_u32 s51, s51, 1
s_cmp_lt_u32 s51, 32
s_cbranch_scc1 L_sl1
v_mov_b32 v233, v232
s_nop 1
v_permlane16_swap_b32 v232, v233
v_max_f32 v232, v232, v233
v_mov_b32 v233, v232
s_nop 1
v_permlane32_swap_b32 v232, v233
v_max_f32 v232, v232, v233
v_sub_f32 v200, 0, v232
v_sub_f32 v201, 0, v232
v_sub_f32 v202, 0, v232
v_sub_f32 v203, 0, v232
v_mov_b32 v235, v234
s_nop 1
v_permlane16_swap_b32 v234, v235
v_max_f32 v234, v234, v235
v_mov_b32 v235, v234
s_nop 1
v_permlane32_swap_b32 v234, v235
v_max_f32 v234, v234, v235
v_sub_f32 v204, 0, v234
v_sub_f32 v205, 0, v234
v_sub_f32 v206, 0, v234
v_sub_f32 v207, 0, v234
v_mov_b32 v237, v236
s_nop 1
v_permlane16_swap_b32 v236, v237
v_max_f32 v236, v236, v237
v_mov_b32 v237, v236
s_nop 1
v_permlane32_swap_b32 v236, v237
v_max_f32 v236, v236, v237
v_sub_f32 v208, 0, v236
v_sub_f32 v209, 0, v236
v_sub_f32 v210, 0, v236
v_sub_f32 v211, 0, v236
v_mov_b32 v76, 0
v_mov_b32 v77, 0
v_mov_b32 v78, 0
v_mov_b32 v79, 0
v_mov_b32 v80, 0
v_mov_b32 v81, 0
v_mov_b32 v82, 0
v_mov_b32 v83, 0
v_mov_b32 v84, 0
v_mov_b32 v85, 0
v_mov_b32 v86, 0
v_mov_b32 v87, 0
v_mov_b32 v88, 0
v_mov_b32 v89, 0
v_mov_b32 v90, 0
v_mov_b32 v91, 0
v_mov_b32 v92, 0
v_mov_b32 v93, 0
v_mov_b32 v94, 0
v_mov_b32 v95, 0
v_mov_b32 v96, 0
v_mov_b32 v97, 0
v_mov_b32 v98, 0
v_mov_b32 v99, 0
v_mov_b32 v100, 0
v_mov_b32 v101, 0
v_mov_b32 v102, 0
v_mov_b32 v103, 0
v_mov_b32 v104, 0
v_mov_b32 v105, 0
v_mov_b32 v106, 0
v_mov_b32 v107, 0
v_mov_b32 v108, 0
v_mov_b32 v109, 0
v_mov_b32 v110, 0
v_mov_b32 v111, 0
v_mov_b32 v112, 0
v_mov_b32 v113, 0
v_mov_b32 v114, 0
v_mov_b32 v115, 0
v_mov_b32 v116, 0
v_mov_b32 v117, 0
v_mov_b32 v118, 0
v_mov_b32 v119, 0
v_mov_b32 v120, 0
v_mov_b32 v121, 0
v_mov_b32 v122, 0
v_mov_b32 v123, 0
v_mov_b32 v124, 0
v_mov_b32 v125, 0
v_mov_b32 v126, 0
v_mov_b32 v127, 0
v_mov_b32 v128, 0
v_mov_b32 v129, 0
v_mov_b32 v130, 0
v_mov_b32 v131, 0
v_mov_b32 v132, 0
v_mov_b32 v133, 0
v_mov_b32 v134, 0
v_mov_b32 v135, 0
v_mov_b32 v136, 0
v_mov_b32 v137, 0
v_mov_b32 v138, 0
v_mov_b32 v139, 0
v_mov_b32 v140, 0
v_mov_b32 v141, 0
v_mov_b32 v142, 0
v_mov_b32 v143, 0
v_mov_b32 v144, 0
v_mov_b32 v145, 0
v_mov_b32 v146, 0
v_mov_b32 v147, 0
v_mov_b32 v148, 0
v_mov_b32 v149, 0
v_mov_b32 v150, 0
v_mov_b32 v151, 0
v_mov_b32 v152, 0
v_mov_b32 v153, 0
v_mov_b32 v154, 0
v_mov_b32 v155, 0
v_mov_b32 v156, 0
v_mov_b32 v157, 0
v_mov_b32 v158, 0
v_mov_b32 v159, 0
v_mov_b32 v160, 0
v_mov_b32 v161, 0
v_mov_b32 v162, 0
v_mov_b32 v163, 0
v_mov_b32 v164, 0
v_mov_b32 v165, 0
v_mov_b32 v166, 0
v_mov_b32 v167, 0
v_mov_b32 v168, 0
v_mov_b32 v169, 0
v_mov_b32 v170, 0
v_mov_b32 v171, 0
v_accvgpr_write_b32 a216, 0
v_accvgpr_write_b32 a217, 0
v_accvgpr_write_b32 a218, 0
v_accvgpr_write_b32 a219, 0
v_accvgpr_write_b32 a220, 0
v_accvgpr_write_b32 a221, 0
v_accvgpr_write_b32 a222, 0
v_accvgpr_write_b32 a223, 0
v_accvgpr_write_b32 a224, 0
v_accvgpr_write_b32 a225, 0
v_accvgpr_write_b32 a226, 0
v_accvgpr_write_b32 a227, 0
s_mov_b32 s49, s48
s_mov_b32 s51, 0
L_sl2:
buffer_load_dwordx4 v[184:187], v212, s[8:11], s49 offen offset:0
buffer_load_dwordx4 v[188:191], v212, s[8:11], s49 offen offset:64
buffer_load_dwordx4 v[192:195], v212, s[8:11], s49 offen offset:128
buffer_load_dwordx4 v[196:199], v212, s[8:11], s49 offen offset:192
s_waitcnt vmcnt(3)
mf v[172:175],v[184:187],v[28:31],v[200:203]
mf v[176:179],v[184:187],v[32:35],v[204:207]
mf v[180:183],v[184:187],v[36:39],v[208:211]
s_waitcnt vmcnt(2)
mf v[172:175],v[188:191],v[40:43],v[172:175]
mf v[176:179],v[188:191],v[44:47],v[176:179]
mf v[180:183],v[188:191],v[48:51],v[180:183]
s_waitcnt vmcnt(1)
mf v[172:175],v[192:195],v[52:55],v[172:175]
mf v[176:179],v[192:195],v[56:59],v[176:179]
mf v[180:183],v[192:195],v[60:63],v[180:183]
s_waitcnt vmcnt(0)
mf v[172:175],v[196:199],v[64:67],v[172:175]
mf v[176:179],v[196:199],v[68:71],v[176:179]
mf v[180:183],v[196:199],v[72:75],v[180:183]
s_nop 5
ex v172
ex v173
ex v174
ex v175
ex v176
ex v177
ex v178
ex v179
ex v180
ex v181
ex v182
ex v183
cv v238,v172,v173
cv v239,v174,v175
cv v240,v176,v177
cv v241,v178,v179
cv v242,v180,v181
cv v243,v182,v183
s_nop 7
v_mfma_f32_16x16x16_bf16 a[216:219], a[228:229], v[238:239], a[216:219]
v_mfma_f32_16x16x16_bf16 a[220:223], a[228:229], v[240:241], a[220:223]
v_mfma_f32_16x16x16_bf16 a[224:227], a[228:229], v[242:243], a[224:227]
buffer_load_ushort v184, v213, s[12:15], s49 offen offset:0
buffer_load_ushort v192, v213, s[12:15], s49 offen offset:256
buffer_load_ushort v185, v213, s[12:15], s49 offen offset:512
buffer_load_ushort v193, v213, s[12:15], s49 offen offset:768
buffer_load_ushort v186, v213, s[12:15], s49 offen offset:32
buffer_load_ushort v194, v213, s[12:15], s49 offen offset:288
buffer_load_ushort v187, v213, s[12:15], s49 offen offset:544
buffer_load_ushort v195, v213, s[12:15], s49 offen offset:800
buffer_load_ushort v188, v213, s[12:15], s49 offen offset:64
buffer_load_ushort v196, v213, s[12:15], s49 offen offset:320
buffer_load_ushort v189, v213, s[12:15], s49 offen offset:576
buffer_load_ushort v197, v213, s[12:15], s49 offen offset:832
buffer_load_ushort v190, v213, s[12:15], s49 offen offset:96
buffer_load_ushort v198, v213, s[12:15], s49 offen offset:352
buffer_load_ushort v191, v213, s[12:15], s49 offen offset:608
buffer_load_ushort v199, v213, s[12:15], s49 offen offset:864
s_waitcnt vmcnt(14)
v_lshl_or_b32 v184, v192, 16, v184
s_waitcnt vmcnt(12)
v_lshl_or_b32 v185, v193, 16, v185
s_waitcnt vmcnt(10)
v_lshl_or_b32 v186, v194, 16, v186
s_waitcnt vmcnt(8)
v_lshl_or_b32 v187, v195, 16, v187
s_waitcnt vmcnt(6)
v_lshl_or_b32 v188, v196, 16, v188
s_waitcnt vmcnt(4)
v_lshl_or_b32 v189, v197, 16, v189
s_waitcnt vmcnt(2)
v_lshl_or_b32 v190, v198, 16, v190
s_waitcnt vmcnt(0)
v_lshl_or_b32 v191, v199, 16, v191
v_mfma_f32_16x16x16_bf16 v[76:79], v[184:185], v[238:239], v[76:79]
v_mfma_f32_16x16x16_bf16 v[80:83], v[184:185], v[240:241], v[80:83]
v_mfma_f32_16x16x16_bf16 v[84:87], v[184:185], v[242:243], v[84:87]
v_mfma_f32_16x16x16_bf16 v[88:91], v[186:187], v[238:239], v[88:91]
v_mfma_f32_16x16x16_bf16 v[92:95], v[186:187], v[240:241], v[92:95]
v_mfma_f32_16x16x16_bf16 v[96:99], v[186:187], v[242:243], v[96:99]
v_mfma_f32_16x16x16_bf16 v[100:103], v[188:189], v[238:239], v[100:103]
v_mfma_f32_16x16x16_bf16 v[104:107], v[188:189], v[240:241], v[104:107]
v_mfma_f32_16x16x16_bf16 v[108:111], v[188:189], v[242:243], v[108:111]
v_mfma_f32_16x16x16_bf16 v[112:115], v[190:191], v[238:239], v[112:115]
v_mfma_f32_16x16x16_bf16 v[116:119], v[190:191], v[240:241], v[116:119]
v_mfma_f32_16x16x16_bf16 v[120:123], v[190:191], v[242:243], v[120:123]
s_nop 7
buffer_load_ushort v184, v213, s[12:15], s49 offen offset:128
buffer_load_ushort v192, v213, s[12:15], s49 offen offset:384
buffer_load_ushort v185, v213, s[12:15], s49 offen offset:640
buffer_load_ushort v193, v213, s[12:15], s49 offen offset:896
buffer_load_ushort v186, v213, s[12:15], s49 offen offset:160
buffer_load_ushort v194, v213, s[12:15], s49 offen offset:416
buffer_load_ushort v187, v213, s[12:15], s49 offen offset:672
buffer_load_ushort v195, v213, s[12:15], s49 offen offset:928
buffer_load_ushort v188, v213, s[12:15], s49 offen offset:192
buffer_load_ushort v196, v213, s[12:15], s49 offen offset:448
buffer_load_ushort v189, v213, s[12:15], s49 offen offset:704
buffer_load_ushort v197, v213, s[12:15], s49 offen offset:960
buffer_load_ushort v190, v213, s[12:15], s49 offen offset:224
buffer_load_ushort v198, v213, s[12:15], s49 offen offset:480
buffer_load_ushort v191, v213, s[12:15], s49 offen offset:736
buffer_load_ushort v199, v213, s[12:15], s49 offen offset:992
s_waitcnt vmcnt(14)
v_lshl_or_b32 v184, v192, 16, v184
s_waitcnt vmcnt(12)
v_lshl_or_b32 v185, v193, 16, v185
s_waitcnt vmcnt(10)
v_lshl_or_b32 v186, v194, 16, v186
s_waitcnt vmcnt(8)
v_lshl_or_b32 v187, v195, 16, v187
s_waitcnt vmcnt(6)
v_lshl_or_b32 v188, v196, 16, v188
s_waitcnt vmcnt(4)
v_lshl_or_b32 v189, v197, 16, v189
s_waitcnt vmcnt(2)
v_lshl_or_b32 v190, v198, 16, v190
s_waitcnt vmcnt(0)
v_lshl_or_b32 v191, v199, 16, v191
v_mfma_f32_16x16x16_bf16 v[124:127], v[184:185], v[238:239], v[124:127]
v_mfma_f32_16x16x16_bf16 v[128:131], v[184:185], v[240:241], v[128:131]
v_mfma_f32_16x16x16_bf16 v[132:135], v[184:185], v[242:243], v[132:135]
v_mfma_f32_16x16x16_bf16 v[136:139], v[186:187], v[238:239], v[136:139]
v_mfma_f32_16x16x16_bf16 v[140:143], v[186:187], v[240:241], v[140:143]
v_mfma_f32_16x16x16_bf16 v[144:147], v[186:187], v[242:243], v[144:147]
v_mfma_f32_16x16x16_bf16 v[148:151], v[188:189], v[238:239], v[148:151]
v_mfma_f32_16x16x16_bf16 v[152:155], v[188:189], v[240:241], v[152:155]
v_mfma_f32_16x16x16_bf16 v[156:159], v[188:189], v[242:243], v[156:159]
v_mfma_f32_16x16x16_bf16 v[160:163], v[190:191], v[238:239], v[160:163]
v_mfma_f32_16x16x16_bf16 v[164:167], v[190:191], v[240:241], v[164:167]
v_mfma_f32_16x16x16_bf16 v[168:171], v[190:191], v[242:243], v[168:171]
s_nop 7
s_nop 15
s_waitcnt vmcnt(0) lgkmcnt(0)
s_add_u32 s49, s49, 4096
s_add_u32 s51, s51, 1
s_cmp_lt_u32 s51, 32
s_cbranch_scc1 L_sl2
v_mov_b32 v232, 0
v_mov_b32 v233, 0
v_mov_b32 v234, 0
v_mov_b32 v235, 0
v_mov_b32 v236, 0
v_mov_b32 v237, 0
v_mov_b32 v238, 0
v_mov_b32 v239, 0
v_mov_b32 v240, 0
v_mov_b32 v241, 0
v_mov_b32 v242, 0
v_mov_b32 v243, 0
v_accvgpr_read_b32 v244, a216
v_accvgpr_read_b32 v246, a220
v_accvgpr_read_b32 v254, a224
s_nop 7
s_setpc_b64 s[6:7]
L_end0:
s_endpgm
L_codeend:
.section .rodata,"a"
.p2align 6
.amdhsa_kernel concat_heads__mha_block_cached__mha_block_cached__near_ridge_kernel
  .amdhsa_next_free_vgpr 512
  .amdhsa_next_free_sgpr 102
  .amdhsa_accum_offset 256
  .amdhsa_group_segment_fixed_size 0
  .amdhsa_kernarg_size 104
  .amdhsa_user_sgpr_count 2
  .amdhsa_user_sgpr_kernarg_segment_ptr 1
  .amdhsa_system_sgpr_workgroup_id_x 1
.end_amdhsa_kernel
```
